```python
import torch

def _softmax(x, axis=-1):
    return torch.softmax(x, dim=axis)
def _gelu(x):
    return torch.nn.functional.gelu(x, approximate="tanh")
def _silu(x):
    return torch.nn.functional.silu(x)
def _sigmoid(x):
    return torch.sigmoid(x)
def _layernorm(x, axis=-1, eps=1e-5):
    m = x.mean(dim=axis, keepdim=True)
    v = x.var(dim=axis, keepdim=True, unbiased=False)
    return (x - m) / torch.sqrt(v + eps)
def _scatter_add(tgt, idx, src, axis=0):
    return tgt.clone().index_add_(axis, idx, src)
def _segment_sum(src, seg, n):
    out = torch.zeros((n,) + src.shape[1:], dtype=src.dtype)
    return out.index_add_(0, seg, src)
def _pad(x, pw):
    flat = tuple(v for pair in reversed(pw) for v in pair)
    return torch.nn.functional.pad(x, flat)

kernel_name = 'standalone__low_rank_proj_linformer__decode'

def setup_inputs():

    _w = (lambda a: (lambda t: t.to(torch.bfloat16) if t.is_floating_point() else t)(torch.as_tensor(a)))
    B, H, Sq, Skv, Dh, R = 2, 32, 1, 16384, 128, 64
    return {
        "q": _w((lambda *s: torch.randn(*s, dtype=torch.bfloat16) * 0.8)(B, H, Sq, Dh)),
        "k": _w((lambda *s: torch.randn(*s, dtype=torch.bfloat16) * 0.8)(B, H, Skv, Dh)),
        "v": _w((lambda *s: torch.randn(*s, dtype=torch.bfloat16) * 0.05)(B, H, Skv, Dh)),
        "e_proj": _w((lambda *s: torch.randn(*s, dtype=torch.bfloat16) * 0.8)(R, Skv) * (Skv ** -0.5)),
        "f_proj": _w((lambda *s: torch.randn(*s, dtype=torch.bfloat16) * 0.05)(R, Skv) * (Skv ** -0.5)),
    }

def reference(q, k, v, e_proj, f_proj):
    B, H, Sq, Dh = q.shape
    kp = torch.einsum("rn,bhnd->bhrd", e_proj, k)
    vp = torch.einsum("rn,bhnd->bhrd", f_proj, v)
    scores = torch.einsum("bhqd,bhrd->bhqr", q, kp) * (Dh ** -0.5)
    p = _softmax(scores, axis=-1)
    o = torch.einsum("bhqr,bhrd->bhqd", p, vp)
    return o
```

```asm
; @launch grid=(256,1,1) block=(512,1,1) lds=162816
.amdgcn_target "amdgcn-amd-amdhsa--gfx950"
.text
.globl standalone__low_rank_proj_linformer__decode_kernel
.p2align 8
.type standalone__low_rank_proj_linformer__decode_kernel,@function
standalone__low_rank_proj_linformer__decode_kernel:
    s_cmp_ge_u32 s2, 0x100
    s_cbranch_scc1 L_end
    s_load_dwordx16 s[4:19], s[0:1], 0
    v_readfirstlane_b32 s3, v0
    v_lshrrev_b32 v13, 4, v0
    v_and_b32 v14, 15, v0
    v_lshlrev_b32 v4, 4, v14
    s_lshr_b32 s40, s2, 4
    s_and_b32 s41, s2, 15
    s_lshr_b32 s3, s3, 6
    s_cmp_ge_u32 s3, 4
    s_cbranch_scc1 L_helper
    v_lshl_add_u32 v1, v13, 11, v4
    s_bfe_u32 s46, s41, 0x20000
    s_lshl_b32 s46, s46, 15
    s_bfe_u32 s42, s41, 0x10002
    s_lshl_b32 s42, s42, 18
    s_or_b32 s46, s46, s42
    s_bfe_u32 s42, s41, 0x10003
    s_lshl_b32 s42, s42, 21
    s_or_b32 s46, s46, s42
    s_bfe_u32 s43, s40, 0x30000
    s_lshl_b32 s43, s43, 8
    s_bfe_u32 s42, s40, 0x10003
    s_lshl_b32 s42, s42, 12
    s_or_b32 s43, s43, s42
    s_lshl_b32 s42, s43, 14
    s_add_u32 s42, s42, s46
    s_mov_b32 s22, 0xa1a8000
    s_mov_b32 s23, 0x20000
    s_mov_b32 s44, 0
    s_waitcnt lgkmcnt(0)
    s_add_u32 s20, s6, s42
    s_addc_u32 s21, s7, 0
    buffer_load_dwordx4 v[96:99], v1, s[20:23], s44 offen offset:0 nt
    buffer_load_dwordx4 v[100:103], v1, s[20:23], s44 offen offset:256 nt
    buffer_load_dwordx4 v[104:107], v1, s[20:23], s44 offen offset:512 nt
    buffer_load_dwordx4 v[108:111], v1, s[20:23], s44 offen offset:768 nt
    buffer_load_dwordx4 v[112:115], v1, s[20:23], s44 offen offset:1024 nt
    buffer_load_dwordx4 v[116:119], v1, s[20:23], s44 offen offset:1280 nt
    s_add_u32 s4, s4, s43
    s_addc_u32 s5, s5, 0
    global_load_dwordx4 v[16:19], v4, s[4:5]
    s_add_u32 s24, s8, s42
    s_addc_u32 s25, s9, 0
    s_mov_b32 s26, 0xa1a8000
    s_mov_b32 s27, 0x20000
    s_waitcnt vmcnt(6)
    buffer_load_dwordx4 v[120:123], v1, s[20:23], s44 offen offset:1536 nt
    s_waitcnt vmcnt(6)
    buffer_load_dwordx4 v[124:127], v1, s[20:23], s44 offen offset:1792 nt
    s_waitcnt vmcnt(6)
    s_mov_b32 s44, 0x20000
    buffer_load_dwordx4 v[44:47], v1, s[20:23], s44 offen offset:0 nt
    s_waitcnt vmcnt(6)
    buffer_load_dwordx4 v[48:51], v1, s[20:23], s44 offen offset:256 nt
    s_waitcnt vmcnt(4)
    v_dot2_f32_bf16 v32, v96, v16, 0
    v_dot2_f32_bf16 v32, v97, v17, v32
    v_dot2_f32_bf16 v32, v98, v18, v32
    v_dot2_f32_bf16 v32, v99, v19, v32
    v_dot2_f32_bf16 v33, v100, v16, 0
    v_dot2_f32_bf16 v33, v101, v17, v33
    v_dot2_f32_bf16 v33, v102, v18, v33
    v_dot2_f32_bf16 v33, v103, v19, v33
    v_dot2_f32_bf16 v34, v104, v16, 0
    v_dot2_f32_bf16 v34, v105, v17, v34
    v_dot2_f32_bf16 v34, v106, v18, v34
    v_dot2_f32_bf16 v34, v107, v19, v34
    v_cvt_pk_bf16_f32 v128, v32, v33
    v_dot2_f32_bf16 v35, v108, v16, 0
    v_dot2_f32_bf16 v35, v109, v17, v35
    v_dot2_f32_bf16 v35, v110, v18, v35
    v_dot2_f32_bf16 v35, v111, v19, v35
    v_dot2_f32_bf16 v36, v112, v16, 0
    v_dot2_f32_bf16 v36, v113, v17, v36
    v_dot2_f32_bf16 v36, v114, v18, v36
    v_dot2_f32_bf16 v36, v115, v19, v36
    buffer_load_dwordx4 v[96:99], v1, s[20:23], s44 offen offset:512 nt
    v_cvt_pk_bf16_f32 v129, v34, v35
    v_dot2_f32_bf16 v37, v116, v16, 0
    v_dot2_f32_bf16 v37, v117, v17, v37
    v_dot2_f32_bf16 v37, v118, v18, v37
    v_dot2_f32_bf16 v37, v119, v19, v37
    buffer_load_dwordx4 v[100:103], v1, s[20:23], s44 offen offset:768 nt
    s_waitcnt vmcnt(5)
    v_dot2_f32_bf16 v38, v120, v16, 0
    v_dot2_f32_bf16 v38, v121, v17, v38
    v_dot2_f32_bf16 v38, v122, v18, v38
    v_dot2_f32_bf16 v38, v123, v19, v38
    buffer_load_dwordx4 v[104:107], v1, s[20:23], s44 offen offset:1024 nt
    v_cvt_pk_bf16_f32 v130, v36, v37
    s_barrier
    s_waitcnt vmcnt(5)
    v_dot2_f32_bf16 v39, v124, v16, 0
    v_dot2_f32_bf16 v39, v125, v17, v39
    v_dot2_f32_bf16 v39, v126, v18, v39
    v_dot2_f32_bf16 v39, v127, v19, v39
    buffer_load_dwordx4 v[108:111], v1, s[20:23], s44 offen offset:1280 nt
    s_waitcnt vmcnt(5)
    v_dot2_f32_bf16 v32, v44, v16, 0
    v_dot2_f32_bf16 v32, v45, v17, v32
    v_dot2_f32_bf16 v32, v46, v18, v32
    v_dot2_f32_bf16 v32, v47, v19, v32
    buffer_load_dwordx4 v[112:115], v1, s[20:23], s44 offen offset:1536 nt
    v_cvt_pk_bf16_f32 v131, v38, v39
    s_waitcnt vmcnt(5)
    v_dot2_f32_bf16 v33, v48, v16, 0
    v_dot2_f32_bf16 v33, v49, v17, v33
    v_dot2_f32_bf16 v33, v50, v18, v33
    v_dot2_f32_bf16 v33, v51, v19, v33
    buffer_load_dwordx4 v[116:119], v1, s[20:23], s44 offen offset:1792 nt
    s_waitcnt vmcnt(5)
    v_dot2_f32_bf16 v34, v96, v16, 0
    v_dot2_f32_bf16 v34, v97, v17, v34
    v_dot2_f32_bf16 v34, v98, v18, v34
    v_dot2_f32_bf16 v34, v99, v19, v34
    s_mov_b32 s44, 0x80000
    buffer_load_dwordx4 v[96:99], v1, s[20:23], s44 offen offset:0 nt
    v_cvt_pk_bf16_f32 v132, v32, v33
    s_waitcnt vmcnt(5)
    v_dot2_f32_bf16 v35, v100, v16, 0
    v_dot2_f32_bf16 v35, v101, v17, v35
    v_dot2_f32_bf16 v35, v102, v18, v35
    v_dot2_f32_bf16 v35, v103, v19, v35
    buffer_load_dwordx4 v[100:103], v1, s[20:23], s44 offen offset:256 nt
    s_waitcnt vmcnt(5)
    v_dot2_f32_bf16 v36, v104, v16, 0
    v_dot2_f32_bf16 v36, v105, v17, v36
    v_dot2_f32_bf16 v36, v106, v18, v36
    v_dot2_f32_bf16 v36, v107, v19, v36
    buffer_load_dwordx4 v[104:107], v1, s[20:23], s44 offen offset:512 nt
    v_cvt_pk_bf16_f32 v133, v34, v35
    v_and_b32 v3, 3, v13
    v_lshrrev_b32 v9, 2, v14
    v_and_b32 v15, 3, v14
    v_lshlrev_b32 v6, 6, v9
    v_lshl_add_u32 v6, v3, 4, v6
    v_lshl_add_u32 v6, v15, 2, v6
    s_lshl_b32 s42, s3, 9
    s_add_u32 s43, s42, 18432
    s_waitcnt vmcnt(5)
    v_dot2_f32_bf16 v37, v108, v16, 0
    v_dot2_f32_bf16 v37, v109, v17, v37
    v_dot2_f32_bf16 v37, v110, v18, v37
    v_dot2_f32_bf16 v37, v111, v19, v37
    buffer_load_dwordx4 v[108:111], v1, s[20:23], s44 offen offset:768 nt
    v_add_u32 v6, s43, v6
    v_lshrrev_b32 v9, 3, v14
    s_mul_i32 s43, s3, 4608
    v_mul_u32_u24 v5, 576, v9
    v_lshl_add_u32 v5, v3, 4, v5
    v_add_u32 v5, s43, v5
    v_lshrrev_b32 v9, 1, v3
    v_and_b32 v15, 1, v3
    s_waitcnt vmcnt(5)
    v_dot2_f32_bf16 v38, v112, v16, 0
    v_dot2_f32_bf16 v38, v113, v17, v38
    v_dot2_f32_bf16 v38, v114, v18, v38
    v_dot2_f32_bf16 v38, v115, v19, v38
    buffer_load_dwordx4 v[112:115], v1, s[20:23], s44 offen offset:1024 nt
    v_cvt_pk_bf16_f32 v134, v36, v37
    v_lshlrev_b32 v8, 5, v14
    v_lshl_add_u32 v8, v15, 4, v8
    v_lshl_add_u32 v8, v9, 3, v8
    s_add_u32 s43, s42, 22528
    v_add_u32 v8, s43, v8
    s_mov_b32 s48, 0xcccccccc
    s_mov_b32 s49, 0xcccccccc
    s_mov_b32 s50, 0xaaaaaaaa
    s_waitcnt vmcnt(5)
    v_dot2_f32_bf16 v39, v116, v16, 0
    v_dot2_f32_bf16 v39, v117, v17, v39
    v_dot2_f32_bf16 v39, v118, v18, v39
    v_dot2_f32_bf16 v39, v119, v19, v39
    buffer_load_dwordx4 v[116:119], v1, s[20:23], s44 offen offset:1280 nt
    s_mov_b32 s51, 0xaaaaaaaa
    v_xor_b32 v9, v13, v14
    v_lshlrev_b32 v9, 4, v9
    v_lshl_add_u32 v9, v14, 8, v9
    v_add_u32 v208, 31744, v9
    v_add_u32 v209, 97280, v9
    v_mov_b32 v15, 0
    s_cmp_eq_u32 s3, 0
    s_waitcnt vmcnt(5)
    v_dot2_f32_bf16 v32, v96, v16, 0
    v_dot2_f32_bf16 v32, v97, v17, v32
    v_dot2_f32_bf16 v32, v98, v18, v32
    v_dot2_f32_bf16 v32, v99, v19, v32
    buffer_load_dwordx4 v[96:99], v1, s[20:23], s44 offen offset:1536 nt
    v_cvt_pk_bf16_f32 v135, v38, v39
    s_cselect_b32 s42, 0, 16
    v_mov_b32 v9, s42
    s_waitcnt vmcnt(5)
    v_dot2_f32_bf16 v33, v100, v16, 0
    v_dot2_f32_bf16 v33, v101, v17, v33
    v_dot2_f32_bf16 v33, v102, v18, v33
    v_dot2_f32_bf16 v33, v103, v19, v33
    buffer_load_dwordx4 v[100:103], v1, s[20:23], s44 offen offset:1792 nt
    s_waitcnt vmcnt(5)
    v_dot2_f32_bf16 v34, v104, v16, 0
    v_dot2_f32_bf16 v34, v105, v17, v34
    v_dot2_f32_bf16 v34, v106, v18, v34
    v_dot2_f32_bf16 v34, v107, v19, v34
    s_mov_b32 s44, 0xa0000
    buffer_load_dwordx4 v[104:107], v1, s[20:23], s44 offen offset:0 nt
    v_cvt_pk_bf16_f32 v136, v32, v33
    s_waitcnt vmcnt(5)
    v_dot2_f32_bf16 v35, v108, v16, 0
    v_dot2_f32_bf16 v35, v109, v17, v35
    v_dot2_f32_bf16 v35, v110, v18, v35
    v_dot2_f32_bf16 v35, v111, v19, v35
    buffer_load_dwordx4 v[108:111], v1, s[20:23], s44 offen offset:256 nt
    s_waitcnt vmcnt(5)
    v_dot2_f32_bf16 v36, v112, v16, 0
    v_dot2_f32_bf16 v36, v113, v17, v36
    v_dot2_f32_bf16 v36, v114, v18, v36
    v_dot2_f32_bf16 v36, v115, v19, v36
    s_add_u32 s4, s4, 2048
    s_addc_u32 s5, s5, 0
    global_load_dwordx4 v[20:23], v4, s[4:5]
    buffer_load_dwordx4 v[112:115], v1, s[20:23], s44 offen offset:512 nt
    v_cvt_pk_bf16_f32 v137, v34, v35
    s_waitcnt vmcnt(6)
    v_dot2_f32_bf16 v37, v116, v16, 0
    v_dot2_f32_bf16 v37, v117, v17, v37
    v_dot2_f32_bf16 v37, v118, v18, v37
    v_dot2_f32_bf16 v37, v119, v19, v37
    buffer_load_dwordx4 v[116:119], v1, s[20:23], s44 offen offset:768 nt
    s_waitcnt vmcnt(6)
    v_dot2_f32_bf16 v38, v96, v16, 0
    v_dot2_f32_bf16 v38, v97, v17, v38
    v_dot2_f32_bf16 v38, v98, v18, v38
    v_dot2_f32_bf16 v38, v99, v19, v38
    s_add_u32 s4, s4, 6144
    s_addc_u32 s5, s5, 0
    global_load_dwordx4 v[24:27], v4, s[4:5]
    buffer_load_dwordx4 v[96:99], v1, s[20:23], s44 offen offset:1024 nt
    v_cvt_pk_bf16_f32 v138, v36, v37
    s_waitcnt vmcnt(7)
    v_dot2_f32_bf16 v39, v100, v16, 0
    v_dot2_f32_bf16 v39, v101, v17, v39
    v_dot2_f32_bf16 v39, v102, v18, v39
    v_dot2_f32_bf16 v39, v103, v19, v39
    buffer_load_dwordx4 v[100:103], v1, s[20:23], s44 offen offset:1280 nt
    s_waitcnt vmcnt(7)
    v_dot2_f32_bf16 v32, v104, v16, 0
    v_dot2_f32_bf16 v32, v105, v17, v32
    v_dot2_f32_bf16 v32, v106, v18, v32
    v_dot2_f32_bf16 v32, v107, v19, v32
    s_add_u32 s4, s4, 2048
    s_addc_u32 s5, s5, 0
    global_load_dwordx4 v[28:31], v4, s[4:5]
    buffer_load_dwordx4 v[104:107], v1, s[20:23], s44 offen offset:1536 nt
    v_cvt_pk_bf16_f32 v139, v38, v39
    s_waitcnt vmcnt(8)
    v_dot2_f32_bf16 v33, v108, v16, 0
    v_dot2_f32_bf16 v33, v109, v17, v33
    v_dot2_f32_bf16 v33, v110, v18, v33
    v_dot2_f32_bf16 v33, v111, v19, v33
    buffer_load_dwordx4 v[108:111], v1, s[20:23], s44 offen offset:1792 nt
    s_waitcnt vmcnt(7)
    v_dot2_f32_bf16 v34, v112, v16, 0
    v_dot2_f32_bf16 v34, v113, v17, v34
    v_dot2_f32_bf16 v34, v114, v18, v34
    v_dot2_f32_bf16 v34, v115, v19, v34
    s_mov_b32 s44, 0x100000
    buffer_load_dwordx4 v[112:115], v1, s[20:23], s44 offen offset:0 nt
    v_cvt_pk_bf16_f32 v140, v32, v33
    s_waitcnt vmcnt(7)
    v_dot2_f32_bf16 v35, v116, v16, 0
    v_dot2_f32_bf16 v35, v117, v17, v35
    v_dot2_f32_bf16 v35, v118, v18, v35
    v_dot2_f32_bf16 v35, v119, v19, v35
    buffer_load_dwordx4 v[116:119], v1, s[20:23], s44 offen offset:256 nt
    s_waitcnt vmcnt(6)
    v_dot2_f32_bf16 v36, v96, v16, 0
    v_dot2_f32_bf16 v36, v97, v17, v36
    v_dot2_f32_bf16 v36, v98, v18, v36
    v_dot2_f32_bf16 v36, v99, v19, v36
    buffer_load_dwordx4 v[96:99], v1, s[20:23], s44 offen offset:512 nt
    v_cvt_pk_bf16_f32 v141, v34, v35
    s_waitcnt vmcnt(6)
    v_dot2_f32_bf16 v37, v100, v16, 0
    v_dot2_f32_bf16 v37, v101, v17, v37
    v_dot2_f32_bf16 v37, v102, v18, v37
    v_dot2_f32_bf16 v37, v103, v19, v37
    buffer_load_dwordx4 v[100:103], v1, s[20:23], s44 offen offset:768 nt
    s_waitcnt vmcnt(5)
    v_dot2_f32_bf16 v38, v104, v16, 0
    v_dot2_f32_bf16 v38, v105, v17, v38
    v_dot2_f32_bf16 v38, v106, v18, v38
    v_dot2_f32_bf16 v38, v107, v19, v38
    buffer_load_dwordx4 v[104:107], v1, s[20:23], s44 offen offset:1024 nt
    v_cvt_pk_bf16_f32 v142, v36, v37
    s_waitcnt vmcnt(5)
    v_dot2_f32_bf16 v39, v108, v16, 0
    v_dot2_f32_bf16 v39, v109, v17, v39
    v_dot2_f32_bf16 v39, v110, v18, v39
    v_dot2_f32_bf16 v39, v111, v19, v39
    buffer_load_dwordx4 v[108:111], v1, s[20:23], s44 offen offset:1280 nt
    s_waitcnt vmcnt(5)
    v_dot2_f32_bf16 v32, v112, v16, 0
    v_dot2_f32_bf16 v32, v113, v17, v32
    v_dot2_f32_bf16 v32, v114, v18, v32
    v_dot2_f32_bf16 v32, v115, v19, v32
    buffer_load_dwordx4 v[112:115], v1, s[20:23], s44 offen offset:1536 nt
    v_cvt_pk_bf16_f32 v143, v38, v39
    s_waitcnt vmcnt(5)
    v_dot2_f32_bf16 v33, v116, v16, 0
    v_dot2_f32_bf16 v33, v117, v17, v33
    v_dot2_f32_bf16 v33, v118, v18, v33
    v_dot2_f32_bf16 v33, v119, v19, v33
    buffer_load_dwordx4 v[116:119], v1, s[20:23], s44 offen offset:1792 nt
    s_waitcnt vmcnt(5)
    v_dot2_f32_bf16 v34, v96, v16, 0
    v_dot2_f32_bf16 v34, v97, v17, v34
    v_dot2_f32_bf16 v34, v98, v18, v34
    v_dot2_f32_bf16 v34, v99, v19, v34
    s_mov_b32 s44, 0x120000
    buffer_load_dwordx4 v[96:99], v1, s[20:23], s44 offen offset:0 nt
    v_cvt_pk_bf16_f32 v144, v32, v33
    s_waitcnt vmcnt(5)
    v_dot2_f32_bf16 v35, v100, v16, 0
    v_dot2_f32_bf16 v35, v101, v17, v35
    v_dot2_f32_bf16 v35, v102, v18, v35
    v_dot2_f32_bf16 v35, v103, v19, v35
    buffer_load_dwordx4 v[100:103], v1, s[20:23], s44 offen offset:256 nt
    s_waitcnt vmcnt(5)
    v_dot2_f32_bf16 v36, v104, v16, 0
    v_dot2_f32_bf16 v36, v105, v17, v36
    v_dot2_f32_bf16 v36, v106, v18, v36
    v_dot2_f32_bf16 v36, v107, v19, v36
    buffer_load_dwordx4 v[104:107], v1, s[20:23], s44 offen offset:512 nt
    v_cvt_pk_bf16_f32 v145, v34, v35
    s_waitcnt vmcnt(5)
    v_dot2_f32_bf16 v37, v108, v16, 0
    v_dot2_f32_bf16 v37, v109, v17, v37
    v_dot2_f32_bf16 v37, v110, v18, v37
    v_dot2_f32_bf16 v37, v111, v19, v37
    buffer_load_dwordx4 v[108:111], v1, s[20:23], s44 offen offset:768 nt
    s_waitcnt vmcnt(5)
    v_dot2_f32_bf16 v38, v112, v16, 0
    v_dot2_f32_bf16 v38, v113, v17, v38
    v_dot2_f32_bf16 v38, v114, v18, v38
    v_dot2_f32_bf16 v38, v115, v19, v38
    buffer_load_dwordx4 v[112:115], v1, s[20:23], s44 offen offset:1024 nt
    v_cvt_pk_bf16_f32 v146, v36, v37
    s_waitcnt vmcnt(5)
    v_dot2_f32_bf16 v39, v116, v16, 0
    v_dot2_f32_bf16 v39, v117, v17, v39
    v_dot2_f32_bf16 v39, v118, v18, v39
    v_dot2_f32_bf16 v39, v119, v19, v39
    buffer_load_dwordx4 v[116:119], v1, s[20:23], s44 offen offset:1280 nt
    s_waitcnt vmcnt(5)
    v_dot2_f32_bf16 v32, v96, v16, 0
    v_dot2_f32_bf16 v32, v97, v17, v32
    v_dot2_f32_bf16 v32, v98, v18, v32
    v_dot2_f32_bf16 v32, v99, v19, v32
    buffer_load_dwordx4 v[96:99], v1, s[20:23], s44 offen offset:1536 nt
    v_cvt_pk_bf16_f32 v147, v38, v39
    s_waitcnt vmcnt(5)
    v_dot2_f32_bf16 v33, v100, v16, 0
    v_dot2_f32_bf16 v33, v101, v17, v33
    v_dot2_f32_bf16 v33, v102, v18, v33
    v_dot2_f32_bf16 v33, v103, v19, v33
    buffer_load_dwordx4 v[100:103], v1, s[20:23], s44 offen offset:1792 nt
    s_waitcnt vmcnt(5)
    v_dot2_f32_bf16 v34, v104, v16, 0
    v_dot2_f32_bf16 v34, v105, v17, v34
    v_dot2_f32_bf16 v34, v106, v18, v34
    v_dot2_f32_bf16 v34, v107, v19, v34
    s_mov_b32 s44, 0x180000
    buffer_load_dwordx4 v[104:107], v1, s[20:23], s44 offen offset:0 nt
    v_cvt_pk_bf16_f32 v148, v32, v33
    s_waitcnt vmcnt(5)
    v_dot2_f32_bf16 v35, v108, v16, 0
    v_dot2_f32_bf16 v35, v109, v17, v35
    v_dot2_f32_bf16 v35, v110, v18, v35
    v_dot2_f32_bf16 v35, v111, v19, v35
    buffer_load_dwordx4 v[108:111], v1, s[20:23], s44 offen offset:256 nt
    s_waitcnt vmcnt(5)
    v_dot2_f32_bf16 v36, v112, v16, 0
    v_dot2_f32_bf16 v36, v113, v17, v36
    v_dot2_f32_bf16 v36, v114, v18, v36
    v_dot2_f32_bf16 v36, v115, v19, v36
    buffer_load_dwordx4 v[112:115], v1, s[20:23], s44 offen offset:512 nt
    v_cvt_pk_bf16_f32 v149, v34, v35
    s_waitcnt vmcnt(5)
    v_dot2_f32_bf16 v37, v116, v16, 0
    v_dot2_f32_bf16 v37, v117, v17, v37
    v_dot2_f32_bf16 v37, v118, v18, v37
    v_dot2_f32_bf16 v37, v119, v19, v37
    buffer_load_dwordx4 v[116:119], v1, s[20:23], s44 offen offset:768 nt
    s_waitcnt vmcnt(5)
    v_dot2_f32_bf16 v38, v96, v16, 0
    v_dot2_f32_bf16 v38, v97, v17, v38
    v_dot2_f32_bf16 v38, v98, v18, v38
    v_dot2_f32_bf16 v38, v99, v19, v38
    buffer_load_dwordx4 v[96:99], v1, s[20:23], s44 offen offset:1024 nt
    v_cvt_pk_bf16_f32 v150, v36, v37
    s_waitcnt vmcnt(5)
    v_dot2_f32_bf16 v39, v100, v16, 0
    v_dot2_f32_bf16 v39, v101, v17, v39
    v_dot2_f32_bf16 v39, v102, v18, v39
    v_dot2_f32_bf16 v39, v103, v19, v39
    buffer_load_dwordx4 v[100:103], v1, s[20:23], s44 offen offset:1280 nt
    s_waitcnt vmcnt(5)
    v_dot2_f32_bf16 v32, v104, v16, 0
    v_dot2_f32_bf16 v32, v105, v17, v32
    v_dot2_f32_bf16 v32, v106, v18, v32
    v_dot2_f32_bf16 v32, v107, v19, v32
    buffer_load_dwordx4 v[104:107], v1, s[20:23], s44 offen offset:1536 nt
    v_cvt_pk_bf16_f32 v151, v38, v39
    s_waitcnt vmcnt(5)
    v_dot2_f32_bf16 v33, v108, v16, 0
    v_dot2_f32_bf16 v33, v109, v17, v33
    v_dot2_f32_bf16 v33, v110, v18, v33
    v_dot2_f32_bf16 v33, v111, v19, v33
    buffer_load_dwordx4 v[108:111], v1, s[20:23], s44 offen offset:1792 nt
    s_waitcnt vmcnt(5)
    v_dot2_f32_bf16 v34, v112, v16, 0
    v_dot2_f32_bf16 v34, v113, v17, v34
    v_dot2_f32_bf16 v34, v114, v18, v34
    v_dot2_f32_bf16 v34, v115, v19, v34
    s_mov_b32 s44, 0x1a0000
    buffer_load_dwordx4 v[112:115], v1, s[20:23], s44 offen offset:0 nt
    v_cvt_pk_bf16_f32 v152, v32, v33
    s_waitcnt vmcnt(5)
    v_dot2_f32_bf16 v35, v116, v16, 0
    v_dot2_f32_bf16 v35, v117, v17, v35
    v_dot2_f32_bf16 v35, v118, v18, v35
    v_dot2_f32_bf16 v35, v119, v19, v35
    buffer_load_dwordx4 v[116:119], v1, s[20:23], s44 offen offset:256 nt
    s_waitcnt vmcnt(5)
    v_dot2_f32_bf16 v36, v96, v16, 0
    v_dot2_f32_bf16 v36, v97, v17, v36
    v_dot2_f32_bf16 v36, v98, v18, v36
    v_dot2_f32_bf16 v36, v99, v19, v36
    buffer_load_dwordx4 v[96:99], v1, s[20:23], s44 offen offset:512 nt
    v_cvt_pk_bf16_f32 v153, v34, v35
    s_waitcnt vmcnt(5)
    v_dot2_f32_bf16 v37, v100, v16, 0
    v_dot2_f32_bf16 v37, v101, v17, v37
    v_dot2_f32_bf16 v37, v102, v18, v37
    v_dot2_f32_bf16 v37, v103, v19, v37
    buffer_load_dwordx4 v[100:103], v1, s[20:23], s44 offen offset:768 nt
    s_waitcnt vmcnt(5)
    v_dot2_f32_bf16 v38, v104, v16, 0
    v_dot2_f32_bf16 v38, v105, v17, v38
    v_dot2_f32_bf16 v38, v106, v18, v38
    v_dot2_f32_bf16 v38, v107, v19, v38
    buffer_load_dwordx4 v[104:107], v1, s[20:23], s44 offen offset:1024 nt
    v_cvt_pk_bf16_f32 v154, v36, v37
    s_waitcnt vmcnt(5)
    v_dot2_f32_bf16 v39, v108, v16, 0
    v_dot2_f32_bf16 v39, v109, v17, v39
    v_dot2_f32_bf16 v39, v110, v18, v39
    v_dot2_f32_bf16 v39, v111, v19, v39
    buffer_load_dwordx4 v[108:111], v1, s[20:23], s44 offen offset:1280 nt
    s_waitcnt vmcnt(5)
    v_dot2_f32_bf16 v32, v112, v16, 0
    v_dot2_f32_bf16 v32, v113, v17, v32
    v_dot2_f32_bf16 v32, v114, v18, v32
    v_dot2_f32_bf16 v32, v115, v19, v32
    buffer_load_dwordx4 v[112:115], v1, s[20:23], s44 offen offset:1536 nt
    v_cvt_pk_bf16_f32 v155, v38, v39
    s_waitcnt vmcnt(5)
    v_dot2_f32_bf16 v33, v116, v16, 0
    v_dot2_f32_bf16 v33, v117, v17, v33
    v_dot2_f32_bf16 v33, v118, v18, v33
    v_dot2_f32_bf16 v33, v119, v19, v33
    buffer_load_dwordx4 v[116:119], v1, s[20:23], s44 offen offset:1792 nt
    s_waitcnt vmcnt(5)
    v_dot2_f32_bf16 v34, v96, v16, 0
    v_dot2_f32_bf16 v34, v97, v17, v34
    v_dot2_f32_bf16 v34, v98, v18, v34
    v_dot2_f32_bf16 v34, v99, v19, v34
    s_mov_b32 s44, 0x2000000
    buffer_load_dwordx4 v[96:99], v1, s[20:23], s44 offen offset:0 nt
    v_cvt_pk_bf16_f32 v156, v32, v33
    s_waitcnt vmcnt(5)
    v_dot2_f32_bf16 v35, v100, v16, 0
    v_dot2_f32_bf16 v35, v101, v17, v35
    v_dot2_f32_bf16 v35, v102, v18, v35
    v_dot2_f32_bf16 v35, v103, v19, v35
    buffer_load_dwordx4 v[100:103], v1, s[20:23], s44 offen offset:256 nt
    s_waitcnt vmcnt(5)
    v_dot2_f32_bf16 v36, v104, v16, 0
    v_dot2_f32_bf16 v36, v105, v17, v36
    v_dot2_f32_bf16 v36, v106, v18, v36
    v_dot2_f32_bf16 v36, v107, v19, v36
    buffer_load_dwordx4 v[104:107], v1, s[20:23], s44 offen offset:512 nt
    v_cvt_pk_bf16_f32 v157, v34, v35
    s_waitcnt vmcnt(5)
    v_dot2_f32_bf16 v37, v108, v16, 0
    v_dot2_f32_bf16 v37, v109, v17, v37
    v_dot2_f32_bf16 v37, v110, v18, v37
    v_dot2_f32_bf16 v37, v111, v19, v37
    buffer_load_dwordx4 v[108:111], v1, s[20:23], s44 offen offset:768 nt
    s_waitcnt vmcnt(5)
    v_dot2_f32_bf16 v38, v112, v16, 0
    v_dot2_f32_bf16 v38, v113, v17, v38
    v_dot2_f32_bf16 v38, v114, v18, v38
    v_dot2_f32_bf16 v38, v115, v19, v38
    buffer_load_dwordx4 v[112:115], v1, s[20:23], s44 offen offset:1024 nt
    v_cvt_pk_bf16_f32 v158, v36, v37
    s_waitcnt vmcnt(5)
    v_dot2_f32_bf16 v39, v116, v16, 0
    v_dot2_f32_bf16 v39, v117, v17, v39
    v_dot2_f32_bf16 v39, v118, v18, v39
    v_dot2_f32_bf16 v39, v119, v19, v39
    buffer_load_dwordx4 v[116:119], v1, s[20:23], s44 offen offset:1280 nt
    s_waitcnt vmcnt(5)
    v_dot2_f32_bf16 v32, v96, v20, 0
    v_dot2_f32_bf16 v32, v97, v21, v32
    v_dot2_f32_bf16 v32, v98, v22, v32
    v_dot2_f32_bf16 v32, v99, v23, v32
    buffer_load_dwordx4 v[96:99], v1, s[20:23], s44 offen offset:1536 nt
    v_cvt_pk_bf16_f32 v159, v38, v39
    s_waitcnt vmcnt(5)
    v_dot2_f32_bf16 v33, v100, v20, 0
    v_dot2_f32_bf16 v33, v101, v21, v33
    v_dot2_f32_bf16 v33, v102, v22, v33
    v_dot2_f32_bf16 v33, v103, v23, v33
    buffer_load_dwordx4 v[100:103], v1, s[20:23], s44 offen offset:1792 nt
    s_waitcnt vmcnt(5)
    v_dot2_f32_bf16 v34, v104, v20, 0
    v_dot2_f32_bf16 v34, v105, v21, v34
    v_dot2_f32_bf16 v34, v106, v22, v34
    v_dot2_f32_bf16 v34, v107, v23, v34
    s_mov_b32 s44, 0x2020000
    buffer_load_dwordx4 v[104:107], v1, s[20:23], s44 offen offset:0 nt
    v_cvt_pk_bf16_f32 v160, v32, v33
    s_waitcnt vmcnt(5)
    v_dot2_f32_bf16 v35, v108, v20, 0
    v_dot2_f32_bf16 v35, v109, v21, v35
    v_dot2_f32_bf16 v35, v110, v22, v35
    v_dot2_f32_bf16 v35, v111, v23, v35
    buffer_load_dwordx4 v[108:111], v1, s[20:23], s44 offen offset:256 nt
    s_waitcnt vmcnt(5)
    v_dot2_f32_bf16 v36, v112, v20, 0
    v_dot2_f32_bf16 v36, v113, v21, v36
    v_dot2_f32_bf16 v36, v114, v22, v36
    v_dot2_f32_bf16 v36, v115, v23, v36
    buffer_load_dwordx4 v[112:115], v1, s[20:23], s44 offen offset:512 nt
    v_cvt_pk_bf16_f32 v161, v34, v35
    s_waitcnt vmcnt(5)
    v_dot2_f32_bf16 v37, v116, v20, 0
    v_dot2_f32_bf16 v37, v117, v21, v37
    v_dot2_f32_bf16 v37, v118, v22, v37
    v_dot2_f32_bf16 v37, v119, v23, v37
    buffer_load_dwordx4 v[116:119], v1, s[20:23], s44 offen offset:768 nt
    s_waitcnt vmcnt(5)
    v_dot2_f32_bf16 v38, v96, v20, 0
    v_dot2_f32_bf16 v38, v97, v21, v38
    v_dot2_f32_bf16 v38, v98, v22, v38
    v_dot2_f32_bf16 v38, v99, v23, v38
    buffer_load_dwordx4 v[96:99], v1, s[20:23], s44 offen offset:1024 nt
    v_cvt_pk_bf16_f32 v162, v36, v37
    s_waitcnt vmcnt(5)
    v_dot2_f32_bf16 v39, v100, v20, 0
    v_dot2_f32_bf16 v39, v101, v21, v39
    v_dot2_f32_bf16 v39, v102, v22, v39
    v_dot2_f32_bf16 v39, v103, v23, v39
    buffer_load_dwordx4 v[100:103], v1, s[20:23], s44 offen offset:1280 nt
    s_waitcnt vmcnt(5)
    v_dot2_f32_bf16 v32, v104, v20, 0
    v_dot2_f32_bf16 v32, v105, v21, v32
    v_dot2_f32_bf16 v32, v106, v22, v32
    v_dot2_f32_bf16 v32, v107, v23, v32
    buffer_load_dwordx4 v[104:107], v1, s[20:23], s44 offen offset:1536 nt
    v_cvt_pk_bf16_f32 v163, v38, v39
    v_and_b32 v52, 7, v14
    v_and_b32 v53, 1, v52
    v_lshrrev_b32 v52, 1, v52
    v_cmp_eq_u32 vcc, 1, v53
    v_mov_b32 v53, 0x0c0c0100
    v_mov_b32 v54, 0x01000c0c
    v_cndmask_b32 v53, v53, v54, vcc
    v_mov_b32 v54, 0x0c0c0302
    s_waitcnt vmcnt(5)
    v_dot2_f32_bf16 v33, v108, v20, 0
    v_dot2_f32_bf16 v33, v109, v21, v33
    v_dot2_f32_bf16 v33, v110, v22, v33
    v_dot2_f32_bf16 v33, v111, v23, v33
    buffer_load_dwordx4 v[108:111], v1, s[20:23], s44 offen offset:1792 nt
    v_mov_b32 v55, 0x03020c0c
    v_cndmask_b32 v54, v54, v55, vcc
    v_mov_b32 v55, 0x0c0c0c0c
    v_cmp_eq_u32 vcc, 0, v52
    s_nop 1
    v_cndmask_b32 v44, v55, v53, vcc
    v_cndmask_b32 v48, v55, v54, vcc
    v_cmp_eq_u32 vcc, 1, v52
    s_nop 1
    v_cndmask_b32 v45, v55, v53, vcc
    s_waitcnt vmcnt(5)
    v_dot2_f32_bf16 v34, v112, v20, 0
    v_dot2_f32_bf16 v34, v113, v21, v34
    v_dot2_f32_bf16 v34, v114, v22, v34
    v_dot2_f32_bf16 v34, v115, v23, v34
    s_mov_b32 s44, 0x2080000
    buffer_load_dwordx4 v[112:115], v1, s[20:23], s44 offen offset:0 nt
    v_cvt_pk_bf16_f32 v164, v32, v33
    v_cndmask_b32 v49, v55, v54, vcc
    v_cmp_eq_u32 vcc, 2, v52
    s_nop 1
    v_cndmask_b32 v46, v55, v53, vcc
    v_cndmask_b32 v50, v55, v54, vcc
    v_cmp_eq_u32 vcc, 3, v52
    s_nop 1
    v_cndmask_b32 v47, v55, v53, vcc
    v_cndmask_b32 v51, v55, v54, vcc
    s_waitcnt vmcnt(5)
    v_dot2_f32_bf16 v35, v116, v20, 0
    v_dot2_f32_bf16 v35, v117, v21, v35
    v_dot2_f32_bf16 v35, v118, v22, v35
    v_dot2_f32_bf16 v35, v119, v23, v35
    buffer_load_dwordx4 v[116:119], v1, s[20:23], s44 offen offset:256 nt
    s_waitcnt vmcnt(5)
    v_dot2_f32_bf16 v36, v96, v20, 0
    v_dot2_f32_bf16 v36, v97, v21, v36
    v_dot2_f32_bf16 v36, v98, v22, v36
    v_dot2_f32_bf16 v36, v99, v23, v36
    buffer_load_dwordx4 v[96:99], v1, s[20:23], s44 offen offset:512 nt
    v_cvt_pk_bf16_f32 v165, v34, v35
    s_waitcnt vmcnt(5)
    v_dot2_f32_bf16 v37, v100, v20, 0
    v_dot2_f32_bf16 v37, v101, v21, v37
    v_dot2_f32_bf16 v37, v102, v22, v37
    v_dot2_f32_bf16 v37, v103, v23, v37
    buffer_load_dwordx4 v[100:103], v1, s[20:23], s44 offen offset:768 nt
    s_waitcnt vmcnt(5)
    v_dot2_f32_bf16 v38, v104, v20, 0
    v_dot2_f32_bf16 v38, v105, v21, v38
    v_dot2_f32_bf16 v38, v106, v22, v38
    v_dot2_f32_bf16 v38, v107, v23, v38
    buffer_load_dwordx4 v[104:107], v1, s[20:23], s44 offen offset:1024 nt
    v_cvt_pk_bf16_f32 v166, v36, v37
    s_waitcnt vmcnt(5)
    v_dot2_f32_bf16 v39, v108, v20, 0
    v_dot2_f32_bf16 v39, v109, v21, v39
    v_dot2_f32_bf16 v39, v110, v22, v39
    v_dot2_f32_bf16 v39, v111, v23, v39
    buffer_load_dwordx4 v[108:111], v1, s[20:23], s44 offen offset:1280 nt
    s_waitcnt vmcnt(5)
    v_dot2_f32_bf16 v32, v112, v20, 0
    v_dot2_f32_bf16 v32, v113, v21, v32
    v_dot2_f32_bf16 v32, v114, v22, v32
    v_dot2_f32_bf16 v32, v115, v23, v32
    buffer_load_dwordx4 v[112:115], v1, s[20:23], s44 offen offset:1536 nt
    v_cvt_pk_bf16_f32 v167, v38, v39
    s_waitcnt vmcnt(5)
    v_dot2_f32_bf16 v33, v116, v20, 0
    v_dot2_f32_bf16 v33, v117, v21, v33
    v_dot2_f32_bf16 v33, v118, v22, v33
    v_dot2_f32_bf16 v33, v119, v23, v33
    buffer_load_dwordx4 v[116:119], v1, s[20:23], s44 offen offset:1792 nt
    s_waitcnt vmcnt(5)
    v_dot2_f32_bf16 v34, v96, v20, 0
    v_dot2_f32_bf16 v34, v97, v21, v34
    v_dot2_f32_bf16 v34, v98, v22, v34
    v_dot2_f32_bf16 v34, v99, v23, v34
    s_mov_b32 s44, 0x20a0000
    buffer_load_dwordx4 v[96:99], v1, s[20:23], s44 offen offset:0 nt
    v_cvt_pk_bf16_f32 v168, v32, v33
    s_waitcnt vmcnt(5)
    v_dot2_f32_bf16 v35, v100, v20, 0
    v_dot2_f32_bf16 v35, v101, v21, v35
    v_dot2_f32_bf16 v35, v102, v22, v35
    v_dot2_f32_bf16 v35, v103, v23, v35
    buffer_load_dwordx4 v[100:103], v1, s[20:23], s44 offen offset:256 nt
    s_waitcnt vmcnt(5)
    v_dot2_f32_bf16 v36, v104, v20, 0
    v_dot2_f32_bf16 v36, v105, v21, v36
    v_dot2_f32_bf16 v36, v106, v22, v36
    v_dot2_f32_bf16 v36, v107, v23, v36
    buffer_load_dwordx4 v[104:107], v1, s[20:23], s44 offen offset:512 nt
    v_cvt_pk_bf16_f32 v169, v34, v35
    s_waitcnt vmcnt(5)
    v_dot2_f32_bf16 v37, v108, v20, 0
    v_dot2_f32_bf16 v37, v109, v21, v37
    v_dot2_f32_bf16 v37, v110, v22, v37
    v_dot2_f32_bf16 v37, v111, v23, v37
    buffer_load_dwordx4 v[108:111], v1, s[20:23], s44 offen offset:768 nt
    s_waitcnt vmcnt(5)
    v_dot2_f32_bf16 v38, v112, v20, 0
    v_dot2_f32_bf16 v38, v113, v21, v38
    v_dot2_f32_bf16 v38, v114, v22, v38
    v_dot2_f32_bf16 v38, v115, v23, v38
    buffer_load_dwordx4 v[112:115], v1, s[20:23], s44 offen offset:1024 nt
    v_cvt_pk_bf16_f32 v170, v36, v37
    s_waitcnt vmcnt(5)
    v_dot2_f32_bf16 v39, v116, v20, 0
    v_dot2_f32_bf16 v39, v117, v21, v39
    v_dot2_f32_bf16 v39, v118, v22, v39
    v_dot2_f32_bf16 v39, v119, v23, v39
    buffer_load_dwordx4 v[116:119], v1, s[20:23], s44 offen offset:1280 nt
    s_waitcnt vmcnt(5)
    v_dot2_f32_bf16 v32, v96, v20, 0
    v_dot2_f32_bf16 v32, v97, v21, v32
    v_dot2_f32_bf16 v32, v98, v22, v32
    v_dot2_f32_bf16 v32, v99, v23, v32
    buffer_load_dwordx4 v[96:99], v1, s[20:23], s44 offen offset:1536 nt
    v_cvt_pk_bf16_f32 v171, v38, v39
    s_waitcnt vmcnt(5)
    v_dot2_f32_bf16 v33, v100, v20, 0
    v_dot2_f32_bf16 v33, v101, v21, v33
    v_dot2_f32_bf16 v33, v102, v22, v33
    v_dot2_f32_bf16 v33, v103, v23, v33
    buffer_load_dwordx4 v[100:103], v1, s[20:23], s44 offen offset:1792 nt
    s_waitcnt vmcnt(5)
    v_dot2_f32_bf16 v34, v104, v20, 0
    v_dot2_f32_bf16 v34, v105, v21, v34
    v_dot2_f32_bf16 v34, v106, v22, v34
    v_dot2_f32_bf16 v34, v107, v23, v34
    s_mov_b32 s44, 0x2100000
    buffer_load_dwordx4 v[104:107], v1, s[20:23], s44 offen offset:0 nt
    v_cvt_pk_bf16_f32 v172, v32, v33
    ds_read_b128 v[192:195], v15 offset:31296
    s_waitcnt vmcnt(5)
    v_dot2_f32_bf16 v35, v108, v20, 0
    v_dot2_f32_bf16 v35, v109, v21, v35
    v_dot2_f32_bf16 v35, v110, v22, v35
    v_dot2_f32_bf16 v35, v111, v23, v35
    buffer_load_dwordx4 v[108:111], v1, s[20:23], s44 offen offset:256 nt
    s_waitcnt vmcnt(5)
    v_dot2_f32_bf16 v36, v112, v20, 0
    v_dot2_f32_bf16 v36, v113, v21, v36
    v_dot2_f32_bf16 v36, v114, v22, v36
    v_dot2_f32_bf16 v36, v115, v23, v36
    buffer_load_dwordx4 v[112:115], v1, s[20:23], s44 offen offset:512 nt
    v_cvt_pk_bf16_f32 v173, v34, v35
    s_waitcnt vmcnt(5)
    v_dot2_f32_bf16 v37, v116, v20, 0
    v_dot2_f32_bf16 v37, v117, v21, v37
    v_dot2_f32_bf16 v37, v118, v22, v37
    v_dot2_f32_bf16 v37, v119, v23, v37
    buffer_load_dwordx4 v[116:119], v1, s[20:23], s44 offen offset:768 nt
    s_waitcnt lgkmcnt(0)
L_wchk2:
    v_and_b32 v192, v192, v193
    v_and_b32 v194, v194, v195
    v_and_b32 v192, v192, v194
    s_nop 0
    v_readfirstlane_b32 s55, v192
    s_nop 1
    s_cmp_lg_u32 s55, 0
    s_cbranch_scc1 L_wok2
    s_sleep 2
    ds_read_b128 v[192:195], v15 offset:31296
    s_waitcnt lgkmcnt(0)
    s_branch L_wchk2
L_wok2:
    s_waitcnt vmcnt(5)
    v_dot2_f32_bf16 v38, v96, v20, 0
    v_dot2_f32_bf16 v38, v97, v21, v38
    v_dot2_f32_bf16 v38, v98, v22, v38
    v_dot2_f32_bf16 v38, v99, v23, v38
    buffer_load_dwordx4 v[96:99], v1, s[20:23], s44 offen offset:1024 nt
    v_cvt_pk_bf16_f32 v174, v36, v37
    ds_read_b128 v[192:195], v208 offset:0
    ds_read_b128 v[196:199], v208 offset:4096
    ds_read_b128 v[200:203], v208 offset:8192
    ds_read_b128 v[204:207], v208 offset:12288
    s_waitcnt vmcnt(5)
    v_dot2_f32_bf16 v39, v100, v20, 0
    v_dot2_f32_bf16 v39, v101, v21, v39
    v_dot2_f32_bf16 v39, v102, v22, v39
    v_dot2_f32_bf16 v39, v103, v23, v39
    buffer_load_dwordx4 v[100:103], v1, s[20:23], s44 offen offset:1280 nt
    s_waitcnt vmcnt(5)
    v_dot2_f32_bf16 v32, v104, v20, 0
    v_dot2_f32_bf16 v32, v105, v21, v32
    v_dot2_f32_bf16 v32, v106, v22, v32
    v_dot2_f32_bf16 v32, v107, v23, v32
    buffer_load_dwordx4 v[104:107], v1, s[20:23], s44 offen offset:1536 nt
    v_cvt_pk_bf16_f32 v175, v38, v39
    s_waitcnt vmcnt(5)
    v_dot2_f32_bf16 v33, v108, v20, 0
    v_dot2_f32_bf16 v33, v109, v21, v33
    v_dot2_f32_bf16 v33, v110, v22, v33
    v_dot2_f32_bf16 v33, v111, v23, v33
    buffer_load_dwordx4 v[108:111], v1, s[20:23], s44 offen offset:1792 nt
    s_waitcnt lgkmcnt(3)
    v_mfma_f32_16x16x32_bf16 v[80:83], v[192:195], v[160:163], 0
    s_waitcnt lgkmcnt(2)
    v_mfma_f32_16x16x32_bf16 v[84:87], v[196:199], v[160:163], 0
    s_waitcnt lgkmcnt(1)
    v_mfma_f32_16x16x32_bf16 v[88:91], v[200:203], v[160:163], 0
    s_waitcnt lgkmcnt(0)
    v_mfma_f32_16x16x32_bf16 v[92:95], v[204:207], v[160:163], 0
    v_mfma_f32_16x16x32_bf16 v[64:67], v[192:195], v[128:131], 0
    v_mfma_f32_16x16x32_bf16 v[68:71], v[196:199], v[128:131], 0
    v_mfma_f32_16x16x32_bf16 v[72:75], v[200:203], v[128:131], 0
    v_mfma_f32_16x16x32_bf16 v[76:79], v[204:207], v[128:131], 0
    s_waitcnt vmcnt(5)
    v_dot2_f32_bf16 v34, v112, v20, 0
    v_dot2_f32_bf16 v34, v113, v21, v34
    v_dot2_f32_bf16 v34, v114, v22, v34
    v_dot2_f32_bf16 v34, v115, v23, v34
    s_mov_b32 s44, 0x2120000
    buffer_load_dwordx4 v[112:115], v1, s[20:23], s44 offen offset:0 nt
    v_cvt_pk_bf16_f32 v176, v32, v33
    ds_read_b128 v[192:195], v208 offset:16384
    ds_read_b128 v[196:199], v208 offset:20480
    ds_read_b128 v[200:203], v208 offset:24576
    ds_read_b128 v[204:207], v208 offset:28672
    s_waitcnt vmcnt(5)
    v_dot2_f32_bf16 v35, v116, v20, 0
    v_dot2_f32_bf16 v35, v117, v21, v35
    v_dot2_f32_bf16 v35, v118, v22, v35
    v_dot2_f32_bf16 v35, v119, v23, v35
    buffer_load_dwordx4 v[116:119], v1, s[20:23], s44 offen offset:256 nt
    s_waitcnt vmcnt(5)
    v_dot2_f32_bf16 v36, v96, v20, 0
    v_dot2_f32_bf16 v36, v97, v21, v36
    v_dot2_f32_bf16 v36, v98, v22, v36
    v_dot2_f32_bf16 v36, v99, v23, v36
    buffer_load_dwordx4 v[96:99], v1, s[20:23], s44 offen offset:512 nt
    v_cvt_pk_bf16_f32 v177, v34, v35
    s_waitcnt vmcnt(5)
    v_dot2_f32_bf16 v37, v100, v20, 0
    v_dot2_f32_bf16 v37, v101, v21, v37
    v_dot2_f32_bf16 v37, v102, v22, v37
    v_dot2_f32_bf16 v37, v103, v23, v37
    buffer_load_dwordx4 v[100:103], v1, s[20:23], s44 offen offset:768 nt
    s_waitcnt lgkmcnt(3)
    v_mfma_f32_16x16x32_bf16 v[80:83], v[192:195], v[164:167], v[80:83]
    s_waitcnt lgkmcnt(2)
    v_mfma_f32_16x16x32_bf16 v[84:87], v[196:199], v[164:167], v[84:87]
    s_waitcnt lgkmcnt(1)
    v_mfma_f32_16x16x32_bf16 v[88:91], v[200:203], v[164:167], v[88:91]
    s_waitcnt lgkmcnt(0)
    v_mfma_f32_16x16x32_bf16 v[92:95], v[204:207], v[164:167], v[92:95]
    v_mfma_f32_16x16x32_bf16 v[64:67], v[192:195], v[132:135], v[64:67]
    v_mfma_f32_16x16x32_bf16 v[68:71], v[196:199], v[132:135], v[68:71]
    v_mfma_f32_16x16x32_bf16 v[72:75], v[200:203], v[132:135], v[72:75]
    v_mfma_f32_16x16x32_bf16 v[76:79], v[204:207], v[132:135], v[76:79]
    s_waitcnt vmcnt(5)
    v_dot2_f32_bf16 v38, v104, v20, 0
    v_dot2_f32_bf16 v38, v105, v21, v38
    v_dot2_f32_bf16 v38, v106, v22, v38
    v_dot2_f32_bf16 v38, v107, v23, v38
    buffer_load_dwordx4 v[104:107], v1, s[20:23], s44 offen offset:1024 nt
    s_mov_b64 vcc, 0
    s_cmp_lg_u32 0, 0
    v_cvt_pk_bf16_f32 v178, v36, v37
    ds_read_b128 v[192:195], v208 offset:32768
    ds_read_b128 v[196:199], v208 offset:36864
    ds_read_b128 v[200:203], v208 offset:40960
    ds_read_b128 v[204:207], v208 offset:45056
    s_waitcnt vmcnt(5)
    v_dot2_f32_bf16 v39, v108, v20, 0
    v_dot2_f32_bf16 v39, v109, v21, v39
    v_dot2_f32_bf16 v39, v110, v22, v39
    v_dot2_f32_bf16 v39, v111, v23, v39
    s_cbranch_vccnz L_is109
    s_waitcnt vmcnt(5)
    s_cbranch_scc0 L_is109
    s_waitcnt vmcnt(4)
L_is109:
    buffer_load_dwordx4 v[108:111], v1, s[20:23], s44 offen offset:1280 nt
    s_cbranch_vccnz L_is110
    s_waitcnt vmcnt(5)
    s_cbranch_scc0 L_is110
    s_waitcnt vmcnt(4)
L_is110:
    buffer_load_dwordx4 v[120:123], v1, s[20:23], s44 offen offset:1536 nt
    s_waitcnt vmcnt(6)
    v_dot2_f32_bf16 v32, v112, v20, 0
    v_dot2_f32_bf16 v32, v113, v21, v32
    v_dot2_f32_bf16 v32, v114, v22, v32
    v_dot2_f32_bf16 v32, v115, v23, v32
    s_cbranch_vccnz L_is111
    s_waitcnt vmcnt(5)
    s_cbranch_scc0 L_is111
    s_waitcnt vmcnt(4)
L_is111:
    buffer_load_dwordx4 v[112:115], v1, s[20:23], s44 offen offset:1792 nt
    v_mov_b32 v3, 26
    ds_write_b32 v9, v3 offset:31268
    v_cvt_pk_bf16_f32 v179, v38, v39
    s_waitcnt vmcnt(6)
    v_dot2_f32_bf16 v33, v116, v20, 0
    v_dot2_f32_bf16 v33, v117, v21, v33
    v_dot2_f32_bf16 v33, v118, v22, v33
    v_dot2_f32_bf16 v33, v119, v23, v33
    s_cbranch_vccnz L_is112
    s_waitcnt vmcnt(5)
    s_cbranch_scc0 L_is112
    s_waitcnt vmcnt(4)
L_is112:
    s_mov_b32 s44, 0x2180000
    buffer_load_dwordx4 v[116:119], v1, s[20:23], s44 offen offset:0 nt
    ds_read_b32 v2, v15 offset:31272
    s_waitcnt lgkmcnt(5)
    v_mfma_f32_16x16x32_bf16 v[80:83], v[192:195], v[168:171], v[80:83]
    s_waitcnt lgkmcnt(4)
    v_mfma_f32_16x16x32_bf16 v[84:87], v[196:199], v[168:171], v[84:87]
    s_waitcnt lgkmcnt(3)
    v_mfma_f32_16x16x32_bf16 v[88:91], v[200:203], v[168:171], v[88:91]
    s_waitcnt lgkmcnt(2)
    v_mfma_f32_16x16x32_bf16 v[92:95], v[204:207], v[168:171], v[92:95]
    v_mfma_f32_16x16x32_bf16 v[64:67], v[192:195], v[136:139], v[64:67]
    v_mfma_f32_16x16x32_bf16 v[68:71], v[196:199], v[136:139], v[68:71]
    v_mfma_f32_16x16x32_bf16 v[72:75], v[200:203], v[136:139], v[72:75]
    v_mfma_f32_16x16x32_bf16 v[76:79], v[204:207], v[136:139], v[76:79]
    s_waitcnt vmcnt(6)
    v_dot2_f32_bf16 v34, v96, v20, 0
    v_dot2_f32_bf16 v34, v97, v21, v34
    v_dot2_f32_bf16 v34, v98, v22, v34
    v_dot2_f32_bf16 v34, v99, v23, v34
    s_cbranch_vccnz L_is113
    s_waitcnt vmcnt(5)
    s_cbranch_scc0 L_is113
    s_waitcnt vmcnt(4)
L_is113:
    buffer_load_dwordx4 v[96:99], v1, s[20:23], s44 offen offset:256 nt
    v_cvt_pk_bf16_f32 v180, v32, v33
    ds_read_b128 v[192:195], v208 offset:49152
    ds_read_b128 v[196:199], v208 offset:53248
    ds_read_b128 v[200:203], v208 offset:57344
    ds_read_b128 v[204:207], v208 offset:61440
    s_waitcnt vmcnt(6)
    v_dot2_f32_bf16 v35, v100, v20, 0
    v_dot2_f32_bf16 v35, v101, v21, v35
    v_dot2_f32_bf16 v35, v102, v22, v35
    v_dot2_f32_bf16 v35, v103, v23, v35
    s_cbranch_vccnz L_is114
    s_waitcnt vmcnt(5)
    s_cbranch_scc0 L_is114
    s_waitcnt vmcnt(4)
L_is114:
    buffer_load_dwordx4 v[100:103], v1, s[20:23], s44 offen offset:512 nt
    s_waitcnt lgkmcnt(4)
    v_readfirstlane_b32 s55, v2
    s_nop 1
    s_cmp_ge_u32 s55, 0x1c00
    s_cselect_b32 s55, s55, 0
    s_bitcmp1_b32 s55, 1
    s_cselect_b64 vcc, -1, 0
    s_bitcmp1_b32 s55, 0
    s_waitcnt vmcnt(6)
    v_dot2_f32_bf16 v36, v104, v20, 0
    v_dot2_f32_bf16 v36, v105, v21, v36
    v_dot2_f32_bf16 v36, v106, v22, v36
    v_dot2_f32_bf16 v36, v107, v23, v36
    s_cbranch_vccnz L_is115
    s_waitcnt vmcnt(5)
    s_cbranch_scc0 L_is115
    s_waitcnt vmcnt(4)
L_is115:
    buffer_load_dwordx4 v[104:107], v1, s[20:23], s44 offen offset:768 nt
    v_mov_b32 v3, 27
    ds_write_b32 v9, v3 offset:31268
    v_cvt_pk_bf16_f32 v181, v34, v35
    s_waitcnt vmcnt(6)
    v_dot2_f32_bf16 v37, v108, v20, 0
    v_dot2_f32_bf16 v37, v109, v21, v37
    v_dot2_f32_bf16 v37, v110, v22, v37
    v_dot2_f32_bf16 v37, v111, v23, v37
    s_cbranch_vccnz L_is116
    s_waitcnt vmcnt(5)
    s_cbranch_scc0 L_is116
    s_waitcnt vmcnt(4)
L_is116:
    buffer_load_dwordx4 v[108:111], v1, s[20:23], s44 offen offset:1024 nt
    ds_read_b32 v2, v15 offset:31272
    s_waitcnt lgkmcnt(5)
    v_mfma_f32_16x16x32_bf16 v[80:83], v[192:195], v[172:175], v[80:83]
    s_waitcnt lgkmcnt(4)
    v_mfma_f32_16x16x32_bf16 v[84:87], v[196:199], v[172:175], v[84:87]
    s_waitcnt lgkmcnt(3)
    v_mfma_f32_16x16x32_bf16 v[88:91], v[200:203], v[172:175], v[88:91]
    s_waitcnt lgkmcnt(2)
    v_mfma_f32_16x16x32_bf16 v[92:95], v[204:207], v[172:175], v[92:95]
    v_mfma_f32_16x16x32_bf16 v[64:67], v[192:195], v[140:143], v[64:67]
    v_mfma_f32_16x16x32_bf16 v[68:71], v[196:199], v[140:143], v[68:71]
    v_mfma_f32_16x16x32_bf16 v[72:75], v[200:203], v[140:143], v[72:75]
    v_mfma_f32_16x16x32_bf16 v[76:79], v[204:207], v[140:143], v[76:79]
    s_waitcnt vmcnt(6)
    v_dot2_f32_bf16 v38, v120, v20, 0
    v_dot2_f32_bf16 v38, v121, v21, v38
    v_dot2_f32_bf16 v38, v122, v22, v38
    v_dot2_f32_bf16 v38, v123, v23, v38
    s_cbranch_vccnz L_is117
    s_waitcnt vmcnt(5)
    s_cbranch_scc0 L_is117
    s_waitcnt vmcnt(4)
L_is117:
    buffer_load_dwordx4 v[120:123], v1, s[20:23], s44 offen offset:1280 nt
    v_cvt_pk_bf16_f32 v182, v36, v37
    ds_read_b128 v[192:195], v209 offset:0
    ds_read_b128 v[196:199], v209 offset:4096
    ds_read_b128 v[200:203], v209 offset:8192
    ds_read_b128 v[204:207], v209 offset:12288
    s_waitcnt vmcnt(6)
    v_dot2_f32_bf16 v39, v112, v20, 0
    v_dot2_f32_bf16 v39, v113, v21, v39
    v_dot2_f32_bf16 v39, v114, v22, v39
    v_dot2_f32_bf16 v39, v115, v23, v39
    s_cbranch_vccnz L_is118
    s_waitcnt vmcnt(5)
    s_cbranch_scc0 L_is118
    s_waitcnt vmcnt(4)
L_is118:
    buffer_load_dwordx4 v[112:115], v1, s[20:23], s44 offen offset:1536 nt
    s_waitcnt lgkmcnt(4)
    v_readfirstlane_b32 s55, v2
    s_nop 1
    s_cmp_ge_u32 s55, 0x1d00
    s_cselect_b32 s55, s55, 0
    s_bitcmp1_b32 s55, 1
    s_cselect_b64 vcc, -1, 0
    s_bitcmp1_b32 s55, 0
    s_waitcnt vmcnt(6)
    v_dot2_f32_bf16 v32, v116, v20, 0
    v_dot2_f32_bf16 v32, v117, v21, v32
    v_dot2_f32_bf16 v32, v118, v22, v32
    v_dot2_f32_bf16 v32, v119, v23, v32
    s_cbranch_vccnz L_is119
    s_waitcnt vmcnt(5)
    s_cbranch_scc0 L_is119
    s_waitcnt vmcnt(4)
L_is119:
    buffer_load_dwordx4 v[116:119], v1, s[20:23], s44 offen offset:1792 nt
    v_mov_b32 v3, 28
    ds_write_b32 v9, v3 offset:31268
    v_cvt_pk_bf16_f32 v183, v38, v39
    s_waitcnt vmcnt(6)
    v_dot2_f32_bf16 v33, v96, v20, 0
    v_dot2_f32_bf16 v33, v97, v21, v33
    v_dot2_f32_bf16 v33, v98, v22, v33
    v_dot2_f32_bf16 v33, v99, v23, v33
    s_cbranch_vccnz L_is120
    s_waitcnt vmcnt(5)
    s_cbranch_scc0 L_is120
    s_waitcnt vmcnt(4)
L_is120:
    s_mov_b32 s44, 0x21a0000
    buffer_load_dwordx4 v[96:99], v1, s[20:23], s44 offen offset:0 nt
    ds_read_b32 v2, v15 offset:31272
    s_waitcnt lgkmcnt(5)
    v_mfma_f32_16x16x32_bf16 v[80:83], v[192:195], v[176:179], v[80:83]
    s_waitcnt lgkmcnt(4)
    v_mfma_f32_16x16x32_bf16 v[84:87], v[196:199], v[176:179], v[84:87]
    s_waitcnt lgkmcnt(3)
    v_mfma_f32_16x16x32_bf16 v[88:91], v[200:203], v[176:179], v[88:91]
    s_waitcnt lgkmcnt(2)
    v_mfma_f32_16x16x32_bf16 v[92:95], v[204:207], v[176:179], v[92:95]
    v_mfma_f32_16x16x32_bf16 v[64:67], v[192:195], v[144:147], v[64:67]
    v_mfma_f32_16x16x32_bf16 v[68:71], v[196:199], v[144:147], v[68:71]
    v_mfma_f32_16x16x32_bf16 v[72:75], v[200:203], v[144:147], v[72:75]
    v_mfma_f32_16x16x32_bf16 v[76:79], v[204:207], v[144:147], v[76:79]
    s_waitcnt vmcnt(6)
    v_dot2_f32_bf16 v34, v100, v20, 0
    v_dot2_f32_bf16 v34, v101, v21, v34
    v_dot2_f32_bf16 v34, v102, v22, v34
    v_dot2_f32_bf16 v34, v103, v23, v34
    s_cbranch_vccnz L_is121
    s_waitcnt vmcnt(5)
    s_cbranch_scc0 L_is121
    s_waitcnt vmcnt(4)
L_is121:
    buffer_load_dwordx4 v[100:103], v1, s[20:23], s44 offen offset:256 nt
    v_cvt_pk_bf16_f32 v184, v32, v33
    ds_read_b128 v[192:195], v209 offset:16384
    ds_read_b128 v[196:199], v209 offset:20480
    ds_read_b128 v[200:203], v209 offset:24576
    ds_read_b128 v[204:207], v209 offset:28672
    s_waitcnt vmcnt(6)
    v_dot2_f32_bf16 v35, v104, v20, 0
    v_dot2_f32_bf16 v35, v105, v21, v35
    v_dot2_f32_bf16 v35, v106, v22, v35
    v_dot2_f32_bf16 v35, v107, v23, v35
    s_cbranch_vccnz L_is122
    s_waitcnt vmcnt(5)
    s_cbranch_scc0 L_is122
    s_waitcnt vmcnt(4)
L_is122:
    buffer_load_dwordx4 v[104:107], v1, s[20:23], s44 offen offset:512 nt
    s_waitcnt lgkmcnt(4)
    v_readfirstlane_b32 s55, v2
    s_nop 1
    s_cmp_ge_u32 s55, 0x1e00
    s_cselect_b32 s55, s55, 0
    s_bitcmp1_b32 s55, 1
    s_cselect_b64 vcc, -1, 0
    s_bitcmp1_b32 s55, 0
    s_waitcnt vmcnt(6)
    v_dot2_f32_bf16 v36, v108, v20, 0
    v_dot2_f32_bf16 v36, v109, v21, v36
    v_dot2_f32_bf16 v36, v110, v22, v36
    v_dot2_f32_bf16 v36, v111, v23, v36
    s_cbranch_vccnz L_is123
    s_waitcnt vmcnt(5)
    s_cbranch_scc0 L_is123
    s_waitcnt vmcnt(4)
L_is123:
    buffer_load_dwordx4 v[108:111], v1, s[20:23], s44 offen offset:768 nt
    v_mov_b32 v3, 29
    ds_write_b32 v9, v3 offset:31268
    v_cvt_pk_bf16_f32 v185, v34, v35
    s_waitcnt vmcnt(6)
    v_dot2_f32_bf16 v37, v120, v20, 0
    v_dot2_f32_bf16 v37, v121, v21, v37
    v_dot2_f32_bf16 v37, v122, v22, v37
    v_dot2_f32_bf16 v37, v123, v23, v37
    s_cbranch_vccnz L_is124
    s_waitcnt vmcnt(5)
    s_cbranch_scc0 L_is124
    s_waitcnt vmcnt(4)
L_is124:
    buffer_load_dwordx4 v[120:123], v1, s[20:23], s44 offen offset:1024 nt
    ds_read_b32 v2, v15 offset:31272
    s_waitcnt lgkmcnt(5)
    v_mfma_f32_16x16x32_bf16 v[80:83], v[192:195], v[180:183], v[80:83]
    s_waitcnt lgkmcnt(4)
    v_mfma_f32_16x16x32_bf16 v[84:87], v[196:199], v[180:183], v[84:87]
    s_waitcnt lgkmcnt(3)
    v_mfma_f32_16x16x32_bf16 v[88:91], v[200:203], v[180:183], v[88:91]
    s_waitcnt lgkmcnt(2)
    v_mfma_f32_16x16x32_bf16 v[92:95], v[204:207], v[180:183], v[92:95]
    v_mfma_f32_16x16x32_bf16 v[64:67], v[192:195], v[148:151], v[64:67]
    v_mfma_f32_16x16x32_bf16 v[68:71], v[196:199], v[148:151], v[68:71]
    v_mfma_f32_16x16x32_bf16 v[72:75], v[200:203], v[148:151], v[72:75]
    v_mfma_f32_16x16x32_bf16 v[76:79], v[204:207], v[148:151], v[76:79]
    s_waitcnt vmcnt(6)
    v_dot2_f32_bf16 v38, v112, v20, 0
    v_dot2_f32_bf16 v38, v113, v21, v38
    v_dot2_f32_bf16 v38, v114, v22, v38
    v_dot2_f32_bf16 v38, v115, v23, v38
    s_cbranch_vccnz L_is125
    s_waitcnt vmcnt(5)
    s_cbranch_scc0 L_is125
    s_waitcnt vmcnt(4)
L_is125:
    buffer_load_dwordx4 v[112:115], v1, s[20:23], s44 offen offset:1280 nt
    v_cvt_pk_bf16_f32 v186, v36, v37
    ds_read_b128 v[192:195], v209 offset:32768
    ds_read_b128 v[196:199], v209 offset:36864
    ds_read_b128 v[200:203], v209 offset:40960
    ds_read_b128 v[204:207], v209 offset:45056
    s_waitcnt vmcnt(6)
    v_dot2_f32_bf16 v39, v116, v20, 0
    v_dot2_f32_bf16 v39, v117, v21, v39
    v_dot2_f32_bf16 v39, v118, v22, v39
    v_dot2_f32_bf16 v39, v119, v23, v39
    s_cbranch_vccnz L_is126
    s_waitcnt vmcnt(5)
    s_cbranch_scc0 L_is126
    s_waitcnt vmcnt(4)
L_is126:
    buffer_load_dwordx4 v[116:119], v1, s[20:23], s44 offen offset:1536 nt
    s_waitcnt lgkmcnt(4)
    v_readfirstlane_b32 s55, v2
    s_nop 1
    s_cmp_ge_u32 s55, 0x1f00
    s_cselect_b32 s55, s55, 0
    s_bitcmp1_b32 s55, 1
    s_cselect_b64 vcc, -1, 0
    s_bitcmp1_b32 s55, 0
    s_waitcnt vmcnt(6)
    v_dot2_f32_bf16 v32, v96, v20, 0
    v_dot2_f32_bf16 v32, v97, v21, v32
    v_dot2_f32_bf16 v32, v98, v22, v32
    v_dot2_f32_bf16 v32, v99, v23, v32
    s_cbranch_vccnz L_is127
    s_waitcnt vmcnt(5)
    s_cbranch_scc0 L_is127
    s_waitcnt vmcnt(4)
L_is127:
    buffer_load_dwordx4 v[96:99], v1, s[20:23], s44 offen offset:1792 nt
    v_mov_b32 v3, 30
    ds_write_b32 v9, v3 offset:31268
    v_cvt_pk_bf16_f32 v187, v38, v39
    s_waitcnt vmcnt(6)
    v_dot2_f32_bf16 v33, v100, v20, 0
    v_dot2_f32_bf16 v33, v101, v21, v33
    v_dot2_f32_bf16 v33, v102, v22, v33
    v_dot2_f32_bf16 v33, v103, v23, v33
    s_cbranch_vccnz L_is128
    s_waitcnt vmcnt(5)
    s_cbranch_scc0 L_is128
    s_waitcnt vmcnt(4)
L_is128:
    s_mov_b32 s44, 0x8000000
    buffer_load_dwordx4 v[100:103], v1, s[20:23], s44 offen offset:0 nt
    ds_read_b32 v2, v15 offset:31272
    s_waitcnt lgkmcnt(5)
    v_mfma_f32_16x16x32_bf16 v[80:83], v[192:195], v[184:187], v[80:83]
    s_waitcnt lgkmcnt(4)
    v_mfma_f32_16x16x32_bf16 v[84:87], v[196:199], v[184:187], v[84:87]
    s_waitcnt lgkmcnt(3)
    v_mfma_f32_16x16x32_bf16 v[88:91], v[200:203], v[184:187], v[88:91]
    s_waitcnt lgkmcnt(2)
    v_mfma_f32_16x16x32_bf16 v[92:95], v[204:207], v[184:187], v[92:95]
    v_mfma_f32_16x16x32_bf16 v[64:67], v[192:195], v[152:155], v[64:67]
    v_mfma_f32_16x16x32_bf16 v[68:71], v[196:199], v[152:155], v[68:71]
    v_mfma_f32_16x16x32_bf16 v[72:75], v[200:203], v[152:155], v[72:75]
    v_mfma_f32_16x16x32_bf16 v[76:79], v[204:207], v[152:155], v[76:79]
    s_waitcnt vmcnt(6)
    v_dot2_f32_bf16 v34, v104, v20, 0
    v_dot2_f32_bf16 v34, v105, v21, v34
    v_dot2_f32_bf16 v34, v106, v22, v34
    v_dot2_f32_bf16 v34, v107, v23, v34
    s_cbranch_vccnz L_is129
    s_waitcnt vmcnt(5)
    s_cbranch_scc0 L_is129
    s_waitcnt vmcnt(4)
L_is129:
    buffer_load_dwordx4 v[104:107], v1, s[20:23], s44 offen offset:256 nt
    v_cvt_pk_bf16_f32 v188, v32, v33
    ds_read_b128 v[192:195], v209 offset:49152
    ds_read_b128 v[196:199], v209 offset:53248
    ds_read_b128 v[200:203], v209 offset:57344
    ds_read_b128 v[204:207], v209 offset:61440
    s_waitcnt vmcnt(6)
    v_dot2_f32_bf16 v35, v108, v20, 0
    v_dot2_f32_bf16 v35, v109, v21, v35
    v_dot2_f32_bf16 v35, v110, v22, v35
    v_dot2_f32_bf16 v35, v111, v23, v35
    s_cbranch_vccnz L_is130
    s_waitcnt vmcnt(5)
    s_cbranch_scc0 L_is130
    s_waitcnt vmcnt(4)
L_is130:
    buffer_load_dwordx4 v[108:111], v1, s[20:23], s44 offen offset:512 nt
    s_waitcnt lgkmcnt(4)
    v_readfirstlane_b32 s55, v2
    s_nop 1
    s_cmp_ge_u32 s55, 0x2000
    s_cselect_b32 s55, s55, 0
    s_bitcmp1_b32 s55, 1
    s_cselect_b64 vcc, -1, 0
    s_bitcmp1_b32 s55, 0
    s_waitcnt vmcnt(6)
    v_dot2_f32_bf16 v36, v120, v20, 0
    v_dot2_f32_bf16 v36, v121, v21, v36
    v_dot2_f32_bf16 v36, v122, v22, v36
    v_dot2_f32_bf16 v36, v123, v23, v36
    s_cbranch_vccnz L_is131
    s_waitcnt vmcnt(5)
    s_cbranch_scc0 L_is131
    s_waitcnt vmcnt(4)
L_is131:
    buffer_load_dwordx4 v[120:123], v1, s[20:23], s44 offen offset:768 nt
    v_mov_b32 v3, 31
    ds_write_b32 v9, v3 offset:31268
    v_cvt_pk_bf16_f32 v189, v34, v35
    s_waitcnt vmcnt(6)
    v_dot2_f32_bf16 v37, v112, v20, 0
    v_dot2_f32_bf16 v37, v113, v21, v37
    v_dot2_f32_bf16 v37, v114, v22, v37
    v_dot2_f32_bf16 v37, v115, v23, v37
    s_cbranch_vccnz L_is132
    s_waitcnt vmcnt(5)
    s_cbranch_scc0 L_is132
    s_waitcnt vmcnt(4)
L_is132:
    buffer_load_dwordx4 v[112:115], v1, s[20:23], s44 offen offset:1024 nt
    ds_read_b32 v2, v15 offset:31272
    s_waitcnt vmcnt(6)
    v_dot2_f32_bf16 v38, v116, v20, 0
    v_dot2_f32_bf16 v38, v117, v21, v38
    v_dot2_f32_bf16 v38, v118, v22, v38
    v_dot2_f32_bf16 v38, v119, v23, v38
    s_cbranch_vccnz L_is133
    s_waitcnt vmcnt(5)
    s_cbranch_scc0 L_is133
    s_waitcnt vmcnt(4)
L_is133:
    buffer_load_dwordx4 v[116:119], v1, s[20:23], s44 offen offset:1280 nt
    v_cvt_pk_bf16_f32 v190, v36, v37
    s_waitcnt vmcnt(6)
    v_dot2_f32_bf16 v39, v96, v20, 0
    v_dot2_f32_bf16 v39, v97, v21, v39
    v_dot2_f32_bf16 v39, v98, v22, v39
    v_dot2_f32_bf16 v39, v99, v23, v39
    s_cbranch_vccnz L_is134
    s_waitcnt vmcnt(5)
    s_cbranch_scc0 L_is134
    s_waitcnt vmcnt(4)
L_is134:
    buffer_load_dwordx4 v[96:99], v1, s[20:23], s44 offen offset:1536 nt
    s_waitcnt lgkmcnt(0)
    v_readfirstlane_b32 s55, v2
    s_nop 1
    s_cmp_ge_u32 s55, 0x2100
    s_cselect_b32 s55, s55, 0
    s_bitcmp1_b32 s55, 1
    s_cselect_b64 vcc, -1, 0
    s_bitcmp1_b32 s55, 0
    s_waitcnt vmcnt(6)
    v_dot2_f32_bf16 v32, v100, v24, 0
    v_dot2_f32_bf16 v32, v101, v25, v32
    v_dot2_f32_bf16 v32, v102, v26, v32
    v_dot2_f32_bf16 v32, v103, v27, v32
    s_cbranch_vccnz L_is135
    s_waitcnt vmcnt(5)
    s_cbranch_scc0 L_is135
    s_waitcnt vmcnt(4)
L_is135:
    buffer_load_dwordx4 v[100:103], v1, s[20:23], s44 offen offset:1792 nt
    v_mov_b32 v3, 32
    ds_write_b32 v9, v3 offset:31268
    v_cvt_pk_bf16_f32 v191, v38, v39
    s_waitcnt vmcnt(6)
    v_dot2_f32_bf16 v33, v104, v24, 0
    v_dot2_f32_bf16 v33, v105, v25, v33
    v_dot2_f32_bf16 v33, v106, v26, v33
    v_dot2_f32_bf16 v33, v107, v27, v33
    s_cbranch_vccnz L_is136
    s_waitcnt vmcnt(5)
    s_cbranch_scc0 L_is136
    s_waitcnt vmcnt(4)
L_is136:
    s_mov_b32 s44, 0x8020000
    buffer_load_dwordx4 v[104:107], v1, s[20:23], s44 offen offset:0 nt
    ds_read_b32 v2, v15 offset:31272
    v_mfma_f32_16x16x32_bf16 v[80:83], v[192:195], v[188:191], v[80:83]
    v_mfma_f32_16x16x32_bf16 v[84:87], v[196:199], v[188:191], v[84:87]
    v_mfma_f32_16x16x32_bf16 v[88:91], v[200:203], v[188:191], v[88:91]
    v_mfma_f32_16x16x32_bf16 v[92:95], v[204:207], v[188:191], v[92:95]
    v_mfma_f32_16x16x32_bf16 v[64:67], v[192:195], v[156:159], v[64:67]
    v_mfma_f32_16x16x32_bf16 v[68:71], v[196:199], v[156:159], v[68:71]
    v_mfma_f32_16x16x32_bf16 v[72:75], v[200:203], v[156:159], v[72:75]
    v_mfma_f32_16x16x32_bf16 v[76:79], v[204:207], v[156:159], v[76:79]
    s_waitcnt vmcnt(6)
    v_dot2_f32_bf16 v34, v108, v24, 0
    v_dot2_f32_bf16 v34, v109, v25, v34
    v_dot2_f32_bf16 v34, v110, v26, v34
    v_dot2_f32_bf16 v34, v111, v27, v34
    s_cbranch_vccnz L_is137
    s_waitcnt vmcnt(5)
    s_cbranch_scc0 L_is137
    s_waitcnt vmcnt(4)
L_is137:
    buffer_load_dwordx4 v[108:111], v1, s[20:23], s44 offen offset:256 nt
    v_cvt_pk_bf16_f32 v40, v32, v33
    v_add_f32_dpp v64, v64, v64 row_ror:8 row_mask:0xf bank_mask:0x3
    v_add_f32_dpp v65, v65, v65 row_ror:8 row_mask:0xf bank_mask:0x3
    v_add_f32_dpp v66, v66, v66 row_ror:8 row_mask:0xf bank_mask:0x3
    v_add_f32_dpp v67, v67, v67 row_ror:8 row_mask:0xf bank_mask:0x3
    v_add_f32_dpp v68, v68, v68 row_ror:8 row_mask:0xf bank_mask:0x3
    v_add_f32_dpp v69, v69, v69 row_ror:8 row_mask:0xf bank_mask:0x3
    v_add_f32_dpp v70, v70, v70 row_ror:8 row_mask:0xf bank_mask:0x3
    v_add_f32_dpp v71, v71, v71 row_ror:8 row_mask:0xf bank_mask:0x3
    s_waitcnt vmcnt(6)
    v_dot2_f32_bf16 v35, v120, v24, 0
    v_dot2_f32_bf16 v35, v121, v25, v35
    v_dot2_f32_bf16 v35, v122, v26, v35
    v_dot2_f32_bf16 v35, v123, v27, v35
    s_cbranch_vccnz L_is138
    s_waitcnt vmcnt(5)
    s_cbranch_scc0 L_is138
    s_waitcnt vmcnt(4)
L_is138:
    buffer_load_dwordx4 v[120:123], v1, s[20:23], s44 offen offset:512 nt
    s_waitcnt lgkmcnt(0)
    v_readfirstlane_b32 s55, v2
    s_nop 1
    s_cmp_ge_u32 s55, 0x2200
    s_cselect_b32 s55, s55, 0
    s_bitcmp1_b32 s55, 1
    s_cselect_b64 vcc, -1, 0
    s_bitcmp1_b32 s55, 0
    v_add_f32_dpp v64, v72, v72 row_ror:8 row_mask:0xf bank_mask:0xc
    v_add_f32_dpp v65, v73, v73 row_ror:8 row_mask:0xf bank_mask:0xc
    v_add_f32_dpp v66, v74, v74 row_ror:8 row_mask:0xf bank_mask:0xc
    v_add_f32_dpp v67, v75, v75 row_ror:8 row_mask:0xf bank_mask:0xc
    v_add_f32_dpp v68, v76, v76 row_ror:8 row_mask:0xf bank_mask:0xc
    v_add_f32_dpp v69, v77, v77 row_ror:8 row_mask:0xf bank_mask:0xc
    v_add_f32_dpp v70, v78, v78 row_ror:8 row_mask:0xf bank_mask:0xc
    v_add_f32_dpp v71, v79, v79 row_ror:8 row_mask:0xf bank_mask:0xc
    s_waitcnt vmcnt(6)
    v_dot2_f32_bf16 v36, v112, v24, 0
    v_dot2_f32_bf16 v36, v113, v25, v36
    v_dot2_f32_bf16 v36, v114, v26, v36
    v_dot2_f32_bf16 v36, v115, v27, v36
    s_cbranch_vccnz L_is139
    s_waitcnt vmcnt(5)
    s_cbranch_scc0 L_is139
    s_waitcnt vmcnt(4)
L_is139:
    buffer_load_dwordx4 v[112:115], v1, s[20:23], s44 offen offset:768 nt
    v_mov_b32 v3, 33
    ds_write_b32 v9, v3 offset:31268
    v_cvt_pk_bf16_f32 v41, v34, v35
    v_add_f32_dpp v64, v64, v64 row_shl:4 row_mask:0xf bank_mask:0x5
    v_add_f32_dpp v65, v65, v65 row_shl:4 row_mask:0xf bank_mask:0x5
    v_add_f32_dpp v66, v66, v66 row_shl:4 row_mask:0xf bank_mask:0x5
    v_add_f32_dpp v67, v67, v67 row_shl:4 row_mask:0xf bank_mask:0x5
    v_add_f32_dpp v64, v68, v68 row_shr:4 row_mask:0xf bank_mask:0xa
    v_add_f32_dpp v65, v69, v69 row_shr:4 row_mask:0xf bank_mask:0xa
    v_add_f32_dpp v66, v70, v70 row_shr:4 row_mask:0xf bank_mask:0xa
    v_add_f32_dpp v67, v71, v71 row_shr:4 row_mask:0xf bank_mask:0xa
    s_waitcnt vmcnt(6)
    v_dot2_f32_bf16 v37, v116, v24, 0
    v_dot2_f32_bf16 v37, v117, v25, v37
    v_dot2_f32_bf16 v37, v118, v26, v37
    v_dot2_f32_bf16 v37, v119, v27, v37
    s_cbranch_vccnz L_is140
    s_waitcnt vmcnt(5)
    s_cbranch_scc0 L_is140
    s_waitcnt vmcnt(4)
L_is140:
    buffer_load_dwordx4 v[116:119], v1, s[20:23], s44 offen offset:1024 nt
    ds_read_b32 v2, v15 offset:31272
    v_add_f32_dpp v64, v64, v64 quad_perm:[2,3,0,1] row_mask:0xf bank_mask:0xf
    v_add_f32_dpp v65, v65, v65 quad_perm:[2,3,0,1] row_mask:0xf bank_mask:0xf
    v_add_f32_dpp v66, v66, v66 quad_perm:[2,3,0,1] row_mask:0xf bank_mask:0xf
    v_add_f32_dpp v67, v67, v67 quad_perm:[2,3,0,1] row_mask:0xf bank_mask:0xf
    v_cndmask_b32 v64, v64, v66, s[48:49]
    v_cndmask_b32 v65, v65, v67, s[48:49]
    s_nop 0
    v_add_f32_dpp v64, v64, v64 quad_perm:[1,0,3,2] row_mask:0xf bank_mask:0xf
    v_add_f32_dpp v65, v65, v65 quad_perm:[1,0,3,2] row_mask:0xf bank_mask:0xf
    s_waitcnt vmcnt(6)
    v_dot2_f32_bf16 v38, v96, v24, 0
    v_dot2_f32_bf16 v38, v97, v25, v38
    v_dot2_f32_bf16 v38, v98, v26, v38
    v_dot2_f32_bf16 v38, v99, v27, v38
    s_cbranch_vccnz L_is141
    s_waitcnt vmcnt(5)
    s_cbranch_scc0 L_is141
    s_waitcnt vmcnt(4)
L_is141:
    buffer_load_dwordx4 v[96:99], v1, s[20:23], s44 offen offset:1280 nt
    v_cvt_pk_bf16_f32 v42, v36, v37
    ds_read_b128 v[192:195], v208 offset:0
    ds_read_b128 v[196:199], v208 offset:4096
    ds_read_b128 v[200:203], v208 offset:8192
    ds_read_b128 v[204:207], v208 offset:12288
    v_cndmask_b32 v64, v64, v65, s[50:51]
    v_min_u32 v64, -2, v64
    ds_write_b32 v6, v64 offset:0
    v_add_f32_dpp v80, v80, v80 row_ror:8 row_mask:0xf bank_mask:0x3
    v_add_f32_dpp v81, v81, v81 row_ror:8 row_mask:0xf bank_mask:0x3
    v_add_f32_dpp v82, v82, v82 row_ror:8 row_mask:0xf bank_mask:0x3
    v_add_f32_dpp v83, v83, v83 row_ror:8 row_mask:0xf bank_mask:0x3
    v_add_f32_dpp v84, v84, v84 row_ror:8 row_mask:0xf bank_mask:0x3
    s_waitcnt vmcnt(6)
    v_dot2_f32_bf16 v39, v100, v24, 0
    v_dot2_f32_bf16 v39, v101, v25, v39
    v_dot2_f32_bf16 v39, v102, v26, v39
    v_dot2_f32_bf16 v39, v103, v27, v39
    s_cbranch_vccnz L_is142
    s_waitcnt vmcnt(5)
    s_cbranch_scc0 L_is142
    s_waitcnt vmcnt(4)
L_is142:
    buffer_load_dwordx4 v[100:103], v1, s[20:23], s44 offen offset:1536 nt
    s_waitcnt lgkmcnt(5)
    v_readfirstlane_b32 s55, v2
    s_nop 1
    s_cmp_ge_u32 s55, 0x2300
    s_cselect_b32 s55, s55, 0
    s_bitcmp1_b32 s55, 1
    s_cselect_b64 vcc, -1, 0
    s_bitcmp1_b32 s55, 0
    v_add_f32_dpp v85, v85, v85 row_ror:8 row_mask:0xf bank_mask:0x3
    v_add_f32_dpp v86, v86, v86 row_ror:8 row_mask:0xf bank_mask:0x3
    v_add_f32_dpp v87, v87, v87 row_ror:8 row_mask:0xf bank_mask:0x3
    v_add_f32_dpp v80, v88, v88 row_ror:8 row_mask:0xf bank_mask:0xc
    v_add_f32_dpp v81, v89, v89 row_ror:8 row_mask:0xf bank_mask:0xc
    v_add_f32_dpp v82, v90, v90 row_ror:8 row_mask:0xf bank_mask:0xc
    v_add_f32_dpp v83, v91, v91 row_ror:8 row_mask:0xf bank_mask:0xc
    v_add_f32_dpp v84, v92, v92 row_ror:8 row_mask:0xf bank_mask:0xc
    s_waitcnt vmcnt(6)
    v_dot2_f32_bf16 v32, v104, v24, 0
    v_dot2_f32_bf16 v32, v105, v25, v32
    v_dot2_f32_bf16 v32, v106, v26, v32
    v_dot2_f32_bf16 v32, v107, v27, v32
    s_cbranch_vccnz L_is143
    s_waitcnt vmcnt(5)
    s_cbranch_scc0 L_is143
    s_waitcnt vmcnt(4)
L_is143:
    buffer_load_dwordx4 v[104:107], v1, s[20:23], s44 offen offset:1792 nt
    v_mov_b32 v3, 34
    ds_write_b32 v9, v3 offset:31268
    v_cvt_pk_bf16_f32 v43, v38, v39
    v_add_f32_dpp v85, v93, v93 row_ror:8 row_mask:0xf bank_mask:0xc
    v_add_f32_dpp v86, v94, v94 row_ror:8 row_mask:0xf bank_mask:0xc
    v_add_f32_dpp v87, v95, v95 row_ror:8 row_mask:0xf bank_mask:0xc
    v_add_f32_dpp v80, v80, v80 row_shl:4 row_mask:0xf bank_mask:0x5
    v_add_f32_dpp v81, v81, v81 row_shl:4 row_mask:0xf bank_mask:0x5
    v_add_f32_dpp v82, v82, v82 row_shl:4 row_mask:0xf bank_mask:0x5
    v_add_f32_dpp v83, v83, v83 row_shl:4 row_mask:0xf bank_mask:0x5
    v_add_f32_dpp v80, v84, v84 row_shr:4 row_mask:0xf bank_mask:0xa
    s_waitcnt vmcnt(6)
    v_dot2_f32_bf16 v33, v108, v24, 0
    v_dot2_f32_bf16 v33, v109, v25, v33
    v_dot2_f32_bf16 v33, v110, v26, v33
    v_dot2_f32_bf16 v33, v111, v27, v33
    s_cbranch_vccnz L_is144
    s_waitcnt vmcnt(5)
    s_cbranch_scc0 L_is144
    s_waitcnt vmcnt(4)
L_is144:
    s_mov_b32 s44, 0x8080000
    buffer_load_dwordx4 v[108:111], v1, s[20:23], s44 offen offset:0 nt
    ds_read_b32 v2, v15 offset:31272
    s_waitcnt lgkmcnt(6)
    v_mfma_f32_16x16x32_bf16 v[64:67], v[192:195], v[40:43], 0
    s_waitcnt lgkmcnt(5)
    v_mfma_f32_16x16x32_bf16 v[68:71], v[196:199], v[40:43], 0
    s_waitcnt lgkmcnt(4)
    v_mfma_f32_16x16x32_bf16 v[72:75], v[200:203], v[40:43], 0
    s_waitcnt lgkmcnt(3)
    v_mfma_f32_16x16x32_bf16 v[76:79], v[204:207], v[40:43], 0
    v_add_f32_dpp v81, v85, v85 row_shr:4 row_mask:0xf bank_mask:0xa
    v_add_f32_dpp v82, v86, v86 row_shr:4 row_mask:0xf bank_mask:0xa
    v_add_f32_dpp v83, v87, v87 row_shr:4 row_mask:0xf bank_mask:0xa
    v_add_f32_dpp v80, v80, v80 quad_perm:[2,3,0,1] row_mask:0xf bank_mask:0xf
    v_add_f32_dpp v81, v81, v81 quad_perm:[2,3,0,1] row_mask:0xf bank_mask:0xf
    v_add_f32_dpp v82, v82, v82 quad_perm:[2,3,0,1] row_mask:0xf bank_mask:0xf
    v_add_f32_dpp v83, v83, v83 quad_perm:[2,3,0,1] row_mask:0xf bank_mask:0xf
    v_cndmask_b32 v80, v80, v82, s[48:49]
    s_waitcnt vmcnt(6)
    v_dot2_f32_bf16 v34, v120, v24, 0
    v_dot2_f32_bf16 v34, v121, v25, v34
    v_dot2_f32_bf16 v34, v122, v26, v34
    v_dot2_f32_bf16 v34, v123, v27, v34
    s_cbranch_vccnz L_is145
    s_waitcnt vmcnt(5)
    s_cbranch_scc0 L_is145
    s_waitcnt vmcnt(4)
L_is145:
    buffer_load_dwordx4 v[120:123], v1, s[20:23], s44 offen offset:256 nt
    v_cvt_pk_bf16_f32 v40, v32, v33
    v_cndmask_b32 v81, v81, v83, s[48:49]
    v_add_f32_dpp v80, v80, v80 quad_perm:[1,0,3,2] row_mask:0xf bank_mask:0xf
    s_nop 0
    v_add_f32_dpp v81, v81, v81 quad_perm:[1,0,3,2] row_mask:0xf bank_mask:0xf
    v_cndmask_b32 v80, v80, v81, s[50:51]
    v_min_u32 v80, -2, v80
    ds_write_b32 v6, v80 offset:256
    s_waitcnt vmcnt(6)
    v_dot2_f32_bf16 v35, v112, v24, 0
    v_dot2_f32_bf16 v35, v113, v25, v35
    v_dot2_f32_bf16 v35, v114, v26, v35
    v_dot2_f32_bf16 v35, v115, v27, v35
    s_cbranch_vccnz L_is146
    s_waitcnt vmcnt(5)
    s_cbranch_scc0 L_is146
    s_waitcnt vmcnt(4)
L_is146:
    buffer_load_dwordx4 v[112:115], v1, s[20:23], s44 offen offset:512 nt
    s_waitcnt lgkmcnt(1)
    v_readfirstlane_b32 s55, v2
    s_nop 1
    s_cmp_ge_u32 s55, 0x2400
    s_cselect_b32 s55, s55, 0
    s_bitcmp1_b32 s55, 1
    s_cselect_b64 vcc, -1, 0
    s_bitcmp1_b32 s55, 0
    s_waitcnt vmcnt(6)
    v_dot2_f32_bf16 v36, v116, v24, 0
    v_dot2_f32_bf16 v36, v117, v25, v36
    v_dot2_f32_bf16 v36, v118, v26, v36
    v_dot2_f32_bf16 v36, v119, v27, v36
    s_cbranch_vccnz L_is147
    s_waitcnt vmcnt(5)
    s_cbranch_scc0 L_is147
    s_waitcnt vmcnt(4)
L_is147:
    buffer_load_dwordx4 v[116:119], v1, s[20:23], s44 offen offset:768 nt
    v_mov_b32 v3, 35
    ds_write_b32 v9, v3 offset:31268
    v_cvt_pk_bf16_f32 v41, v34, v35
    s_waitcnt vmcnt(6)
    v_dot2_f32_bf16 v37, v96, v24, 0
    v_dot2_f32_bf16 v37, v97, v25, v37
    v_dot2_f32_bf16 v37, v98, v26, v37
    v_dot2_f32_bf16 v37, v99, v27, v37
    s_cbranch_vccnz L_is148
    s_waitcnt vmcnt(5)
    s_cbranch_scc0 L_is148
    s_waitcnt vmcnt(4)
L_is148:
    buffer_load_dwordx4 v[96:99], v1, s[20:23], s44 offen offset:1024 nt
    ds_read_b32 v2, v15 offset:31272
    s_waitcnt vmcnt(6)
    v_dot2_f32_bf16 v38, v100, v24, 0
    v_dot2_f32_bf16 v38, v101, v25, v38
    v_dot2_f32_bf16 v38, v102, v26, v38
    v_dot2_f32_bf16 v38, v103, v27, v38
    s_cbranch_vccnz L_is149
    s_waitcnt vmcnt(5)
    s_cbranch_scc0 L_is149
    s_waitcnt vmcnt(4)
L_is149:
    buffer_load_dwordx4 v[100:103], v1, s[20:23], s44 offen offset:1280 nt
    v_cvt_pk_bf16_f32 v42, v36, v37
    ds_read_b128 v[192:195], v208 offset:16384
    ds_read_b128 v[196:199], v208 offset:20480
    ds_read_b128 v[200:203], v208 offset:24576
    ds_read_b128 v[204:207], v208 offset:28672
    s_waitcnt vmcnt(6)
    v_dot2_f32_bf16 v39, v104, v24, 0
    v_dot2_f32_bf16 v39, v105, v25, v39
    v_dot2_f32_bf16 v39, v106, v26, v39
    v_dot2_f32_bf16 v39, v107, v27, v39
    s_cbranch_vccnz L_is150
    s_waitcnt vmcnt(5)
    s_cbranch_scc0 L_is150
    s_waitcnt vmcnt(4)
L_is150:
    buffer_load_dwordx4 v[104:107], v1, s[20:23], s44 offen offset:1536 nt
    s_waitcnt lgkmcnt(4)
    v_readfirstlane_b32 s55, v2
    s_nop 1
    s_cmp_ge_u32 s55, 0x2500
    s_cselect_b32 s55, s55, 0
    s_bitcmp1_b32 s55, 1
    s_cselect_b64 vcc, -1, 0
    s_bitcmp1_b32 s55, 0
    s_waitcnt vmcnt(6)
    v_dot2_f32_bf16 v32, v108, v24, 0
    v_dot2_f32_bf16 v32, v109, v25, v32
    v_dot2_f32_bf16 v32, v110, v26, v32
    v_dot2_f32_bf16 v32, v111, v27, v32
    s_cbranch_vccnz L_is151
    s_waitcnt vmcnt(5)
    s_cbranch_scc0 L_is151
    s_waitcnt vmcnt(4)
L_is151:
    buffer_load_dwordx4 v[108:111], v1, s[20:23], s44 offen offset:1792 nt
    v_mov_b32 v3, 36
    ds_write_b32 v9, v3 offset:31268
    v_cvt_pk_bf16_f32 v43, v38, v39
    s_waitcnt vmcnt(6)
    v_dot2_f32_bf16 v33, v120, v24, 0
    v_dot2_f32_bf16 v33, v121, v25, v33
    v_dot2_f32_bf16 v33, v122, v26, v33
    v_dot2_f32_bf16 v33, v123, v27, v33
    s_cbranch_vccnz L_is152
    s_waitcnt vmcnt(5)
    s_cbranch_scc0 L_is152
    s_waitcnt vmcnt(4)
L_is152:
    s_mov_b32 s44, 0x80a0000
    buffer_load_dwordx4 v[120:123], v1, s[20:23], s44 offen offset:0 nt
    ds_read_b32 v2, v15 offset:31272
    s_waitcnt lgkmcnt(5)
    v_mfma_f32_16x16x32_bf16 v[64:67], v[192:195], v[40:43], v[64:67]
    s_waitcnt lgkmcnt(4)
    v_mfma_f32_16x16x32_bf16 v[68:71], v[196:199], v[40:43], v[68:71]
    s_waitcnt lgkmcnt(3)
    v_mfma_f32_16x16x32_bf16 v[72:75], v[200:203], v[40:43], v[72:75]
    s_waitcnt lgkmcnt(2)
    v_mfma_f32_16x16x32_bf16 v[76:79], v[204:207], v[40:43], v[76:79]
    s_waitcnt vmcnt(6)
    v_dot2_f32_bf16 v34, v112, v24, 0
    v_dot2_f32_bf16 v34, v113, v25, v34
    v_dot2_f32_bf16 v34, v114, v26, v34
    v_dot2_f32_bf16 v34, v115, v27, v34
    s_cbranch_vccnz L_is153
    s_waitcnt vmcnt(5)
    s_cbranch_scc0 L_is153
    s_waitcnt vmcnt(4)
L_is153:
    buffer_load_dwordx4 v[112:115], v1, s[20:23], s44 offen offset:256 nt
    v_cvt_pk_bf16_f32 v40, v32, v33
    s_waitcnt vmcnt(6)
    v_dot2_f32_bf16 v35, v116, v24, 0
    v_dot2_f32_bf16 v35, v117, v25, v35
    v_dot2_f32_bf16 v35, v118, v26, v35
    v_dot2_f32_bf16 v35, v119, v27, v35
    s_cbranch_vccnz L_is154
    s_waitcnt vmcnt(5)
    s_cbranch_scc0 L_is154
    s_waitcnt vmcnt(4)
L_is154:
    buffer_load_dwordx4 v[116:119], v1, s[20:23], s44 offen offset:512 nt
    s_waitcnt lgkmcnt(0)
    v_readfirstlane_b32 s55, v2
    s_nop 1
    s_cmp_ge_u32 s55, 0x2600
    s_cselect_b32 s55, s55, 0
    s_bitcmp1_b32 s55, 1
    s_cselect_b64 vcc, -1, 0
    s_bitcmp1_b32 s55, 0
    s_waitcnt vmcnt(6)
    v_dot2_f32_bf16 v36, v96, v24, 0
    v_dot2_f32_bf16 v36, v97, v25, v36
    v_dot2_f32_bf16 v36, v98, v26, v36
    v_dot2_f32_bf16 v36, v99, v27, v36
    s_cbranch_vccnz L_is155
    s_waitcnt vmcnt(5)
    s_cbranch_scc0 L_is155
    s_waitcnt vmcnt(4)
L_is155:
    buffer_load_dwordx4 v[96:99], v1, s[20:23], s44 offen offset:768 nt
    v_mov_b32 v3, 37
    ds_write_b32 v9, v3 offset:31268
    v_cvt_pk_bf16_f32 v41, v34, v35
    s_waitcnt vmcnt(6)
    v_dot2_f32_bf16 v37, v100, v24, 0
    v_dot2_f32_bf16 v37, v101, v25, v37
    v_dot2_f32_bf16 v37, v102, v26, v37
    v_dot2_f32_bf16 v37, v103, v27, v37
    s_cbranch_vccnz L_is156
    s_waitcnt vmcnt(5)
    s_cbranch_scc0 L_is156
    s_waitcnt vmcnt(4)
L_is156:
    buffer_load_dwordx4 v[100:103], v1, s[20:23], s44 offen offset:1024 nt
    ds_read_b32 v2, v15 offset:31272
    s_waitcnt vmcnt(6)
    v_dot2_f32_bf16 v38, v104, v24, 0
    v_dot2_f32_bf16 v38, v105, v25, v38
    v_dot2_f32_bf16 v38, v106, v26, v38
    v_dot2_f32_bf16 v38, v107, v27, v38
    s_cbranch_vccnz L_is157
    s_waitcnt vmcnt(5)
    s_cbranch_scc0 L_is157
    s_waitcnt vmcnt(4)
L_is157:
    buffer_load_dwordx4 v[104:107], v1, s[20:23], s44 offen offset:1280 nt
    v_cvt_pk_bf16_f32 v42, v36, v37
    ds_read_b128 v[192:195], v208 offset:32768
    ds_read_b128 v[196:199], v208 offset:36864
    ds_read_b128 v[200:203], v208 offset:40960
    ds_read_b128 v[204:207], v208 offset:45056
    s_waitcnt vmcnt(6)
    v_dot2_f32_bf16 v39, v108, v24, 0
    v_dot2_f32_bf16 v39, v109, v25, v39
    v_dot2_f32_bf16 v39, v110, v26, v39
    v_dot2_f32_bf16 v39, v111, v27, v39
    s_cbranch_vccnz L_is158
    s_waitcnt vmcnt(5)
    s_cbranch_scc0 L_is158
    s_waitcnt vmcnt(4)
L_is158:
    buffer_load_dwordx4 v[108:111], v1, s[20:23], s44 offen offset:1536 nt
    s_waitcnt lgkmcnt(4)
    v_readfirstlane_b32 s55, v2
    s_nop 1
    s_cmp_ge_u32 s55, 0x2700
    s_cselect_b32 s55, s55, 0
    s_bitcmp1_b32 s55, 1
    s_cselect_b64 vcc, -1, 0
    s_bitcmp1_b32 s55, 0
    s_waitcnt vmcnt(6)
    v_dot2_f32_bf16 v32, v120, v24, 0
    v_dot2_f32_bf16 v32, v121, v25, v32
    v_dot2_f32_bf16 v32, v122, v26, v32
    v_dot2_f32_bf16 v32, v123, v27, v32
    s_cbranch_vccnz L_is159
    s_waitcnt vmcnt(5)
    s_cbranch_scc0 L_is159
    s_waitcnt vmcnt(4)
L_is159:
    buffer_load_dwordx4 v[120:123], v1, s[20:23], s44 offen offset:1792 nt
    v_mov_b32 v3, 38
    ds_write_b32 v9, v3 offset:31268
    v_cvt_pk_bf16_f32 v43, v38, v39
    s_waitcnt vmcnt(6)
    v_dot2_f32_bf16 v33, v112, v24, 0
    v_dot2_f32_bf16 v33, v113, v25, v33
    v_dot2_f32_bf16 v33, v114, v26, v33
    v_dot2_f32_bf16 v33, v115, v27, v33
    s_cbranch_vccnz L_is160
    s_waitcnt vmcnt(5)
    s_cbranch_scc0 L_is160
    s_waitcnt vmcnt(4)
L_is160:
    s_mov_b32 s44, 0x8100000
    buffer_load_dwordx4 v[112:115], v1, s[20:23], s44 offen offset:0 nt
    ds_read_b32 v2, v15 offset:31272
    s_waitcnt lgkmcnt(5)
    v_mfma_f32_16x16x32_bf16 v[64:67], v[192:195], v[40:43], v[64:67]
    s_waitcnt lgkmcnt(4)
    v_mfma_f32_16x16x32_bf16 v[68:71], v[196:199], v[40:43], v[68:71]
    s_waitcnt lgkmcnt(3)
    v_mfma_f32_16x16x32_bf16 v[72:75], v[200:203], v[40:43], v[72:75]
    s_waitcnt lgkmcnt(2)
    v_mfma_f32_16x16x32_bf16 v[76:79], v[204:207], v[40:43], v[76:79]
    s_waitcnt vmcnt(6)
    v_dot2_f32_bf16 v34, v116, v24, 0
    v_dot2_f32_bf16 v34, v117, v25, v34
    v_dot2_f32_bf16 v34, v118, v26, v34
    v_dot2_f32_bf16 v34, v119, v27, v34
    s_cbranch_vccnz L_is161
    s_waitcnt vmcnt(5)
    s_cbranch_scc0 L_is161
    s_waitcnt vmcnt(4)
L_is161:
    buffer_load_dwordx4 v[116:119], v1, s[20:23], s44 offen offset:256 nt
    v_cvt_pk_bf16_f32 v40, v32, v33
    s_waitcnt vmcnt(6)
    v_dot2_f32_bf16 v35, v96, v24, 0
    v_dot2_f32_bf16 v35, v97, v25, v35
    v_dot2_f32_bf16 v35, v98, v26, v35
    v_dot2_f32_bf16 v35, v99, v27, v35
    s_cbranch_vccnz L_is162
    s_waitcnt vmcnt(5)
    s_cbranch_scc0 L_is162
    s_waitcnt vmcnt(4)
L_is162:
    buffer_load_dwordx4 v[96:99], v1, s[20:23], s44 offen offset:512 nt
    s_waitcnt lgkmcnt(0)
    v_readfirstlane_b32 s55, v2
    s_nop 1
    s_cmp_ge_u32 s55, 0x2800
    s_cselect_b32 s55, s55, 0
    s_bitcmp1_b32 s55, 1
    s_cselect_b64 vcc, -1, 0
    s_bitcmp1_b32 s55, 0
    s_waitcnt vmcnt(6)
    v_dot2_f32_bf16 v36, v100, v24, 0
    v_dot2_f32_bf16 v36, v101, v25, v36
    v_dot2_f32_bf16 v36, v102, v26, v36
    v_dot2_f32_bf16 v36, v103, v27, v36
    s_cbranch_vccnz L_is163
    s_waitcnt vmcnt(5)
    s_cbranch_scc0 L_is163
    s_waitcnt vmcnt(4)
L_is163:
    buffer_load_dwordx4 v[100:103], v1, s[20:23], s44 offen offset:768 nt
    v_mov_b32 v3, 39
    ds_write_b32 v9, v3 offset:31268
    v_cvt_pk_bf16_f32 v41, v34, v35
    s_waitcnt vmcnt(6)
    v_dot2_f32_bf16 v37, v104, v24, 0
    v_dot2_f32_bf16 v37, v105, v25, v37
    v_dot2_f32_bf16 v37, v106, v26, v37
    v_dot2_f32_bf16 v37, v107, v27, v37
    s_cbranch_vccnz L_is164
    s_waitcnt vmcnt(5)
    s_cbranch_scc0 L_is164
    s_waitcnt vmcnt(4)
L_is164:
    buffer_load_dwordx4 v[104:107], v1, s[20:23], s44 offen offset:1024 nt
    ds_read_b32 v2, v15 offset:31272
    s_waitcnt vmcnt(6)
    v_dot2_f32_bf16 v38, v108, v24, 0
    v_dot2_f32_bf16 v38, v109, v25, v38
    v_dot2_f32_bf16 v38, v110, v26, v38
    v_dot2_f32_bf16 v38, v111, v27, v38
    s_cbranch_vccnz L_is165
    s_waitcnt vmcnt(5)
    s_cbranch_scc0 L_is165
    s_waitcnt vmcnt(4)
L_is165:
    buffer_load_dwordx4 v[108:111], v1, s[20:23], s44 offen offset:1280 nt
    v_cvt_pk_bf16_f32 v42, v36, v37
    ds_read_b128 v[192:195], v208 offset:49152
    ds_read_b128 v[196:199], v208 offset:53248
    ds_read_b128 v[200:203], v208 offset:57344
    ds_read_b128 v[204:207], v208 offset:61440
    s_waitcnt vmcnt(6)
    v_dot2_f32_bf16 v39, v120, v24, 0
    v_dot2_f32_bf16 v39, v121, v25, v39
    v_dot2_f32_bf16 v39, v122, v26, v39
    v_dot2_f32_bf16 v39, v123, v27, v39
    s_cbranch_vccnz L_is166
    s_waitcnt vmcnt(5)
    s_cbranch_scc0 L_is166
    s_waitcnt vmcnt(4)
L_is166:
    buffer_load_dwordx4 v[120:123], v1, s[20:23], s44 offen offset:1536 nt
    s_waitcnt lgkmcnt(4)
    v_readfirstlane_b32 s55, v2
    s_nop 1
    s_cmp_ge_u32 s55, 0x2900
    s_cselect_b32 s55, s55, 0
    s_bitcmp1_b32 s55, 1
    s_cselect_b64 vcc, -1, 0
    s_bitcmp1_b32 s55, 0
    s_waitcnt vmcnt(6)
    v_dot2_f32_bf16 v32, v112, v24, 0
    v_dot2_f32_bf16 v32, v113, v25, v32
    v_dot2_f32_bf16 v32, v114, v26, v32
    v_dot2_f32_bf16 v32, v115, v27, v32
    s_cbranch_vccnz L_is167
    s_waitcnt vmcnt(5)
    s_cbranch_scc0 L_is167
    s_waitcnt vmcnt(4)
L_is167:
    buffer_load_dwordx4 v[112:115], v1, s[20:23], s44 offen offset:1792 nt
    v_mov_b32 v3, 40
    ds_write_b32 v9, v3 offset:31268
    v_cvt_pk_bf16_f32 v43, v38, v39
    s_waitcnt vmcnt(6)
    v_dot2_f32_bf16 v33, v116, v24, 0
    v_dot2_f32_bf16 v33, v117, v25, v33
    v_dot2_f32_bf16 v33, v118, v26, v33
    v_dot2_f32_bf16 v33, v119, v27, v33
    s_cbranch_vccnz L_is168
    s_waitcnt vmcnt(5)
    s_cbranch_scc0 L_is168
    s_waitcnt vmcnt(4)
L_is168:
    s_mov_b32 s44, 0x8120000
    buffer_load_dwordx4 v[116:119], v1, s[20:23], s44 offen offset:0 nt
    ds_read_b32 v2, v15 offset:31272
    s_waitcnt lgkmcnt(5)
    v_mfma_f32_16x16x32_bf16 v[64:67], v[192:195], v[40:43], v[64:67]
    s_waitcnt lgkmcnt(4)
    v_mfma_f32_16x16x32_bf16 v[68:71], v[196:199], v[40:43], v[68:71]
    s_waitcnt lgkmcnt(3)
    v_mfma_f32_16x16x32_bf16 v[72:75], v[200:203], v[40:43], v[72:75]
    s_waitcnt lgkmcnt(2)
    v_mfma_f32_16x16x32_bf16 v[76:79], v[204:207], v[40:43], v[76:79]
    s_waitcnt vmcnt(6)
    v_dot2_f32_bf16 v34, v96, v24, 0
    v_dot2_f32_bf16 v34, v97, v25, v34
    v_dot2_f32_bf16 v34, v98, v26, v34
    v_dot2_f32_bf16 v34, v99, v27, v34
    s_cbranch_vccnz L_is169
    s_waitcnt vmcnt(5)
    s_cbranch_scc0 L_is169
    s_waitcnt vmcnt(4)
L_is169:
    buffer_load_dwordx4 v[96:99], v1, s[20:23], s44 offen offset:256 nt
    v_cvt_pk_bf16_f32 v40, v32, v33
    s_waitcnt vmcnt(6)
    v_dot2_f32_bf16 v35, v100, v24, 0
    v_dot2_f32_bf16 v35, v101, v25, v35
    v_dot2_f32_bf16 v35, v102, v26, v35
    v_dot2_f32_bf16 v35, v103, v27, v35
    s_cbranch_vccnz L_is170
    s_waitcnt vmcnt(5)
    s_cbranch_scc0 L_is170
    s_waitcnt vmcnt(4)
L_is170:
    buffer_load_dwordx4 v[100:103], v1, s[20:23], s44 offen offset:512 nt
    s_waitcnt lgkmcnt(0)
    v_readfirstlane_b32 s55, v2
    s_nop 1
    s_cmp_ge_u32 s55, 0x2a00
    s_cselect_b32 s55, s55, 0
    s_bitcmp1_b32 s55, 1
    s_cselect_b64 vcc, -1, 0
    s_bitcmp1_b32 s55, 0
    s_waitcnt vmcnt(6)
    v_dot2_f32_bf16 v36, v104, v24, 0
    v_dot2_f32_bf16 v36, v105, v25, v36
    v_dot2_f32_bf16 v36, v106, v26, v36
    v_dot2_f32_bf16 v36, v107, v27, v36
    s_cbranch_vccnz L_is171
    s_waitcnt vmcnt(5)
    s_cbranch_scc0 L_is171
    s_waitcnt vmcnt(4)
L_is171:
    buffer_load_dwordx4 v[104:107], v1, s[20:23], s44 offen offset:768 nt
    v_mov_b32 v3, 41
    ds_write_b32 v9, v3 offset:31268
    v_cvt_pk_bf16_f32 v41, v34, v35
    s_waitcnt vmcnt(6)
    v_dot2_f32_bf16 v37, v108, v24, 0
    v_dot2_f32_bf16 v37, v109, v25, v37
    v_dot2_f32_bf16 v37, v110, v26, v37
    v_dot2_f32_bf16 v37, v111, v27, v37
    s_cbranch_vccnz L_is172
    s_waitcnt vmcnt(5)
    s_cbranch_scc0 L_is172
    s_waitcnt vmcnt(4)
L_is172:
    buffer_load_dwordx4 v[108:111], v1, s[20:23], s44 offen offset:1024 nt
    ds_read_b32 v2, v15 offset:31272
    s_waitcnt vmcnt(6)
    v_dot2_f32_bf16 v38, v120, v24, 0
    v_dot2_f32_bf16 v38, v121, v25, v38
    v_dot2_f32_bf16 v38, v122, v26, v38
    v_dot2_f32_bf16 v38, v123, v27, v38
    s_cbranch_vccnz L_is173
    s_waitcnt vmcnt(5)
    s_cbranch_scc0 L_is173
    s_waitcnt vmcnt(4)
L_is173:
    buffer_load_dwordx4 v[120:123], v1, s[20:23], s44 offen offset:1280 nt
    v_cvt_pk_bf16_f32 v42, v36, v37
    ds_read_b128 v[192:195], v209 offset:0
    ds_read_b128 v[196:199], v209 offset:4096
    ds_read_b128 v[200:203], v209 offset:8192
    ds_read_b128 v[204:207], v209 offset:12288
    s_waitcnt vmcnt(6)
    v_dot2_f32_bf16 v39, v112, v24, 0
    v_dot2_f32_bf16 v39, v113, v25, v39
    v_dot2_f32_bf16 v39, v114, v26, v39
    v_dot2_f32_bf16 v39, v115, v27, v39
    s_cbranch_vccnz L_is174
    s_waitcnt vmcnt(5)
    s_cbranch_scc0 L_is174
    s_waitcnt vmcnt(4)
L_is174:
    buffer_load_dwordx4 v[112:115], v1, s[20:23], s44 offen offset:1536 nt
    s_waitcnt lgkmcnt(4)
    v_readfirstlane_b32 s55, v2
    s_nop 1
    s_cmp_ge_u32 s55, 0x2b00
    s_cselect_b32 s55, s55, 0
    s_bitcmp1_b32 s55, 1
    s_cselect_b64 vcc, -1, 0
    s_bitcmp1_b32 s55, 0
    s_waitcnt vmcnt(6)
    v_dot2_f32_bf16 v32, v116, v24, 0
    v_dot2_f32_bf16 v32, v117, v25, v32
    v_dot2_f32_bf16 v32, v118, v26, v32
    v_dot2_f32_bf16 v32, v119, v27, v32
    s_cbranch_vccnz L_is175
    s_waitcnt vmcnt(5)
    s_cbranch_scc0 L_is175
    s_waitcnt vmcnt(4)
L_is175:
    buffer_load_dwordx4 v[116:119], v1, s[20:23], s44 offen offset:1792 nt
    v_mov_b32 v3, 42
    ds_write_b32 v9, v3 offset:31268
    v_cvt_pk_bf16_f32 v43, v38, v39
    s_waitcnt vmcnt(6)
    v_dot2_f32_bf16 v33, v96, v24, 0
    v_dot2_f32_bf16 v33, v97, v25, v33
    v_dot2_f32_bf16 v33, v98, v26, v33
    v_dot2_f32_bf16 v33, v99, v27, v33
    s_cbranch_vccnz L_is176
    s_waitcnt vmcnt(5)
    s_cbranch_scc0 L_is176
    s_waitcnt vmcnt(4)
L_is176:
    s_mov_b32 s44, 0x8180000
    buffer_load_dwordx4 v[96:99], v1, s[20:23], s44 offen offset:0 nt
    ds_read_b32 v2, v15 offset:31272
    s_waitcnt lgkmcnt(5)
    v_mfma_f32_16x16x32_bf16 v[64:67], v[192:195], v[40:43], v[64:67]
    s_waitcnt lgkmcnt(4)
    v_mfma_f32_16x16x32_bf16 v[68:71], v[196:199], v[40:43], v[68:71]
    s_waitcnt lgkmcnt(3)
    v_mfma_f32_16x16x32_bf16 v[72:75], v[200:203], v[40:43], v[72:75]
    s_waitcnt lgkmcnt(2)
    v_mfma_f32_16x16x32_bf16 v[76:79], v[204:207], v[40:43], v[76:79]
    s_waitcnt vmcnt(6)
    v_dot2_f32_bf16 v34, v100, v24, 0
    v_dot2_f32_bf16 v34, v101, v25, v34
    v_dot2_f32_bf16 v34, v102, v26, v34
    v_dot2_f32_bf16 v34, v103, v27, v34
    s_cbranch_vccnz L_is177
    s_waitcnt vmcnt(5)
    s_cbranch_scc0 L_is177
    s_waitcnt vmcnt(4)
L_is177:
    buffer_load_dwordx4 v[100:103], v1, s[20:23], s44 offen offset:256 nt
    v_cvt_pk_bf16_f32 v40, v32, v33
    s_waitcnt vmcnt(6)
    v_dot2_f32_bf16 v35, v104, v24, 0
    v_dot2_f32_bf16 v35, v105, v25, v35
    v_dot2_f32_bf16 v35, v106, v26, v35
    v_dot2_f32_bf16 v35, v107, v27, v35
    s_cbranch_vccnz L_is178
    s_waitcnt vmcnt(5)
    s_cbranch_scc0 L_is178
    s_waitcnt vmcnt(4)
L_is178:
    buffer_load_dwordx4 v[104:107], v1, s[20:23], s44 offen offset:512 nt
    s_waitcnt lgkmcnt(0)
    v_readfirstlane_b32 s55, v2
    s_nop 1
    s_cmp_ge_u32 s55, 0x2c00
    s_cselect_b32 s55, s55, 0
    s_bitcmp1_b32 s55, 1
    s_cselect_b64 vcc, -1, 0
    s_bitcmp1_b32 s55, 0
    s_waitcnt vmcnt(6)
    v_dot2_f32_bf16 v36, v108, v24, 0
    v_dot2_f32_bf16 v36, v109, v25, v36
    v_dot2_f32_bf16 v36, v110, v26, v36
    v_dot2_f32_bf16 v36, v111, v27, v36
    s_cbranch_vccnz L_is179
    s_waitcnt vmcnt(5)
    s_cbranch_scc0 L_is179
    s_waitcnt vmcnt(4)
L_is179:
    buffer_load_dwordx4 v[108:111], v1, s[20:23], s44 offen offset:768 nt
    v_mov_b32 v3, 43
    ds_write_b32 v9, v3 offset:31268
    v_cvt_pk_bf16_f32 v41, v34, v35
    s_waitcnt vmcnt(6)
    v_dot2_f32_bf16 v37, v120, v24, 0
    v_dot2_f32_bf16 v37, v121, v25, v37
    v_dot2_f32_bf16 v37, v122, v26, v37
    v_dot2_f32_bf16 v37, v123, v27, v37
    s_cbranch_vccnz L_is180
    s_waitcnt vmcnt(5)
    s_cbranch_scc0 L_is180
    s_waitcnt vmcnt(4)
L_is180:
    buffer_load_dwordx4 v[120:123], v1, s[20:23], s44 offen offset:1024 nt
    ds_read_b32 v2, v15 offset:31272
    s_waitcnt vmcnt(6)
    v_dot2_f32_bf16 v38, v112, v24, 0
    v_dot2_f32_bf16 v38, v113, v25, v38
    v_dot2_f32_bf16 v38, v114, v26, v38
    v_dot2_f32_bf16 v38, v115, v27, v38
    s_cbranch_vccnz L_is181
    s_waitcnt vmcnt(5)
    s_cbranch_scc0 L_is181
    s_waitcnt vmcnt(4)
L_is181:
    buffer_load_dwordx4 v[112:115], v1, s[20:23], s44 offen offset:1280 nt
    v_cvt_pk_bf16_f32 v42, v36, v37
    ds_read_b128 v[192:195], v209 offset:16384
    ds_read_b128 v[196:199], v209 offset:20480
    ds_read_b128 v[200:203], v209 offset:24576
    ds_read_b128 v[204:207], v209 offset:28672
    s_waitcnt vmcnt(6)
    v_dot2_f32_bf16 v39, v116, v24, 0
    v_dot2_f32_bf16 v39, v117, v25, v39
    v_dot2_f32_bf16 v39, v118, v26, v39
    v_dot2_f32_bf16 v39, v119, v27, v39
    s_cbranch_vccnz L_is182
    s_waitcnt vmcnt(5)
    s_cbranch_scc0 L_is182
    s_waitcnt vmcnt(4)
L_is182:
    buffer_load_dwordx4 v[116:119], v1, s[20:23], s44 offen offset:1536 nt
    s_waitcnt lgkmcnt(4)
    v_readfirstlane_b32 s55, v2
    s_nop 1
    s_cmp_ge_u32 s55, 0x2d00
    s_cselect_b32 s55, s55, 0
    s_bitcmp1_b32 s55, 1
    s_cselect_b64 vcc, -1, 0
    s_bitcmp1_b32 s55, 0
    s_waitcnt vmcnt(6)
    v_dot2_f32_bf16 v32, v96, v24, 0
    v_dot2_f32_bf16 v32, v97, v25, v32
    v_dot2_f32_bf16 v32, v98, v26, v32
    v_dot2_f32_bf16 v32, v99, v27, v32
    s_cbranch_vccnz L_is183
    s_waitcnt vmcnt(5)
    s_cbranch_scc0 L_is183
    s_waitcnt vmcnt(4)
L_is183:
    buffer_load_dwordx4 v[96:99], v1, s[20:23], s44 offen offset:1792 nt
    v_mov_b32 v3, 44
    ds_write_b32 v9, v3 offset:31268
    v_cvt_pk_bf16_f32 v43, v38, v39
    s_waitcnt vmcnt(6)
    v_dot2_f32_bf16 v33, v100, v24, 0
    v_dot2_f32_bf16 v33, v101, v25, v33
    v_dot2_f32_bf16 v33, v102, v26, v33
    v_dot2_f32_bf16 v33, v103, v27, v33
    s_cbranch_vccnz L_is184
    s_waitcnt vmcnt(5)
    s_cbranch_scc0 L_is184
    s_waitcnt vmcnt(4)
L_is184:
    s_mov_b32 s44, 0x81a0000
    buffer_load_dwordx4 v[100:103], v1, s[20:23], s44 offen offset:0 nt
    ds_read_b32 v2, v15 offset:31272
    s_waitcnt lgkmcnt(5)
    v_mfma_f32_16x16x32_bf16 v[64:67], v[192:195], v[40:43], v[64:67]
    s_waitcnt lgkmcnt(4)
    v_mfma_f32_16x16x32_bf16 v[68:71], v[196:199], v[40:43], v[68:71]
    s_waitcnt lgkmcnt(3)
    v_mfma_f32_16x16x32_bf16 v[72:75], v[200:203], v[40:43], v[72:75]
    s_waitcnt lgkmcnt(2)
    v_mfma_f32_16x16x32_bf16 v[76:79], v[204:207], v[40:43], v[76:79]
    s_waitcnt vmcnt(6)
    v_dot2_f32_bf16 v34, v104, v24, 0
    v_dot2_f32_bf16 v34, v105, v25, v34
    v_dot2_f32_bf16 v34, v106, v26, v34
    v_dot2_f32_bf16 v34, v107, v27, v34
    s_cbranch_vccnz L_is185
    s_waitcnt vmcnt(5)
    s_cbranch_scc0 L_is185
    s_waitcnt vmcnt(4)
L_is185:
    buffer_load_dwordx4 v[104:107], v1, s[20:23], s44 offen offset:256 nt
    v_cvt_pk_bf16_f32 v40, v32, v33
    s_waitcnt vmcnt(6)
    v_dot2_f32_bf16 v35, v108, v24, 0
    v_dot2_f32_bf16 v35, v109, v25, v35
    v_dot2_f32_bf16 v35, v110, v26, v35
    v_dot2_f32_bf16 v35, v111, v27, v35
    s_cbranch_vccnz L_is186
    s_waitcnt vmcnt(5)
    s_cbranch_scc0 L_is186
    s_waitcnt vmcnt(4)
L_is186:
    buffer_load_dwordx4 v[108:111], v1, s[20:23], s44 offen offset:512 nt
    s_waitcnt lgkmcnt(0)
    v_readfirstlane_b32 s55, v2
    s_nop 1
    s_cmp_ge_u32 s55, 0x2e00
    s_cselect_b32 s55, s55, 0
    s_bitcmp1_b32 s55, 1
    s_cselect_b64 vcc, -1, 0
    s_bitcmp1_b32 s55, 0
    s_waitcnt vmcnt(6)
    v_dot2_f32_bf16 v36, v120, v24, 0
    v_dot2_f32_bf16 v36, v121, v25, v36
    v_dot2_f32_bf16 v36, v122, v26, v36
    v_dot2_f32_bf16 v36, v123, v27, v36
    s_cbranch_vccnz L_is187
    s_waitcnt vmcnt(5)
    s_cbranch_scc0 L_is187
    s_waitcnt vmcnt(4)
L_is187:
    buffer_load_dwordx4 v[120:123], v1, s[20:23], s44 offen offset:768 nt
    v_mov_b32 v3, 45
    ds_write_b32 v9, v3 offset:31268
    v_cvt_pk_bf16_f32 v41, v34, v35
    s_waitcnt vmcnt(6)
    v_dot2_f32_bf16 v37, v112, v24, 0
    v_dot2_f32_bf16 v37, v113, v25, v37
    v_dot2_f32_bf16 v37, v114, v26, v37
    v_dot2_f32_bf16 v37, v115, v27, v37
    s_cbranch_vccnz L_is188
    s_waitcnt vmcnt(5)
    s_cbranch_scc0 L_is188
    s_waitcnt vmcnt(4)
L_is188:
    buffer_load_dwordx4 v[112:115], v1, s[20:23], s44 offen offset:1024 nt
    ds_read_b32 v2, v15 offset:31272
    s_waitcnt vmcnt(6)
    v_dot2_f32_bf16 v38, v116, v24, 0
    v_dot2_f32_bf16 v38, v117, v25, v38
    v_dot2_f32_bf16 v38, v118, v26, v38
    v_dot2_f32_bf16 v38, v119, v27, v38
    s_cbranch_vccnz L_is189
    s_waitcnt vmcnt(5)
    s_cbranch_scc0 L_is189
    s_waitcnt vmcnt(4)
L_is189:
    buffer_load_dwordx4 v[116:119], v1, s[20:23], s44 offen offset:1280 nt
    v_cvt_pk_bf16_f32 v42, v36, v37
    ds_read_b128 v[192:195], v209 offset:32768
    ds_read_b128 v[196:199], v209 offset:36864
    ds_read_b128 v[200:203], v209 offset:40960
    ds_read_b128 v[204:207], v209 offset:45056
    s_waitcnt vmcnt(6)
    v_dot2_f32_bf16 v39, v96, v24, 0
    v_dot2_f32_bf16 v39, v97, v25, v39
    v_dot2_f32_bf16 v39, v98, v26, v39
    v_dot2_f32_bf16 v39, v99, v27, v39
    s_cbranch_vccnz L_is190
    s_waitcnt vmcnt(5)
    s_cbranch_scc0 L_is190
    s_waitcnt vmcnt(4)
L_is190:
    buffer_load_dwordx4 v[96:99], v1, s[20:23], s44 offen offset:1536 nt
    s_waitcnt lgkmcnt(4)
    v_readfirstlane_b32 s55, v2
    s_nop 1
    s_cmp_ge_u32 s55, 0x2f00
    s_cselect_b32 s55, s55, 0
    s_bitcmp1_b32 s55, 1
    s_cselect_b64 vcc, -1, 0
    s_bitcmp1_b32 s55, 0
    s_waitcnt vmcnt(6)
    v_dot2_f32_bf16 v32, v100, v24, 0
    v_dot2_f32_bf16 v32, v101, v25, v32
    v_dot2_f32_bf16 v32, v102, v26, v32
    v_dot2_f32_bf16 v32, v103, v27, v32
    s_cbranch_vccnz L_is191
    s_waitcnt vmcnt(5)
    s_cbranch_scc0 L_is191
    s_waitcnt vmcnt(4)
L_is191:
    buffer_load_dwordx4 v[100:103], v1, s[20:23], s44 offen offset:1792 nt
    v_mov_b32 v3, 46
    ds_write_b32 v9, v3 offset:31268
    v_cvt_pk_bf16_f32 v43, v38, v39
    s_waitcnt vmcnt(6)
    v_dot2_f32_bf16 v33, v104, v24, 0
    v_dot2_f32_bf16 v33, v105, v25, v33
    v_dot2_f32_bf16 v33, v106, v26, v33
    v_dot2_f32_bf16 v33, v107, v27, v33
    s_cbranch_vccnz L_is192
    s_waitcnt vmcnt(5)
    s_cbranch_scc0 L_is192
    s_waitcnt vmcnt(4)
L_is192:
    s_mov_b32 s44, 0xa000000
    buffer_load_dwordx4 v[104:107], v1, s[20:23], s44 offen offset:0 nt
    ds_read_b32 v2, v15 offset:31272
    s_waitcnt lgkmcnt(5)
    v_mfma_f32_16x16x32_bf16 v[64:67], v[192:195], v[40:43], v[64:67]
    s_waitcnt lgkmcnt(4)
    v_mfma_f32_16x16x32_bf16 v[68:71], v[196:199], v[40:43], v[68:71]
    s_waitcnt lgkmcnt(3)
    v_mfma_f32_16x16x32_bf16 v[72:75], v[200:203], v[40:43], v[72:75]
    s_waitcnt lgkmcnt(2)
    v_mfma_f32_16x16x32_bf16 v[76:79], v[204:207], v[40:43], v[76:79]
    s_waitcnt vmcnt(6)
    v_dot2_f32_bf16 v34, v108, v24, 0
    v_dot2_f32_bf16 v34, v109, v25, v34
    v_dot2_f32_bf16 v34, v110, v26, v34
    v_dot2_f32_bf16 v34, v111, v27, v34
    s_cbranch_vccnz L_is193
    s_waitcnt vmcnt(5)
    s_cbranch_scc0 L_is193
    s_waitcnt vmcnt(4)
L_is193:
    buffer_load_dwordx4 v[108:111], v1, s[20:23], s44 offen offset:256 nt
    v_cvt_pk_bf16_f32 v40, v32, v33
    s_waitcnt vmcnt(6)
    v_dot2_f32_bf16 v35, v120, v24, 0
    v_dot2_f32_bf16 v35, v121, v25, v35
    v_dot2_f32_bf16 v35, v122, v26, v35
    v_dot2_f32_bf16 v35, v123, v27, v35
    s_cbranch_vccnz L_is194
    s_waitcnt vmcnt(5)
    s_cbranch_scc0 L_is194
    s_waitcnt vmcnt(4)
L_is194:
    buffer_load_dwordx4 v[120:123], v1, s[20:23], s44 offen offset:512 nt
    s_waitcnt lgkmcnt(0)
    v_readfirstlane_b32 s55, v2
    s_nop 1
    s_cmp_ge_u32 s55, 0x3000
    s_cselect_b32 s55, s55, 0
    s_bitcmp1_b32 s55, 1
    s_cselect_b64 vcc, -1, 0
    s_bitcmp1_b32 s55, 0
    s_waitcnt vmcnt(6)
    v_dot2_f32_bf16 v36, v112, v24, 0
    v_dot2_f32_bf16 v36, v113, v25, v36
    v_dot2_f32_bf16 v36, v114, v26, v36
    v_dot2_f32_bf16 v36, v115, v27, v36
    s_cbranch_vccnz L_is195
    s_waitcnt vmcnt(5)
    s_cbranch_scc0 L_is195
    s_waitcnt vmcnt(4)
L_is195:
    buffer_load_dwordx4 v[112:115], v1, s[20:23], s44 offen offset:768 nt
    v_mov_b32 v3, 47
    ds_write_b32 v9, v3 offset:31268
    v_cvt_pk_bf16_f32 v41, v34, v35
    s_waitcnt vmcnt(6)
    v_dot2_f32_bf16 v37, v116, v24, 0
    v_dot2_f32_bf16 v37, v117, v25, v37
    v_dot2_f32_bf16 v37, v118, v26, v37
    v_dot2_f32_bf16 v37, v119, v27, v37
    s_cbranch_vccnz L_is196
    s_waitcnt vmcnt(5)
    s_cbranch_scc0 L_is196
    s_waitcnt vmcnt(4)
L_is196:
    buffer_load_dwordx4 v[116:119], v1, s[20:23], s44 offen offset:1024 nt
    ds_read_b32 v2, v15 offset:31272
    s_waitcnt vmcnt(6)
    v_dot2_f32_bf16 v38, v96, v24, 0
    v_dot2_f32_bf16 v38, v97, v25, v38
    v_dot2_f32_bf16 v38, v98, v26, v38
    v_dot2_f32_bf16 v38, v99, v27, v38
    s_cbranch_vccnz L_is197
    s_waitcnt vmcnt(5)
    s_cbranch_scc0 L_is197
    s_waitcnt vmcnt(4)
L_is197:
    buffer_load_dwordx4 v[96:99], v1, s[20:23], s44 offen offset:1280 nt
    v_cvt_pk_bf16_f32 v42, v36, v37
    ds_read_b128 v[192:195], v209 offset:49152
    ds_read_b128 v[196:199], v209 offset:53248
    ds_read_b128 v[200:203], v209 offset:57344
    ds_read_b128 v[204:207], v209 offset:61440
    s_waitcnt vmcnt(6)
    v_dot2_f32_bf16 v39, v100, v24, 0
    v_dot2_f32_bf16 v39, v101, v25, v39
    v_dot2_f32_bf16 v39, v102, v26, v39
    v_dot2_f32_bf16 v39, v103, v27, v39
    s_cbranch_vccnz L_is198
    s_waitcnt vmcnt(5)
    s_cbranch_scc0 L_is198
    s_waitcnt vmcnt(4)
L_is198:
    buffer_load_dwordx4 v[100:103], v1, s[20:23], s44 offen offset:1536 nt
    s_waitcnt lgkmcnt(4)
    v_readfirstlane_b32 s55, v2
    s_nop 1
    s_cmp_ge_u32 s55, 0x3100
    s_cselect_b32 s55, s55, 0
    s_bitcmp1_b32 s55, 1
    s_cselect_b64 vcc, -1, 0
    s_bitcmp1_b32 s55, 0
    s_waitcnt vmcnt(6)
    v_dot2_f32_bf16 v32, v104, v28, 0
    v_dot2_f32_bf16 v32, v105, v29, v32
    v_dot2_f32_bf16 v32, v106, v30, v32
    v_dot2_f32_bf16 v32, v107, v31, v32
    s_cbranch_vccnz L_is199
    s_waitcnt vmcnt(5)
    s_cbranch_scc0 L_is199
    s_waitcnt vmcnt(4)
L_is199:
    buffer_load_dwordx4 v[104:107], v1, s[20:23], s44 offen offset:1792 nt
    v_mov_b32 v3, 48
    ds_write_b32 v9, v3 offset:31268
    v_cvt_pk_bf16_f32 v43, v38, v39
    s_waitcnt vmcnt(6)
    v_dot2_f32_bf16 v33, v108, v28, 0
    v_dot2_f32_bf16 v33, v109, v29, v33
    v_dot2_f32_bf16 v33, v110, v30, v33
    v_dot2_f32_bf16 v33, v111, v31, v33
    s_cbranch_vccnz L_is200
    s_waitcnt vmcnt(5)
    s_cbranch_scc0 L_is200
    s_waitcnt vmcnt(4)
L_is200:
    s_mov_b32 s44, 0xa020000
    buffer_load_dwordx4 v[108:111], v1, s[20:23], s44 offen offset:0 nt
    ds_read_b32 v2, v15 offset:31272
    s_waitcnt lgkmcnt(5)
    v_mfma_f32_16x16x32_bf16 v[64:67], v[192:195], v[40:43], v[64:67]
    s_waitcnt lgkmcnt(4)
    v_mfma_f32_16x16x32_bf16 v[68:71], v[196:199], v[40:43], v[68:71]
    s_waitcnt lgkmcnt(3)
    v_mfma_f32_16x16x32_bf16 v[72:75], v[200:203], v[40:43], v[72:75]
    s_waitcnt lgkmcnt(2)
    v_mfma_f32_16x16x32_bf16 v[76:79], v[204:207], v[40:43], v[76:79]
    s_waitcnt vmcnt(6)
    v_dot2_f32_bf16 v34, v120, v28, 0
    v_dot2_f32_bf16 v34, v121, v29, v34
    v_dot2_f32_bf16 v34, v122, v30, v34
    v_dot2_f32_bf16 v34, v123, v31, v34
    s_cbranch_vccnz L_is201
    s_waitcnt vmcnt(5)
    s_cbranch_scc0 L_is201
    s_waitcnt vmcnt(4)
L_is201:
    buffer_load_dwordx4 v[120:123], v1, s[20:23], s44 offen offset:256 nt
    v_cvt_pk_bf16_f32 v40, v32, v33
    v_add_f32_dpp v64, v64, v64 row_ror:8 row_mask:0xf bank_mask:0x3
    v_add_f32_dpp v65, v65, v65 row_ror:8 row_mask:0xf bank_mask:0x3
    v_add_f32_dpp v66, v66, v66 row_ror:8 row_mask:0xf bank_mask:0x3
    v_add_f32_dpp v67, v67, v67 row_ror:8 row_mask:0xf bank_mask:0x3
    v_add_f32_dpp v68, v68, v68 row_ror:8 row_mask:0xf bank_mask:0x3
    v_add_f32_dpp v69, v69, v69 row_ror:8 row_mask:0xf bank_mask:0x3
    v_add_f32_dpp v70, v70, v70 row_ror:8 row_mask:0xf bank_mask:0x3
    v_add_f32_dpp v71, v71, v71 row_ror:8 row_mask:0xf bank_mask:0x3
    s_waitcnt vmcnt(6)
    v_dot2_f32_bf16 v35, v112, v28, 0
    v_dot2_f32_bf16 v35, v113, v29, v35
    v_dot2_f32_bf16 v35, v114, v30, v35
    v_dot2_f32_bf16 v35, v115, v31, v35
    s_cbranch_vccnz L_is202
    s_waitcnt vmcnt(5)
    s_cbranch_scc0 L_is202
    s_waitcnt vmcnt(4)
L_is202:
    buffer_load_dwordx4 v[112:115], v1, s[20:23], s44 offen offset:512 nt
    s_waitcnt lgkmcnt(0)
    v_readfirstlane_b32 s55, v2
    s_nop 1
    s_cmp_ge_u32 s55, 0x3200
    s_cselect_b32 s55, s55, 0
    s_bitcmp1_b32 s55, 1
    s_cselect_b64 vcc, -1, 0
    s_bitcmp1_b32 s55, 0
    v_add_f32_dpp v64, v72, v72 row_ror:8 row_mask:0xf bank_mask:0xc
    v_add_f32_dpp v65, v73, v73 row_ror:8 row_mask:0xf bank_mask:0xc
    v_add_f32_dpp v66, v74, v74 row_ror:8 row_mask:0xf bank_mask:0xc
    v_add_f32_dpp v67, v75, v75 row_ror:8 row_mask:0xf bank_mask:0xc
    v_add_f32_dpp v68, v76, v76 row_ror:8 row_mask:0xf bank_mask:0xc
    v_add_f32_dpp v69, v77, v77 row_ror:8 row_mask:0xf bank_mask:0xc
    v_add_f32_dpp v70, v78, v78 row_ror:8 row_mask:0xf bank_mask:0xc
    v_add_f32_dpp v71, v79, v79 row_ror:8 row_mask:0xf bank_mask:0xc
    s_waitcnt vmcnt(6)
    v_dot2_f32_bf16 v36, v116, v28, 0
    v_dot2_f32_bf16 v36, v117, v29, v36
    v_dot2_f32_bf16 v36, v118, v30, v36
    v_dot2_f32_bf16 v36, v119, v31, v36
    s_cbranch_vccnz L_is203
    s_waitcnt vmcnt(5)
    s_cbranch_scc0 L_is203
    s_waitcnt vmcnt(4)
L_is203:
    buffer_load_dwordx4 v[116:119], v1, s[20:23], s44 offen offset:768 nt
    v_mov_b32 v3, 49
    ds_write_b32 v9, v3 offset:31268
    v_cvt_pk_bf16_f32 v41, v34, v35
    v_add_f32_dpp v64, v64, v64 row_shl:4 row_mask:0xf bank_mask:0x5
    v_add_f32_dpp v65, v65, v65 row_shl:4 row_mask:0xf bank_mask:0x5
    v_add_f32_dpp v66, v66, v66 row_shl:4 row_mask:0xf bank_mask:0x5
    v_add_f32_dpp v67, v67, v67 row_shl:4 row_mask:0xf bank_mask:0x5
    v_add_f32_dpp v64, v68, v68 row_shr:4 row_mask:0xf bank_mask:0xa
    v_add_f32_dpp v65, v69, v69 row_shr:4 row_mask:0xf bank_mask:0xa
    v_add_f32_dpp v66, v70, v70 row_shr:4 row_mask:0xf bank_mask:0xa
    v_add_f32_dpp v67, v71, v71 row_shr:4 row_mask:0xf bank_mask:0xa
    s_waitcnt vmcnt(6)
    v_dot2_f32_bf16 v37, v96, v28, 0
    v_dot2_f32_bf16 v37, v97, v29, v37
    v_dot2_f32_bf16 v37, v98, v30, v37
    v_dot2_f32_bf16 v37, v99, v31, v37
    s_cbranch_vccnz L_is204
    s_waitcnt vmcnt(5)
    s_cbranch_scc0 L_is204
    s_waitcnt vmcnt(4)
L_is204:
    buffer_load_dwordx4 v[96:99], v1, s[20:23], s44 offen offset:1024 nt
    ds_read_b32 v2, v15 offset:31272
    v_add_f32_dpp v64, v64, v64 quad_perm:[2,3,0,1] row_mask:0xf bank_mask:0xf
    v_add_f32_dpp v65, v65, v65 quad_perm:[2,3,0,1] row_mask:0xf bank_mask:0xf
    v_add_f32_dpp v66, v66, v66 quad_perm:[2,3,0,1] row_mask:0xf bank_mask:0xf
    v_add_f32_dpp v67, v67, v67 quad_perm:[2,3,0,1] row_mask:0xf bank_mask:0xf
    v_cndmask_b32 v64, v64, v66, s[48:49]
    v_cndmask_b32 v65, v65, v67, s[48:49]
    s_nop 0
    v_add_f32_dpp v64, v64, v64 quad_perm:[1,0,3,2] row_mask:0xf bank_mask:0xf
    v_add_f32_dpp v65, v65, v65 quad_perm:[1,0,3,2] row_mask:0xf bank_mask:0xf
    s_waitcnt vmcnt(6)
    v_dot2_f32_bf16 v38, v100, v28, 0
    v_dot2_f32_bf16 v38, v101, v29, v38
    v_dot2_f32_bf16 v38, v102, v30, v38
    v_dot2_f32_bf16 v38, v103, v31, v38
    s_cbranch_vccnz L_is205
    s_waitcnt vmcnt(5)
    s_cbranch_scc0 L_is205
    s_waitcnt vmcnt(4)
L_is205:
    buffer_load_dwordx4 v[100:103], v1, s[20:23], s44 offen offset:1280 nt
    v_cvt_pk_bf16_f32 v42, v36, v37
    ds_read_b128 v[192:195], v208 offset:0
    ds_read_b128 v[196:199], v208 offset:4096
    ds_read_b128 v[200:203], v208 offset:8192
    ds_read_b128 v[204:207], v208 offset:12288
    v_cndmask_b32 v64, v64, v65, s[50:51]
    v_min_u32 v64, -2, v64
    ds_write_b32 v6, v64 offset:2048
    s_waitcnt vmcnt(6)
    v_dot2_f32_bf16 v39, v104, v28, 0
    v_dot2_f32_bf16 v39, v105, v29, v39
    v_dot2_f32_bf16 v39, v106, v30, v39
    v_dot2_f32_bf16 v39, v107, v31, v39
    s_cbranch_vccnz L_is206
    s_waitcnt vmcnt(5)
    s_cbranch_scc0 L_is206
    s_waitcnt vmcnt(4)
L_is206:
    buffer_load_dwordx4 v[104:107], v1, s[20:23], s44 offen offset:1536 nt
    s_waitcnt lgkmcnt(5)
    v_readfirstlane_b32 s55, v2
    s_nop 1
    s_cmp_ge_u32 s55, 0x3300
    s_cselect_b32 s55, s55, 0
    s_bitcmp1_b32 s55, 1
    s_cselect_b64 vcc, -1, 0
    s_bitcmp1_b32 s55, 0
    s_waitcnt vmcnt(6)
    v_dot2_f32_bf16 v32, v108, v28, 0
    v_dot2_f32_bf16 v32, v109, v29, v32
    v_dot2_f32_bf16 v32, v110, v30, v32
    v_dot2_f32_bf16 v32, v111, v31, v32
    s_cbranch_vccnz L_is207
    s_waitcnt vmcnt(5)
    s_cbranch_scc0 L_is207
    s_waitcnt vmcnt(4)
L_is207:
    buffer_load_dwordx4 v[108:111], v1, s[20:23], s44 offen offset:1792 nt
    v_mov_b32 v3, 50
    ds_write_b32 v9, v3 offset:31268
    v_cvt_pk_bf16_f32 v43, v38, v39
    s_waitcnt vmcnt(6)
    v_dot2_f32_bf16 v33, v120, v28, 0
    v_dot2_f32_bf16 v33, v121, v29, v33
    v_dot2_f32_bf16 v33, v122, v30, v33
    v_dot2_f32_bf16 v33, v123, v31, v33
    s_cbranch_vccnz L_is208
    s_waitcnt vmcnt(5)
    s_cbranch_scc0 L_is208
    s_waitcnt vmcnt(4)
L_is208:
    s_mov_b32 s44, 0xa080000
    buffer_load_dwordx4 v[120:123], v1, s[20:23], s44 offen offset:0 nt
    ds_read_b32 v2, v15 offset:31272
    s_waitcnt lgkmcnt(6)
    v_mfma_f32_16x16x32_bf16 v[80:83], v[192:195], v[40:43], 0
    s_waitcnt lgkmcnt(5)
    v_mfma_f32_16x16x32_bf16 v[84:87], v[196:199], v[40:43], 0
    s_waitcnt lgkmcnt(4)
    v_mfma_f32_16x16x32_bf16 v[88:91], v[200:203], v[40:43], 0
    s_waitcnt lgkmcnt(3)
    v_mfma_f32_16x16x32_bf16 v[92:95], v[204:207], v[40:43], 0
    s_waitcnt vmcnt(6)
    v_dot2_f32_bf16 v34, v112, v28, 0
    v_dot2_f32_bf16 v34, v113, v29, v34
    v_dot2_f32_bf16 v34, v114, v30, v34
    v_dot2_f32_bf16 v34, v115, v31, v34
    s_cbranch_vccnz L_is209
    s_waitcnt vmcnt(5)
    s_cbranch_scc0 L_is209
    s_waitcnt vmcnt(4)
L_is209:
    buffer_load_dwordx4 v[112:115], v1, s[20:23], s44 offen offset:256 nt
    v_cvt_pk_bf16_f32 v40, v32, v33
    s_waitcnt vmcnt(6)
    v_dot2_f32_bf16 v35, v116, v28, 0
    v_dot2_f32_bf16 v35, v117, v29, v35
    v_dot2_f32_bf16 v35, v118, v30, v35
    v_dot2_f32_bf16 v35, v119, v31, v35
    s_cbranch_vccnz L_is210
    s_waitcnt vmcnt(5)
    s_cbranch_scc0 L_is210
    s_waitcnt vmcnt(4)
L_is210:
    buffer_load_dwordx4 v[116:119], v1, s[20:23], s44 offen offset:512 nt
    s_waitcnt lgkmcnt(0)
    v_readfirstlane_b32 s55, v2
    s_nop 1
    s_cmp_ge_u32 s55, 0x3400
    s_cselect_b32 s55, s55, 0
    s_bitcmp1_b32 s55, 1
    s_cselect_b64 vcc, -1, 0
    s_bitcmp1_b32 s55, 0
    s_waitcnt vmcnt(6)
    v_dot2_f32_bf16 v36, v96, v28, 0
    v_dot2_f32_bf16 v36, v97, v29, v36
    v_dot2_f32_bf16 v36, v98, v30, v36
    v_dot2_f32_bf16 v36, v99, v31, v36
    s_cbranch_vccnz L_is211
    s_waitcnt vmcnt(5)
    s_cbranch_scc0 L_is211
    s_waitcnt vmcnt(4)
L_is211:
    buffer_load_dwordx4 v[96:99], v1, s[20:23], s44 offen offset:768 nt
    v_mov_b32 v3, 51
    ds_write_b32 v9, v3 offset:31268
    v_cvt_pk_bf16_f32 v41, v34, v35
    s_waitcnt vmcnt(6)
    v_dot2_f32_bf16 v37, v100, v28, 0
    v_dot2_f32_bf16 v37, v101, v29, v37
    v_dot2_f32_bf16 v37, v102, v30, v37
    v_dot2_f32_bf16 v37, v103, v31, v37
    s_cbranch_vccnz L_is212
    s_waitcnt vmcnt(5)
    s_cbranch_scc0 L_is212
    s_waitcnt vmcnt(4)
L_is212:
    buffer_load_dwordx4 v[100:103], v1, s[20:23], s44 offen offset:1024 nt
    ds_read_b32 v2, v15 offset:31272
    s_waitcnt vmcnt(6)
    v_dot2_f32_bf16 v38, v104, v28, 0
    v_dot2_f32_bf16 v38, v105, v29, v38
    v_dot2_f32_bf16 v38, v106, v30, v38
    v_dot2_f32_bf16 v38, v107, v31, v38
    s_cbranch_vccnz L_is213
    s_waitcnt vmcnt(5)
    s_cbranch_scc0 L_is213
    s_waitcnt vmcnt(4)
L_is213:
    buffer_load_dwordx4 v[104:107], v1, s[20:23], s44 offen offset:1280 nt
    v_cvt_pk_bf16_f32 v42, v36, v37
    ds_read_b128 v[192:195], v208 offset:16384
    ds_read_b128 v[196:199], v208 offset:20480
    ds_read_b128 v[200:203], v208 offset:24576
    ds_read_b128 v[204:207], v208 offset:28672
    s_waitcnt vmcnt(6)
    v_dot2_f32_bf16 v39, v108, v28, 0
    v_dot2_f32_bf16 v39, v109, v29, v39
    v_dot2_f32_bf16 v39, v110, v30, v39
    v_dot2_f32_bf16 v39, v111, v31, v39
    s_cbranch_vccnz L_is214
    s_waitcnt vmcnt(5)
    s_cbranch_scc0 L_is214
    s_waitcnt vmcnt(4)
L_is214:
    buffer_load_dwordx4 v[108:111], v1, s[20:23], s44 offen offset:1536 nt
    s_waitcnt lgkmcnt(4)
    v_readfirstlane_b32 s55, v2
    s_nop 1
    s_cmp_ge_u32 s55, 0x3500
    s_cselect_b32 s55, s55, 0
    s_bitcmp1_b32 s55, 1
    s_cselect_b64 vcc, -1, 0
    s_bitcmp1_b32 s55, 0
    s_waitcnt vmcnt(6)
    v_dot2_f32_bf16 v32, v120, v28, 0
    v_dot2_f32_bf16 v32, v121, v29, v32
    v_dot2_f32_bf16 v32, v122, v30, v32
    v_dot2_f32_bf16 v32, v123, v31, v32
    s_cbranch_vccnz L_is215
    s_waitcnt vmcnt(5)
    s_cbranch_scc0 L_is215
    s_waitcnt vmcnt(4)
L_is215:
    buffer_load_dwordx4 v[120:123], v1, s[20:23], s44 offen offset:1792 nt
    v_mov_b32 v3, 52
    ds_write_b32 v9, v3 offset:31268
    v_cvt_pk_bf16_f32 v43, v38, v39
    s_waitcnt vmcnt(6)
    v_dot2_f32_bf16 v33, v112, v28, 0
    v_dot2_f32_bf16 v33, v113, v29, v33
    v_dot2_f32_bf16 v33, v114, v30, v33
    v_dot2_f32_bf16 v33, v115, v31, v33
    s_cbranch_vccnz L_is216
    s_waitcnt vmcnt(5)
    s_cbranch_scc0 L_is216
    s_waitcnt vmcnt(4)
L_is216:
    s_mov_b32 s44, 0xa0a0000
    buffer_load_dwordx4 v[112:115], v1, s[20:23], s44 offen offset:0 nt
    ds_read_b32 v2, v15 offset:31272
    s_waitcnt lgkmcnt(5)
    v_mfma_f32_16x16x32_bf16 v[80:83], v[192:195], v[40:43], v[80:83]
    s_waitcnt lgkmcnt(4)
    v_mfma_f32_16x16x32_bf16 v[84:87], v[196:199], v[40:43], v[84:87]
    s_waitcnt lgkmcnt(3)
    v_mfma_f32_16x16x32_bf16 v[88:91], v[200:203], v[40:43], v[88:91]
    s_waitcnt lgkmcnt(2)
    v_mfma_f32_16x16x32_bf16 v[92:95], v[204:207], v[40:43], v[92:95]
    s_waitcnt vmcnt(6)
    v_dot2_f32_bf16 v34, v116, v28, 0
    v_dot2_f32_bf16 v34, v117, v29, v34
    v_dot2_f32_bf16 v34, v118, v30, v34
    v_dot2_f32_bf16 v34, v119, v31, v34
    s_cbranch_vccnz L_is217
    s_waitcnt vmcnt(5)
    s_cbranch_scc0 L_is217
    s_waitcnt vmcnt(4)
L_is217:
    buffer_load_dwordx4 v[116:119], v1, s[20:23], s44 offen offset:256 nt
    v_cvt_pk_bf16_f32 v40, v32, v33
    s_waitcnt vmcnt(6)
    v_dot2_f32_bf16 v35, v96, v28, 0
    v_dot2_f32_bf16 v35, v97, v29, v35
    v_dot2_f32_bf16 v35, v98, v30, v35
    v_dot2_f32_bf16 v35, v99, v31, v35
    s_cbranch_vccnz L_is218
    s_waitcnt vmcnt(5)
    s_cbranch_scc0 L_is218
    s_waitcnt vmcnt(4)
L_is218:
    buffer_load_dwordx4 v[96:99], v1, s[20:23], s44 offen offset:512 nt
    s_waitcnt lgkmcnt(0)
    v_readfirstlane_b32 s55, v2
    s_nop 1
    s_cmp_ge_u32 s55, 0x3600
    s_cselect_b32 s55, s55, 0
    s_bitcmp1_b32 s55, 1
    s_cselect_b64 vcc, -1, 0
    s_bitcmp1_b32 s55, 0
    s_waitcnt vmcnt(6)
    v_dot2_f32_bf16 v36, v100, v28, 0
    v_dot2_f32_bf16 v36, v101, v29, v36
    v_dot2_f32_bf16 v36, v102, v30, v36
    v_dot2_f32_bf16 v36, v103, v31, v36
    s_cbranch_vccnz L_is219
    s_waitcnt vmcnt(5)
    s_cbranch_scc0 L_is219
    s_waitcnt vmcnt(4)
L_is219:
    buffer_load_dwordx4 v[100:103], v1, s[20:23], s44 offen offset:768 nt
    v_mov_b32 v3, 53
    ds_write_b32 v9, v3 offset:31268
    v_cvt_pk_bf16_f32 v41, v34, v35
    s_waitcnt vmcnt(6)
    v_dot2_f32_bf16 v37, v104, v28, 0
    v_dot2_f32_bf16 v37, v105, v29, v37
    v_dot2_f32_bf16 v37, v106, v30, v37
    v_dot2_f32_bf16 v37, v107, v31, v37
    s_cbranch_vccnz L_is220
    s_waitcnt vmcnt(5)
    s_cbranch_scc0 L_is220
    s_waitcnt vmcnt(4)
L_is220:
    buffer_load_dwordx4 v[104:107], v1, s[20:23], s44 offen offset:1024 nt
    ds_read_b32 v2, v15 offset:31272
    s_waitcnt vmcnt(6)
    v_dot2_f32_bf16 v38, v108, v28, 0
    v_dot2_f32_bf16 v38, v109, v29, v38
    v_dot2_f32_bf16 v38, v110, v30, v38
    v_dot2_f32_bf16 v38, v111, v31, v38
    s_cbranch_vccnz L_is221
    s_waitcnt vmcnt(5)
    s_cbranch_scc0 L_is221
    s_waitcnt vmcnt(4)
L_is221:
    buffer_load_dwordx4 v[108:111], v1, s[20:23], s44 offen offset:1280 nt
    v_cvt_pk_bf16_f32 v42, v36, v37
    ds_read_b128 v[192:195], v208 offset:32768
    ds_read_b128 v[196:199], v208 offset:36864
    ds_read_b128 v[200:203], v208 offset:40960
    ds_read_b128 v[204:207], v208 offset:45056
    s_waitcnt vmcnt(6)
    v_dot2_f32_bf16 v39, v120, v28, 0
    v_dot2_f32_bf16 v39, v121, v29, v39
    v_dot2_f32_bf16 v39, v122, v30, v39
    v_dot2_f32_bf16 v39, v123, v31, v39
    s_cbranch_vccnz L_is222
    s_waitcnt vmcnt(5)
    s_cbranch_scc0 L_is222
    s_waitcnt vmcnt(4)
L_is222:
    buffer_load_dwordx4 v[120:123], v1, s[20:23], s44 offen offset:1536 nt
    s_waitcnt lgkmcnt(4)
    v_readfirstlane_b32 s55, v2
    s_nop 1
    s_cmp_ge_u32 s55, 0x3700
    s_cselect_b32 s55, s55, 0
    s_bitcmp1_b32 s55, 1
    s_cselect_b64 vcc, -1, 0
    s_bitcmp1_b32 s55, 0
    s_waitcnt vmcnt(6)
    v_dot2_f32_bf16 v32, v112, v28, 0
    v_dot2_f32_bf16 v32, v113, v29, v32
    v_dot2_f32_bf16 v32, v114, v30, v32
    v_dot2_f32_bf16 v32, v115, v31, v32
    s_cbranch_vccnz L_is223
    s_waitcnt vmcnt(5)
    s_cbranch_scc0 L_is223
    s_waitcnt vmcnt(4)
L_is223:
    buffer_load_dwordx4 v[112:115], v1, s[20:23], s44 offen offset:1792 nt
    v_mov_b32 v3, 54
    ds_write_b32 v9, v3 offset:31268
    v_cvt_pk_bf16_f32 v43, v38, v39
    s_waitcnt vmcnt(6)
    v_dot2_f32_bf16 v33, v116, v28, 0
    v_dot2_f32_bf16 v33, v117, v29, v33
    v_dot2_f32_bf16 v33, v118, v30, v33
    v_dot2_f32_bf16 v33, v119, v31, v33
    s_cbranch_vccnz L_is224
    s_waitcnt vmcnt(5)
    s_cbranch_scc0 L_is224
    s_waitcnt vmcnt(4)
L_is224:
    s_mov_b32 s44, 0xa100000
    buffer_load_dwordx4 v[116:119], v1, s[20:23], s44 offen offset:0 nt
    ds_read_b32 v2, v15 offset:31272
    s_waitcnt lgkmcnt(5)
    v_mfma_f32_16x16x32_bf16 v[80:83], v[192:195], v[40:43], v[80:83]
    s_waitcnt lgkmcnt(4)
    v_mfma_f32_16x16x32_bf16 v[84:87], v[196:199], v[40:43], v[84:87]
    s_waitcnt lgkmcnt(3)
    v_mfma_f32_16x16x32_bf16 v[88:91], v[200:203], v[40:43], v[88:91]
    s_waitcnt lgkmcnt(2)
    v_mfma_f32_16x16x32_bf16 v[92:95], v[204:207], v[40:43], v[92:95]
    s_waitcnt vmcnt(6)
    v_dot2_f32_bf16 v34, v96, v28, 0
    v_dot2_f32_bf16 v34, v97, v29, v34
    v_dot2_f32_bf16 v34, v98, v30, v34
    v_dot2_f32_bf16 v34, v99, v31, v34
    s_cbranch_vccnz L_is225
    s_waitcnt vmcnt(5)
    s_cbranch_scc0 L_is225
    s_waitcnt vmcnt(4)
L_is225:
    buffer_load_dwordx4 v[96:99], v1, s[20:23], s44 offen offset:256 nt
    v_cvt_pk_bf16_f32 v40, v32, v33
    s_waitcnt vmcnt(6)
    v_dot2_f32_bf16 v35, v100, v28, 0
    v_dot2_f32_bf16 v35, v101, v29, v35
    v_dot2_f32_bf16 v35, v102, v30, v35
    v_dot2_f32_bf16 v35, v103, v31, v35
    s_cbranch_vccnz L_is226
    s_waitcnt vmcnt(5)
    s_cbranch_scc0 L_is226
    s_waitcnt vmcnt(4)
L_is226:
    buffer_load_dwordx4 v[100:103], v1, s[20:23], s44 offen offset:512 nt
    s_waitcnt lgkmcnt(0)
    v_readfirstlane_b32 s55, v2
    s_nop 1
    s_cmp_ge_u32 s55, 0x3800
    s_cselect_b32 s55, s55, 0
    s_bitcmp1_b32 s55, 1
    s_cselect_b64 vcc, -1, 0
    s_bitcmp1_b32 s55, 0
    s_waitcnt vmcnt(6)
    v_dot2_f32_bf16 v36, v104, v28, 0
    v_dot2_f32_bf16 v36, v105, v29, v36
    v_dot2_f32_bf16 v36, v106, v30, v36
    v_dot2_f32_bf16 v36, v107, v31, v36
    s_cbranch_vccnz L_is227
    s_waitcnt vmcnt(5)
    s_cbranch_scc0 L_is227
    s_waitcnt vmcnt(4)
L_is227:
    buffer_load_dwordx4 v[104:107], v1, s[20:23], s44 offen offset:768 nt
    v_mov_b32 v3, 55
    ds_write_b32 v9, v3 offset:31268
    v_cvt_pk_bf16_f32 v41, v34, v35
    s_waitcnt vmcnt(6)
    v_dot2_f32_bf16 v37, v108, v28, 0
    v_dot2_f32_bf16 v37, v109, v29, v37
    v_dot2_f32_bf16 v37, v110, v30, v37
    v_dot2_f32_bf16 v37, v111, v31, v37
    s_cbranch_vccnz L_is228
    s_waitcnt vmcnt(5)
    s_cbranch_scc0 L_is228
    s_waitcnt vmcnt(4)
L_is228:
    buffer_load_dwordx4 v[108:111], v1, s[20:23], s44 offen offset:1024 nt
    ds_read_b32 v2, v15 offset:31272
    s_waitcnt vmcnt(6)
    v_dot2_f32_bf16 v38, v120, v28, 0
    v_dot2_f32_bf16 v38, v121, v29, v38
    v_dot2_f32_bf16 v38, v122, v30, v38
    v_dot2_f32_bf16 v38, v123, v31, v38
    s_cbranch_vccnz L_is229
    s_waitcnt vmcnt(5)
    s_cbranch_scc0 L_is229
    s_waitcnt vmcnt(4)
L_is229:
    buffer_load_dwordx4 v[120:123], v1, s[20:23], s44 offen offset:1280 nt
    v_cvt_pk_bf16_f32 v42, v36, v37
    ds_read_b128 v[192:195], v208 offset:49152
    ds_read_b128 v[196:199], v208 offset:53248
    ds_read_b128 v[200:203], v208 offset:57344
    ds_read_b128 v[204:207], v208 offset:61440
    s_waitcnt vmcnt(6)
    v_dot2_f32_bf16 v39, v112, v28, 0
    v_dot2_f32_bf16 v39, v113, v29, v39
    v_dot2_f32_bf16 v39, v114, v30, v39
    v_dot2_f32_bf16 v39, v115, v31, v39
    s_cbranch_vccnz L_is230
    s_waitcnt vmcnt(5)
    s_cbranch_scc0 L_is230
    s_waitcnt vmcnt(4)
L_is230:
    buffer_load_dwordx4 v[112:115], v1, s[20:23], s44 offen offset:1536 nt
    s_waitcnt lgkmcnt(4)
    v_readfirstlane_b32 s55, v2
    s_nop 1
    s_cmp_ge_u32 s55, 0x3900
    s_cselect_b32 s55, s55, 0
    s_bitcmp1_b32 s55, 1
    s_cselect_b64 vcc, -1, 0
    s_bitcmp1_b32 s55, 0
    s_waitcnt vmcnt(6)
    v_dot2_f32_bf16 v32, v116, v28, 0
    v_dot2_f32_bf16 v32, v117, v29, v32
    v_dot2_f32_bf16 v32, v118, v30, v32
    v_dot2_f32_bf16 v32, v119, v31, v32
    s_cbranch_vccnz L_is231
    s_waitcnt vmcnt(5)
    s_cbranch_scc0 L_is231
    s_waitcnt vmcnt(4)
L_is231:
    buffer_load_dwordx4 v[116:119], v1, s[20:23], s44 offen offset:1792 nt
    v_mov_b32 v3, 56
    ds_write_b32 v9, v3 offset:31268
    v_cvt_pk_bf16_f32 v43, v38, v39
    s_waitcnt vmcnt(6)
    v_dot2_f32_bf16 v33, v96, v28, 0
    v_dot2_f32_bf16 v33, v97, v29, v33
    v_dot2_f32_bf16 v33, v98, v30, v33
    v_dot2_f32_bf16 v33, v99, v31, v33
    s_cbranch_vccnz L_is232
    s_waitcnt vmcnt(5)
    s_cbranch_scc0 L_is232
    s_waitcnt vmcnt(4)
L_is232:
    s_mov_b32 s44, 0xa120000
    buffer_load_dwordx4 v[96:99], v1, s[20:23], s44 offen offset:0 nt
    ds_read_b32 v2, v15 offset:31272
    s_waitcnt lgkmcnt(5)
    v_mfma_f32_16x16x32_bf16 v[80:83], v[192:195], v[40:43], v[80:83]
    s_waitcnt lgkmcnt(4)
    v_mfma_f32_16x16x32_bf16 v[84:87], v[196:199], v[40:43], v[84:87]
    s_waitcnt lgkmcnt(3)
    v_mfma_f32_16x16x32_bf16 v[88:91], v[200:203], v[40:43], v[88:91]
    s_waitcnt lgkmcnt(2)
    v_mfma_f32_16x16x32_bf16 v[92:95], v[204:207], v[40:43], v[92:95]
    s_waitcnt vmcnt(6)
    v_dot2_f32_bf16 v34, v100, v28, 0
    v_dot2_f32_bf16 v34, v101, v29, v34
    v_dot2_f32_bf16 v34, v102, v30, v34
    v_dot2_f32_bf16 v34, v103, v31, v34
    s_cbranch_vccnz L_is233
    s_waitcnt vmcnt(5)
    s_cbranch_scc0 L_is233
    s_waitcnt vmcnt(4)
L_is233:
    buffer_load_dwordx4 v[100:103], v1, s[20:23], s44 offen offset:256 nt
    v_cvt_pk_bf16_f32 v40, v32, v33
    s_waitcnt vmcnt(6)
    v_dot2_f32_bf16 v35, v104, v28, 0
    v_dot2_f32_bf16 v35, v105, v29, v35
    v_dot2_f32_bf16 v35, v106, v30, v35
    v_dot2_f32_bf16 v35, v107, v31, v35
    s_cbranch_vccnz L_is234
    s_waitcnt vmcnt(5)
    s_cbranch_scc0 L_is234
    s_waitcnt vmcnt(4)
L_is234:
    buffer_load_dwordx4 v[104:107], v1, s[20:23], s44 offen offset:512 nt
    s_waitcnt lgkmcnt(0)
    v_readfirstlane_b32 s55, v2
    s_nop 1
    s_cmp_ge_u32 s55, 0x3a00
    s_cselect_b32 s55, s55, 0
    s_bitcmp1_b32 s55, 1
    s_cselect_b64 vcc, -1, 0
    s_bitcmp1_b32 s55, 0
    s_waitcnt vmcnt(6)
    v_dot2_f32_bf16 v36, v108, v28, 0
    v_dot2_f32_bf16 v36, v109, v29, v36
    v_dot2_f32_bf16 v36, v110, v30, v36
    v_dot2_f32_bf16 v36, v111, v31, v36
    s_cbranch_vccnz L_is235
    s_waitcnt vmcnt(5)
    s_cbranch_scc0 L_is235
    s_waitcnt vmcnt(4)
L_is235:
    buffer_load_dwordx4 v[108:111], v1, s[20:23], s44 offen offset:768 nt
    v_mov_b32 v3, 57
    ds_write_b32 v9, v3 offset:31268
    v_cvt_pk_bf16_f32 v41, v34, v35
    s_waitcnt vmcnt(6)
    v_dot2_f32_bf16 v37, v120, v28, 0
    v_dot2_f32_bf16 v37, v121, v29, v37
    v_dot2_f32_bf16 v37, v122, v30, v37
    v_dot2_f32_bf16 v37, v123, v31, v37
    s_cbranch_vccnz L_is236
    s_waitcnt vmcnt(5)
    s_cbranch_scc0 L_is236
    s_waitcnt vmcnt(4)
L_is236:
    buffer_load_dwordx4 v[120:123], v1, s[20:23], s44 offen offset:1024 nt
    ds_read_b32 v2, v15 offset:31272
    s_waitcnt vmcnt(6)
    v_dot2_f32_bf16 v38, v112, v28, 0
    v_dot2_f32_bf16 v38, v113, v29, v38
    v_dot2_f32_bf16 v38, v114, v30, v38
    v_dot2_f32_bf16 v38, v115, v31, v38
    s_cbranch_vccnz L_is237
    s_waitcnt vmcnt(5)
    s_cbranch_scc0 L_is237
    s_waitcnt vmcnt(4)
L_is237:
    buffer_load_dwordx4 v[112:115], v1, s[20:23], s44 offen offset:1280 nt
    v_cvt_pk_bf16_f32 v42, v36, v37
    ds_read_b128 v[192:195], v209 offset:0
    ds_read_b128 v[196:199], v209 offset:4096
    ds_read_b128 v[200:203], v209 offset:8192
    ds_read_b128 v[204:207], v209 offset:12288
    s_waitcnt vmcnt(6)
    v_dot2_f32_bf16 v39, v116, v28, 0
    v_dot2_f32_bf16 v39, v117, v29, v39
    v_dot2_f32_bf16 v39, v118, v30, v39
    v_dot2_f32_bf16 v39, v119, v31, v39
    s_cbranch_vccnz L_is238
    s_waitcnt vmcnt(5)
    s_cbranch_scc0 L_is238
    s_waitcnt vmcnt(4)
L_is238:
    buffer_load_dwordx4 v[116:119], v1, s[20:23], s44 offen offset:1536 nt
    s_waitcnt lgkmcnt(4)
    v_readfirstlane_b32 s55, v2
    s_nop 1
    s_cmp_ge_u32 s55, 0x3b00
    s_cselect_b32 s55, s55, 0
    s_bitcmp1_b32 s55, 1
    s_cselect_b64 vcc, -1, 0
    s_bitcmp1_b32 s55, 0
    s_waitcnt vmcnt(6)
    v_dot2_f32_bf16 v32, v96, v28, 0
    v_dot2_f32_bf16 v32, v97, v29, v32
    v_dot2_f32_bf16 v32, v98, v30, v32
    v_dot2_f32_bf16 v32, v99, v31, v32
    s_cbranch_vccnz L_is239
    s_waitcnt vmcnt(5)
    s_cbranch_scc0 L_is239
    s_waitcnt vmcnt(4)
L_is239:
    buffer_load_dwordx4 v[96:99], v1, s[20:23], s44 offen offset:1792 nt
    v_mov_b32 v3, 58
    ds_write_b32 v9, v3 offset:31268
    v_cvt_pk_bf16_f32 v43, v38, v39
    s_waitcnt vmcnt(6)
    v_dot2_f32_bf16 v33, v100, v28, 0
    v_dot2_f32_bf16 v33, v101, v29, v33
    v_dot2_f32_bf16 v33, v102, v30, v33
    v_dot2_f32_bf16 v33, v103, v31, v33
    s_cbranch_vccnz L_is240
    s_waitcnt vmcnt(5)
    s_cbranch_scc0 L_is240
    s_waitcnt vmcnt(4)
L_is240:
    s_mov_b32 s44, 0xa180000
    buffer_load_dwordx4 v[100:103], v1, s[20:23], s44 offen offset:0 nt
    ds_read_b32 v2, v15 offset:31272
    s_waitcnt lgkmcnt(5)
    v_mfma_f32_16x16x32_bf16 v[80:83], v[192:195], v[40:43], v[80:83]
    s_waitcnt lgkmcnt(4)
    v_mfma_f32_16x16x32_bf16 v[84:87], v[196:199], v[40:43], v[84:87]
    s_waitcnt lgkmcnt(3)
    v_mfma_f32_16x16x32_bf16 v[88:91], v[200:203], v[40:43], v[88:91]
    s_waitcnt lgkmcnt(2)
    v_mfma_f32_16x16x32_bf16 v[92:95], v[204:207], v[40:43], v[92:95]
    s_waitcnt vmcnt(6)
    v_dot2_f32_bf16 v34, v104, v28, 0
    v_dot2_f32_bf16 v34, v105, v29, v34
    v_dot2_f32_bf16 v34, v106, v30, v34
    v_dot2_f32_bf16 v34, v107, v31, v34
    s_cbranch_vccnz L_is241
    s_waitcnt vmcnt(5)
    s_cbranch_scc0 L_is241
    s_waitcnt vmcnt(4)
L_is241:
    buffer_load_dwordx4 v[104:107], v1, s[20:23], s44 offen offset:256 nt
    v_cvt_pk_bf16_f32 v40, v32, v33
    s_waitcnt vmcnt(6)
    v_dot2_f32_bf16 v35, v108, v28, 0
    v_dot2_f32_bf16 v35, v109, v29, v35
    v_dot2_f32_bf16 v35, v110, v30, v35
    v_dot2_f32_bf16 v35, v111, v31, v35
    s_cbranch_vccnz L_is242
    s_waitcnt vmcnt(5)
    s_cbranch_scc0 L_is242
    s_waitcnt vmcnt(4)
L_is242:
    buffer_load_dwordx4 v[108:111], v1, s[20:23], s44 offen offset:512 nt
    s_waitcnt lgkmcnt(0)
    v_readfirstlane_b32 s55, v2
    s_nop 1
    s_cmp_ge_u32 s55, 0x3c00
    s_cselect_b32 s55, s55, 0
    s_bitcmp1_b32 s55, 1
    s_cselect_b64 vcc, -1, 0
    s_bitcmp1_b32 s55, 0
    s_waitcnt vmcnt(6)
    v_dot2_f32_bf16 v36, v120, v28, 0
    v_dot2_f32_bf16 v36, v121, v29, v36
    v_dot2_f32_bf16 v36, v122, v30, v36
    v_dot2_f32_bf16 v36, v123, v31, v36
    s_cbranch_vccnz L_is243
    s_waitcnt vmcnt(5)
    s_cbranch_scc0 L_is243
    s_waitcnt vmcnt(4)
L_is243:
    buffer_load_dwordx4 v[120:123], v1, s[20:23], s44 offen offset:768 nt
    v_mov_b32 v3, 59
    ds_write_b32 v9, v3 offset:31268
    v_cvt_pk_bf16_f32 v41, v34, v35
    s_waitcnt vmcnt(6)
    v_dot2_f32_bf16 v37, v112, v28, 0
    v_dot2_f32_bf16 v37, v113, v29, v37
    v_dot2_f32_bf16 v37, v114, v30, v37
    v_dot2_f32_bf16 v37, v115, v31, v37
    s_cbranch_vccnz L_is244
    s_waitcnt vmcnt(5)
    s_cbranch_scc0 L_is244
    s_waitcnt vmcnt(4)
L_is244:
    buffer_load_dwordx4 v[112:115], v1, s[20:23], s44 offen offset:1024 nt
    ds_read_b32 v2, v15 offset:31272
    s_waitcnt vmcnt(6)
    v_dot2_f32_bf16 v38, v116, v28, 0
    v_dot2_f32_bf16 v38, v117, v29, v38
    v_dot2_f32_bf16 v38, v118, v30, v38
    v_dot2_f32_bf16 v38, v119, v31, v38
    s_cbranch_vccnz L_is245
    s_waitcnt vmcnt(5)
    s_cbranch_scc0 L_is245
    s_waitcnt vmcnt(4)
L_is245:
    buffer_load_dwordx4 v[116:119], v1, s[20:23], s44 offen offset:1280 nt
    v_cvt_pk_bf16_f32 v42, v36, v37
    ds_read_b128 v[192:195], v209 offset:16384
    ds_read_b128 v[196:199], v209 offset:20480
    ds_read_b128 v[200:203], v209 offset:24576
    ds_read_b128 v[204:207], v209 offset:28672
    s_waitcnt vmcnt(6)
    v_dot2_f32_bf16 v39, v96, v28, 0
    v_dot2_f32_bf16 v39, v97, v29, v39
    v_dot2_f32_bf16 v39, v98, v30, v39
    v_dot2_f32_bf16 v39, v99, v31, v39
    s_cbranch_vccnz L_is246
    s_waitcnt vmcnt(5)
    s_cbranch_scc0 L_is246
    s_waitcnt vmcnt(4)
L_is246:
    buffer_load_dwordx4 v[96:99], v1, s[20:23], s44 offen offset:1536 nt
    s_waitcnt lgkmcnt(4)
    v_readfirstlane_b32 s55, v2
    s_nop 1
    s_cmp_ge_u32 s55, 0x3d00
    s_cselect_b32 s55, s55, 0
    s_bitcmp1_b32 s55, 1
    s_cselect_b64 vcc, -1, 0
    s_bitcmp1_b32 s55, 0
    s_waitcnt vmcnt(6)
    v_dot2_f32_bf16 v32, v100, v28, 0
    v_dot2_f32_bf16 v32, v101, v29, v32
    v_dot2_f32_bf16 v32, v102, v30, v32
    v_dot2_f32_bf16 v32, v103, v31, v32
    s_cbranch_vccnz L_is247
    s_waitcnt vmcnt(5)
    s_cbranch_scc0 L_is247
    s_waitcnt vmcnt(4)
L_is247:
    buffer_load_dwordx4 v[100:103], v1, s[20:23], s44 offen offset:1792 nt
    v_mov_b32 v3, 60
    ds_write_b32 v9, v3 offset:31268
    v_cvt_pk_bf16_f32 v43, v38, v39
    s_waitcnt vmcnt(6)
    v_dot2_f32_bf16 v33, v104, v28, 0
    v_dot2_f32_bf16 v33, v105, v29, v33
    v_dot2_f32_bf16 v33, v106, v30, v33
    v_dot2_f32_bf16 v33, v107, v31, v33
    s_cbranch_vccnz L_is248
    s_waitcnt vmcnt(5)
    s_cbranch_scc0 L_is248
    s_waitcnt vmcnt(4)
L_is248:
    s_mov_b32 s44, 0xa1a0000
    buffer_load_dwordx4 v[104:107], v1, s[20:23], s44 offen offset:0 nt
    ds_read_b32 v2, v15 offset:31272
    s_waitcnt lgkmcnt(5)
    v_mfma_f32_16x16x32_bf16 v[80:83], v[192:195], v[40:43], v[80:83]
    s_waitcnt lgkmcnt(4)
    v_mfma_f32_16x16x32_bf16 v[84:87], v[196:199], v[40:43], v[84:87]
    s_waitcnt lgkmcnt(3)
    v_mfma_f32_16x16x32_bf16 v[88:91], v[200:203], v[40:43], v[88:91]
    s_waitcnt lgkmcnt(2)
    v_mfma_f32_16x16x32_bf16 v[92:95], v[204:207], v[40:43], v[92:95]
    s_waitcnt vmcnt(6)
    v_dot2_f32_bf16 v34, v108, v28, 0
    v_dot2_f32_bf16 v34, v109, v29, v34
    v_dot2_f32_bf16 v34, v110, v30, v34
    v_dot2_f32_bf16 v34, v111, v31, v34
    s_cbranch_vccnz L_is249
    s_waitcnt vmcnt(5)
    s_cbranch_scc0 L_is249
    s_waitcnt vmcnt(4)
L_is249:
    buffer_load_dwordx4 v[108:111], v1, s[20:23], s44 offen offset:256 nt
    v_cvt_pk_bf16_f32 v40, v32, v33
    s_waitcnt vmcnt(6)
    v_dot2_f32_bf16 v35, v120, v28, 0
    v_dot2_f32_bf16 v35, v121, v29, v35
    v_dot2_f32_bf16 v35, v122, v30, v35
    v_dot2_f32_bf16 v35, v123, v31, v35
    s_cbranch_vccnz L_is250
    s_waitcnt vmcnt(5)
    s_cbranch_scc0 L_is250
    s_waitcnt vmcnt(4)
L_is250:
    buffer_load_dwordx4 v[120:123], v1, s[20:23], s44 offen offset:512 nt
    s_waitcnt lgkmcnt(0)
    v_readfirstlane_b32 s55, v2
    s_nop 1
    s_cmp_ge_u32 s55, 0x3e00
    s_cselect_b32 s55, s55, 0
    s_bitcmp1_b32 s55, 1
    s_cselect_b64 vcc, -1, 0
    s_bitcmp1_b32 s55, 0
    s_waitcnt vmcnt(6)
    v_dot2_f32_bf16 v36, v112, v28, 0
    v_dot2_f32_bf16 v36, v113, v29, v36
    v_dot2_f32_bf16 v36, v114, v30, v36
    v_dot2_f32_bf16 v36, v115, v31, v36
    s_cbranch_vccnz L_is251
    s_waitcnt vmcnt(5)
    s_cbranch_scc0 L_is251
    s_waitcnt vmcnt(4)
L_is251:
    buffer_load_dwordx4 v[112:115], v1, s[20:23], s44 offen offset:768 nt
    v_mov_b32 v3, 61
    ds_write_b32 v9, v3 offset:31268
    v_cvt_pk_bf16_f32 v41, v34, v35
    s_waitcnt vmcnt(6)
    v_dot2_f32_bf16 v37, v116, v28, 0
    v_dot2_f32_bf16 v37, v117, v29, v37
    v_dot2_f32_bf16 v37, v118, v30, v37
    v_dot2_f32_bf16 v37, v119, v31, v37
    s_cbranch_vccnz L_is252
    s_waitcnt vmcnt(5)
    s_cbranch_scc0 L_is252
    s_waitcnt vmcnt(4)
L_is252:
    buffer_load_dwordx4 v[116:119], v1, s[20:23], s44 offen offset:1024 nt
    ds_read_b32 v2, v15 offset:31272
    s_waitcnt vmcnt(6)
    v_dot2_f32_bf16 v38, v96, v28, 0
    v_dot2_f32_bf16 v38, v97, v29, v38
    v_dot2_f32_bf16 v38, v98, v30, v38
    v_dot2_f32_bf16 v38, v99, v31, v38
    s_cbranch_vccnz L_is253
    s_waitcnt vmcnt(5)
    s_cbranch_scc0 L_is253
    s_waitcnt vmcnt(4)
L_is253:
    buffer_load_dwordx4 v[96:99], v1, s[20:23], s44 offen offset:1280 nt
    v_cvt_pk_bf16_f32 v42, v36, v37
    ds_read_b128 v[192:195], v209 offset:32768
    ds_read_b128 v[196:199], v209 offset:36864
    ds_read_b128 v[200:203], v209 offset:40960
    ds_read_b128 v[204:207], v209 offset:45056
    s_waitcnt vmcnt(6)
    v_dot2_f32_bf16 v39, v100, v28, 0
    v_dot2_f32_bf16 v39, v101, v29, v39
    v_dot2_f32_bf16 v39, v102, v30, v39
    v_dot2_f32_bf16 v39, v103, v31, v39
    s_cbranch_vccnz L_is254
    s_waitcnt vmcnt(5)
    s_cbranch_scc0 L_is254
    s_waitcnt vmcnt(4)
L_is254:
    buffer_load_dwordx4 v[100:103], v1, s[20:23], s44 offen offset:1536 nt
    s_waitcnt lgkmcnt(4)
    v_readfirstlane_b32 s55, v2
    s_nop 1
    s_cmp_ge_u32 s55, 0x3f00
    s_cselect_b32 s55, s55, 0
    s_bitcmp1_b32 s55, 1
    s_cselect_b64 vcc, -1, 0
    s_bitcmp1_b32 s55, 0
    s_waitcnt vmcnt(6)
    v_dot2_f32_bf16 v32, v104, v28, 0
    v_dot2_f32_bf16 v32, v105, v29, v32
    v_dot2_f32_bf16 v32, v106, v30, v32
    v_dot2_f32_bf16 v32, v107, v31, v32
    s_cbranch_vccnz L_is255
    s_waitcnt vmcnt(5)
    s_cbranch_scc0 L_is255
    s_waitcnt vmcnt(4)
L_is255:
    buffer_load_dwordx4 v[104:107], v1, s[20:23], s44 offen offset:1792 nt
    v_mov_b32 v3, 62
    ds_write_b32 v9, v3 offset:31268
    v_cvt_pk_bf16_f32 v43, v38, v39
    s_waitcnt vmcnt(6)
    v_dot2_f32_bf16 v33, v108, v28, 0
    v_dot2_f32_bf16 v33, v109, v29, v33
    v_dot2_f32_bf16 v33, v110, v30, v33
    v_dot2_f32_bf16 v33, v111, v31, v33
    s_cbranch_vccnz L_is256
    s_waitcnt vmcnt(5)
    s_cbranch_scc0 L_is256
    s_waitcnt vmcnt(4)
L_is256:
    s_mov_b32 s44, 0x0
    buffer_load_dwordx4 v[108:111], v1, s[24:27], s44 offen offset:0 nt
    ds_read_b32 v2, v15 offset:31272
    s_waitcnt lgkmcnt(5)
    v_mfma_f32_16x16x32_bf16 v[80:83], v[192:195], v[40:43], v[80:83]
    s_waitcnt lgkmcnt(4)
    v_mfma_f32_16x16x32_bf16 v[84:87], v[196:199], v[40:43], v[84:87]
    s_waitcnt lgkmcnt(3)
    v_mfma_f32_16x16x32_bf16 v[88:91], v[200:203], v[40:43], v[88:91]
    s_waitcnt lgkmcnt(2)
    v_mfma_f32_16x16x32_bf16 v[92:95], v[204:207], v[40:43], v[92:95]
    s_waitcnt vmcnt(6)
    v_dot2_f32_bf16 v34, v120, v28, 0
    v_dot2_f32_bf16 v34, v121, v29, v34
    v_dot2_f32_bf16 v34, v122, v30, v34
    v_dot2_f32_bf16 v34, v123, v31, v34
    s_cbranch_vccnz L_is257
    s_waitcnt vmcnt(5)
    s_cbranch_scc0 L_is257
    s_waitcnt vmcnt(4)
L_is257:
    buffer_load_dwordx4 v[120:123], v1, s[24:27], s44 offen offset:256 nt
    v_cvt_pk_bf16_f32 v40, v32, v33
    ds_read_b128 v[60:63], v15 offset:31232
    s_waitcnt vmcnt(6)
    v_dot2_f32_bf16 v35, v112, v28, 0
    v_dot2_f32_bf16 v35, v113, v29, v35
    v_dot2_f32_bf16 v35, v114, v30, v35
    v_dot2_f32_bf16 v35, v115, v31, v35
    s_cbranch_vccnz L_is258
    s_waitcnt vmcnt(5)
    s_cbranch_scc0 L_is258
    s_waitcnt vmcnt(4)
L_is258:
    buffer_load_dwordx4 v[112:115], v1, s[24:27], s44 offen offset:512 nt
    s_waitcnt lgkmcnt(1)
    v_readfirstlane_b32 s55, v2
    s_nop 1
    s_cmp_ge_u32 s55, 0x4000
    s_cselect_b32 s55, s55, 0
    s_bitcmp1_b32 s55, 1
    s_cselect_b64 vcc, -1, 0
    s_bitcmp1_b32 s55, 0
    s_waitcnt vmcnt(6)
    v_dot2_f32_bf16 v36, v116, v28, 0
    v_dot2_f32_bf16 v36, v117, v29, v36
    v_dot2_f32_bf16 v36, v118, v30, v36
    v_dot2_f32_bf16 v36, v119, v31, v36
    s_cbranch_vccnz L_is259
    s_waitcnt vmcnt(5)
    s_cbranch_scc0 L_is259
    s_waitcnt vmcnt(4)
L_is259:
    buffer_load_dwordx4 v[116:119], v1, s[24:27], s44 offen offset:768 nt
    v_mov_b32 v3, 63
    ds_write_b32 v9, v3 offset:31268
    v_cvt_pk_bf16_f32 v41, v34, v35
    s_waitcnt vmcnt(6)
    v_dot2_f32_bf16 v37, v96, v28, 0
    v_dot2_f32_bf16 v37, v97, v29, v37
    v_dot2_f32_bf16 v37, v98, v30, v37
    v_dot2_f32_bf16 v37, v99, v31, v37
    s_cbranch_vccnz L_is260
    s_waitcnt vmcnt(5)
    s_cbranch_scc0 L_is260
    s_waitcnt vmcnt(4)
L_is260:
    buffer_load_dwordx4 v[96:99], v1, s[24:27], s44 offen offset:1024 nt
    ds_read_b32 v2, v15 offset:31272
    s_waitcnt lgkmcnt(2)
L_wchk0:
    v_and_b32 v60, v60, v61
    v_and_b32 v62, v62, v63
    v_and_b32 v60, v60, v62
    s_nop 0
    v_readfirstlane_b32 s55, v60
    s_nop 1
    s_cmp_lg_u32 s55, 0
    s_cbranch_scc1 L_wok0
    s_sleep 2
    ds_read_b128 v[60:63], v15 offset:31232
    s_waitcnt lgkmcnt(0)
    s_branch L_wchk0
L_wok0:
    s_cmp_lg_u32 0, 0
    ds_read_b128 v[60:63], v5 offset:0
    s_waitcnt vmcnt(6)
    v_dot2_f32_bf16 v38, v100, v28, 0
    v_dot2_f32_bf16 v38, v101, v29, v38
    v_dot2_f32_bf16 v38, v102, v30, v38
    v_dot2_f32_bf16 v38, v103, v31, v38
    s_cbranch_vccnz L_is261
    s_waitcnt vmcnt(5)
    s_cbranch_scc0 L_is261
    s_waitcnt vmcnt(4)
L_is261:
    buffer_load_dwordx4 v[100:103], v1, s[24:27], s44 offen offset:1280 nt
    v_cvt_pk_bf16_f32 v42, v36, v37
    ds_read_b128 v[192:195], v209 offset:49152
    ds_read_b128 v[196:199], v209 offset:53248
    ds_read_b128 v[200:203], v209 offset:57344
    ds_read_b128 v[204:207], v209 offset:61440
    s_waitcnt vmcnt(6)
    v_dot2_f32_bf16 v39, v104, v28, 0
    v_dot2_f32_bf16 v39, v105, v29, v39
    v_dot2_f32_bf16 v39, v106, v30, v39
    v_dot2_f32_bf16 v39, v107, v31, v39
    s_cbranch_vccnz L_is262
    s_waitcnt vmcnt(5)
    s_cbranch_scc0 L_is262
    s_waitcnt vmcnt(4)
L_is262:
    buffer_load_dwordx4 v[104:107], v1, s[24:27], s44 offen offset:1536 nt
    s_waitcnt lgkmcnt(5)
    v_readfirstlane_b32 s55, v2
    s_nop 1
    s_cmp_ge_u32 s55, 0x4100
    s_cselect_b32 s55, s55, 0
    s_bitcmp1_b32 s55, 1
    s_cselect_b64 vcc, -1, 0
    s_bitcmp1_b32 s55, 0
    s_waitcnt lgkmcnt(4)
    v_perm_b32 v52, v60, v60, v44
    v_perm_b32 v53, v60, v60, v45
    v_perm_b32 v54, v60, v60, v46
    v_perm_b32 v55, v60, v60, v47
    s_waitcnt vmcnt(6)
    s_nop 0
    v_mfma_f32_16x16x32_bf16 v[16:19], v[52:55], v[108:111], 0
    s_cbranch_vccnz L_is263
    s_waitcnt vmcnt(5)
    s_cbranch_scc0 L_is263
    s_waitcnt vmcnt(4)
L_is263:
    buffer_load_dwordx4 v[108:111], v1, s[24:27], s44 offen offset:1792 nt
    v_mov_b32 v3, 64
    ds_write_b32 v9, v3 offset:31268
    v_cvt_pk_bf16_f32 v43, v38, v39
    v_perm_b32 v56, v60, v60, v48
    v_perm_b32 v57, v60, v60, v49
    v_perm_b32 v58, v60, v60, v50
    v_perm_b32 v59, v60, v60, v51
    s_waitcnt vmcnt(6)
    s_nop 0
    v_mfma_f32_16x16x32_bf16 v[16:19], v[56:59], v[120:123], v[16:19]
    s_cbranch_vccnz L_is264
    s_waitcnt vmcnt(5)
    s_cbranch_scc0 L_is264
    s_waitcnt vmcnt(4)
L_is264:
    s_mov_b32 s44, 0x20000
    buffer_load_dwordx4 v[120:123], v1, s[24:27], s44 offen offset:0 nt
    ds_read_b32 v2, v15 offset:31272
    s_waitcnt lgkmcnt(5)
    v_mfma_f32_16x16x32_bf16 v[80:83], v[192:195], v[40:43], v[80:83]
    s_waitcnt lgkmcnt(4)
    v_mfma_f32_16x16x32_bf16 v[84:87], v[196:199], v[40:43], v[84:87]
    s_waitcnt lgkmcnt(3)
    v_mfma_f32_16x16x32_bf16 v[88:91], v[200:203], v[40:43], v[88:91]
    s_waitcnt lgkmcnt(2)
    v_mfma_f32_16x16x32_bf16 v[92:95], v[204:207], v[40:43], v[92:95]
    ds_read_b128 v[32:35], v5 offset:64
    v_perm_b32 v52, v61, v61, v44
    v_perm_b32 v53, v61, v61, v45
    v_perm_b32 v54, v61, v61, v46
    v_perm_b32 v55, v61, v61, v47
    s_waitcnt vmcnt(6)
    s_nop 0
    v_mfma_f32_16x16x32_bf16 v[16:19], v[52:55], v[112:115], v[16:19]
    s_cbranch_vccnz L_is265
    s_waitcnt vmcnt(5)
    s_cbranch_scc0 L_is265
    s_waitcnt vmcnt(4)
L_is265:
    buffer_load_dwordx4 v[112:115], v1, s[24:27], s44 offen offset:256 nt
    v_perm_b32 v56, v61, v61, v48
    v_perm_b32 v57, v61, v61, v49
    v_perm_b32 v58, v61, v61, v50
    v_perm_b32 v59, v61, v61, v51
    v_add_f32_dpp v80, v80, v80 row_ror:8 row_mask:0xf bank_mask:0x3
    v_add_f32_dpp v81, v81, v81 row_ror:8 row_mask:0xf bank_mask:0x3
    v_add_f32_dpp v82, v82, v82 row_ror:8 row_mask:0xf bank_mask:0x3
    v_add_f32_dpp v83, v83, v83 row_ror:8 row_mask:0xf bank_mask:0x3
    v_add_f32_dpp v84, v84, v84 row_ror:8 row_mask:0xf bank_mask:0x3
    v_add_f32_dpp v85, v85, v85 row_ror:8 row_mask:0xf bank_mask:0x3
    v_add_f32_dpp v86, v86, v86 row_ror:8 row_mask:0xf bank_mask:0x3
    v_add_f32_dpp v87, v87, v87 row_ror:8 row_mask:0xf bank_mask:0x3
    s_waitcnt vmcnt(6)
    v_mfma_f32_16x16x32_bf16 v[16:19], v[56:59], v[116:119], v[16:19]
    s_cbranch_vccnz L_is266
    s_waitcnt vmcnt(5)
    s_cbranch_scc0 L_is266
    s_waitcnt vmcnt(4)
L_is266:
    buffer_load_dwordx4 v[116:119], v1, s[24:27], s44 offen offset:512 nt
    s_waitcnt lgkmcnt(1)
    v_readfirstlane_b32 s55, v2
    s_nop 1
    s_cmp_ge_u32 s55, 0x4200
    s_cselect_b32 s55, s55, 0
    s_bitcmp1_b32 s55, 1
    s_cselect_b64 vcc, -1, 0
    s_bitcmp1_b32 s55, 0
    v_perm_b32 v52, v62, v62, v44
    v_perm_b32 v53, v62, v62, v45
    v_perm_b32 v54, v62, v62, v46
    v_perm_b32 v55, v62, v62, v47
    v_add_f32_dpp v80, v88, v88 row_ror:8 row_mask:0xf bank_mask:0xc
    v_add_f32_dpp v81, v89, v89 row_ror:8 row_mask:0xf bank_mask:0xc
    v_add_f32_dpp v82, v90, v90 row_ror:8 row_mask:0xf bank_mask:0xc
    v_add_f32_dpp v83, v91, v91 row_ror:8 row_mask:0xf bank_mask:0xc
    v_add_f32_dpp v84, v92, v92 row_ror:8 row_mask:0xf bank_mask:0xc
    v_add_f32_dpp v85, v93, v93 row_ror:8 row_mask:0xf bank_mask:0xc
    v_add_f32_dpp v86, v94, v94 row_ror:8 row_mask:0xf bank_mask:0xc
    v_add_f32_dpp v87, v95, v95 row_ror:8 row_mask:0xf bank_mask:0xc
    s_waitcnt vmcnt(6)
    v_mfma_f32_16x16x32_bf16 v[16:19], v[52:55], v[96:99], v[16:19]
    s_cbranch_vccnz L_is267
    s_waitcnt vmcnt(5)
    s_cbranch_scc0 L_is267
    s_waitcnt vmcnt(4)
L_is267:
    buffer_load_dwordx4 v[96:99], v1, s[24:27], s44 offen offset:768 nt
    v_mov_b32 v3, 65
    ds_write_b32 v9, v3 offset:31268
    v_perm_b32 v56, v62, v62, v48
    v_perm_b32 v57, v62, v62, v49
    v_perm_b32 v58, v62, v62, v50
    v_perm_b32 v59, v62, v62, v51
    v_add_f32_dpp v80, v80, v80 row_shl:4 row_mask:0xf bank_mask:0x5
    v_add_f32_dpp v81, v81, v81 row_shl:4 row_mask:0xf bank_mask:0x5
    v_add_f32_dpp v82, v82, v82 row_shl:4 row_mask:0xf bank_mask:0x5
    v_add_f32_dpp v83, v83, v83 row_shl:4 row_mask:0xf bank_mask:0x5
    v_add_f32_dpp v80, v84, v84 row_shr:4 row_mask:0xf bank_mask:0xa
    v_add_f32_dpp v81, v85, v85 row_shr:4 row_mask:0xf bank_mask:0xa
    v_add_f32_dpp v82, v86, v86 row_shr:4 row_mask:0xf bank_mask:0xa
    v_add_f32_dpp v83, v87, v87 row_shr:4 row_mask:0xf bank_mask:0xa
    s_waitcnt vmcnt(6)
    v_mfma_f32_16x16x32_bf16 v[16:19], v[56:59], v[100:103], v[16:19]
    s_cbranch_vccnz L_is268
    s_waitcnt vmcnt(5)
    s_cbranch_scc0 L_is268
    s_waitcnt vmcnt(4)
L_is268:
    buffer_load_dwordx4 v[100:103], v1, s[24:27], s44 offen offset:1024 nt
    ds_read_b32 v2, v15 offset:31272
    v_perm_b32 v52, v63, v63, v44
    v_perm_b32 v53, v63, v63, v45
    v_perm_b32 v54, v63, v63, v46
    v_perm_b32 v55, v63, v63, v47
    v_add_f32_dpp v80, v80, v80 quad_perm:[2,3,0,1] row_mask:0xf bank_mask:0xf
    v_add_f32_dpp v81, v81, v81 quad_perm:[2,3,0,1] row_mask:0xf bank_mask:0xf
    v_add_f32_dpp v82, v82, v82 quad_perm:[2,3,0,1] row_mask:0xf bank_mask:0xf
    v_add_f32_dpp v83, v83, v83 quad_perm:[2,3,0,1] row_mask:0xf bank_mask:0xf
    v_cndmask_b32 v80, v80, v82, s[48:49]
    v_cndmask_b32 v81, v81, v83, s[48:49]
    s_nop 0
    v_add_f32_dpp v80, v80, v80 quad_perm:[1,0,3,2] row_mask:0xf bank_mask:0xf
    v_add_f32_dpp v81, v81, v81 quad_perm:[1,0,3,2] row_mask:0xf bank_mask:0xf
    s_waitcnt vmcnt(6)
    v_mfma_f32_16x16x32_bf16 v[16:19], v[52:55], v[104:107], v[16:19]
    s_cbranch_vccnz L_is269
    s_waitcnt vmcnt(5)
    s_cbranch_scc0 L_is269
    s_waitcnt vmcnt(4)
L_is269:
    buffer_load_dwordx4 v[104:107], v1, s[24:27], s44 offen offset:1280 nt
    v_perm_b32 v56, v63, v63, v48
    v_perm_b32 v57, v63, v63, v49
    v_perm_b32 v58, v63, v63, v50
    v_perm_b32 v59, v63, v63, v51
    v_cndmask_b32 v80, v80, v81, s[50:51]
    v_min_u32 v80, -2, v80
    ds_write_b32 v6, v80 offset:2304
    s_waitcnt vmcnt(6)
    v_mfma_f32_16x16x32_bf16 v[16:19], v[56:59], v[108:111], v[16:19]
    s_cbranch_vccnz L_is270
    s_waitcnt vmcnt(5)
    s_cbranch_scc0 L_is270
    s_waitcnt vmcnt(4)
L_is270:
    buffer_load_dwordx4 v[108:111], v1, s[24:27], s44 offen offset:1536 nt
    s_waitcnt lgkmcnt(1)
    v_readfirstlane_b32 s55, v2
    s_nop 1
    s_cmp_ge_u32 s55, 0x4300
    s_cselect_b32 s55, s55, 0
    s_bitcmp1_b32 s55, 1
    s_cselect_b64 vcc, -1, 0
    s_bitcmp1_b32 s55, 0
    v_perm_b32 v52, v32, v32, v44
    v_perm_b32 v53, v32, v32, v45
    v_perm_b32 v54, v32, v32, v46
    v_perm_b32 v55, v32, v32, v47
    s_waitcnt vmcnt(6)
    s_nop 0
    v_mfma_f32_16x16x32_bf16 v[16:19], v[52:55], v[120:123], v[16:19]
    s_cbranch_vccnz L_is271
    s_waitcnt vmcnt(5)
    s_cbranch_scc0 L_is271
    s_waitcnt vmcnt(4)
L_is271:
    buffer_load_dwordx4 v[120:123], v1, s[24:27], s44 offen offset:1792 nt
    v_mov_b32 v3, 66
    ds_write_b32 v9, v3 offset:31268
    v_perm_b32 v56, v32, v32, v48
    v_perm_b32 v57, v32, v32, v49
    v_perm_b32 v58, v32, v32, v50
    v_perm_b32 v59, v32, v32, v51
    s_waitcnt vmcnt(6)
    s_nop 0
    v_mfma_f32_16x16x32_bf16 v[16:19], v[56:59], v[112:115], v[16:19]
    s_cbranch_vccnz L_is272
    s_waitcnt vmcnt(5)
    s_cbranch_scc0 L_is272
    s_waitcnt vmcnt(4)
L_is272:
    s_mov_b32 s44, 0x80000
    buffer_load_dwordx4 v[112:115], v1, s[24:27], s44 offen offset:0 nt
    ds_read_b32 v2, v15 offset:31272
    ds_read_b128 v[60:63], v5 offset:128
    v_perm_b32 v52, v33, v33, v44
    v_perm_b32 v53, v33, v33, v45
    v_perm_b32 v54, v33, v33, v46
    v_perm_b32 v55, v33, v33, v47
    s_waitcnt vmcnt(6)
    s_nop 0
    v_mfma_f32_16x16x32_bf16 v[16:19], v[52:55], v[116:119], v[16:19]
    s_cbranch_vccnz L_is273
    s_waitcnt vmcnt(5)
    s_cbranch_scc0 L_is273
    s_waitcnt vmcnt(4)
L_is273:
    buffer_load_dwordx4 v[116:119], v1, s[24:27], s44 offen offset:256 nt
    v_perm_b32 v56, v33, v33, v48
    v_perm_b32 v57, v33, v33, v49
    v_perm_b32 v58, v33, v33, v50
    v_perm_b32 v59, v33, v33, v51
    s_waitcnt vmcnt(6)
    s_nop 0
    v_mfma_f32_16x16x32_bf16 v[16:19], v[56:59], v[96:99], v[16:19]
    s_cbranch_vccnz L_is274
    s_waitcnt vmcnt(5)
    s_cbranch_scc0 L_is274
    s_waitcnt vmcnt(4)
L_is274:
    buffer_load_dwordx4 v[96:99], v1, s[24:27], s44 offen offset:512 nt
    s_waitcnt lgkmcnt(1)
    v_readfirstlane_b32 s55, v2
    s_nop 1
    s_cmp_ge_u32 s55, 0x4400
    s_cselect_b32 s55, s55, 0
    s_bitcmp1_b32 s55, 1
    s_cselect_b64 vcc, -1, 0
    s_bitcmp1_b32 s55, 0
    v_perm_b32 v52, v34, v34, v44
    v_perm_b32 v53, v34, v34, v45
    v_perm_b32 v54, v34, v34, v46
    v_perm_b32 v55, v34, v34, v47
    s_waitcnt vmcnt(6)
    s_nop 0
    v_mfma_f32_16x16x32_bf16 v[16:19], v[52:55], v[100:103], v[16:19]
    s_cbranch_vccnz L_is275
    s_waitcnt vmcnt(5)
    s_cbranch_scc0 L_is275
    s_waitcnt vmcnt(4)
L_is275:
    buffer_load_dwordx4 v[100:103], v1, s[24:27], s44 offen offset:768 nt
    v_mov_b32 v3, 67
    ds_write_b32 v9, v3 offset:31268
    v_perm_b32 v56, v34, v34, v48
    v_perm_b32 v57, v34, v34, v49
    v_perm_b32 v58, v34, v34, v50
    v_perm_b32 v59, v34, v34, v51
    s_waitcnt vmcnt(6)
    s_nop 0
    v_mfma_f32_16x16x32_bf16 v[16:19], v[56:59], v[104:107], v[16:19]
    s_cbranch_vccnz L_is276
    s_waitcnt vmcnt(5)
    s_cbranch_scc0 L_is276
    s_waitcnt vmcnt(4)
L_is276:
    buffer_load_dwordx4 v[104:107], v1, s[24:27], s44 offen offset:1024 nt
    ds_read_b32 v2, v15 offset:31272
    v_perm_b32 v52, v35, v35, v44
    v_perm_b32 v53, v35, v35, v45
    v_perm_b32 v54, v35, v35, v46
    v_perm_b32 v55, v35, v35, v47
    s_waitcnt vmcnt(6)
    s_nop 0
    v_mfma_f32_16x16x32_bf16 v[16:19], v[52:55], v[108:111], v[16:19]
    s_cbranch_vccnz L_is277
    s_waitcnt vmcnt(5)
    s_cbranch_scc0 L_is277
    s_waitcnt vmcnt(4)
L_is277:
    buffer_load_dwordx4 v[108:111], v1, s[24:27], s44 offen offset:1280 nt
    v_perm_b32 v56, v35, v35, v48
    v_perm_b32 v57, v35, v35, v49
    v_perm_b32 v58, v35, v35, v50
    v_perm_b32 v59, v35, v35, v51
    s_waitcnt vmcnt(6)
    s_nop 0
    v_mfma_f32_16x16x32_bf16 v[16:19], v[56:59], v[120:123], v[16:19]
    s_cbranch_vccnz L_is278
    s_waitcnt vmcnt(5)
    s_cbranch_scc0 L_is278
    s_waitcnt vmcnt(4)
L_is278:
    buffer_load_dwordx4 v[120:123], v1, s[24:27], s44 offen offset:1536 nt
    s_waitcnt lgkmcnt(0)
    v_readfirstlane_b32 s55, v2
    s_nop 1
    s_cmp_ge_u32 s55, 0x4500
    s_cselect_b32 s55, s55, 0
    s_bitcmp1_b32 s55, 1
    s_cselect_b64 vcc, -1, 0
    s_bitcmp1_b32 s55, 0
    v_perm_b32 v52, v60, v60, v44
    v_perm_b32 v53, v60, v60, v45
    v_perm_b32 v54, v60, v60, v46
    v_perm_b32 v55, v60, v60, v47
    s_waitcnt vmcnt(6)
    s_nop 0
    v_mfma_f32_16x16x32_bf16 v[16:19], v[52:55], v[112:115], v[16:19]
    s_cbranch_vccnz L_is279
    s_waitcnt vmcnt(5)
    s_cbranch_scc0 L_is279
    s_waitcnt vmcnt(4)
L_is279:
    buffer_load_dwordx4 v[112:115], v1, s[24:27], s44 offen offset:1792 nt
    v_mov_b32 v3, 68
    ds_write_b32 v9, v3 offset:31268
    v_perm_b32 v56, v60, v60, v48
    v_perm_b32 v57, v60, v60, v49
    v_perm_b32 v58, v60, v60, v50
    v_perm_b32 v59, v60, v60, v51
    s_waitcnt vmcnt(6)
    s_nop 0
    v_mfma_f32_16x16x32_bf16 v[16:19], v[56:59], v[116:119], v[16:19]
    s_cbranch_vccnz L_is280
    s_waitcnt vmcnt(5)
    s_cbranch_scc0 L_is280
    s_waitcnt vmcnt(4)
L_is280:
    s_mov_b32 s44, 0xa0000
    buffer_load_dwordx4 v[116:119], v1, s[24:27], s44 offen offset:0 nt
    ds_read_b32 v2, v15 offset:31272
    ds_read_b128 v[32:35], v5 offset:192
    v_perm_b32 v52, v61, v61, v44
    v_perm_b32 v53, v61, v61, v45
    v_perm_b32 v54, v61, v61, v46
    v_perm_b32 v55, v61, v61, v47
    s_waitcnt vmcnt(6)
    s_nop 0
    v_mfma_f32_16x16x32_bf16 v[16:19], v[52:55], v[96:99], v[16:19]
    s_cbranch_vccnz L_is281
    s_waitcnt vmcnt(5)
    s_cbranch_scc0 L_is281
    s_waitcnt vmcnt(4)
L_is281:
    buffer_load_dwordx4 v[96:99], v1, s[24:27], s44 offen offset:256 nt
    v_perm_b32 v56, v61, v61, v48
    v_perm_b32 v57, v61, v61, v49
    v_perm_b32 v58, v61, v61, v50
    v_perm_b32 v59, v61, v61, v51
    s_waitcnt vmcnt(6)
    s_nop 0
    v_mfma_f32_16x16x32_bf16 v[16:19], v[56:59], v[100:103], v[16:19]
    s_cbranch_vccnz L_is282
    s_waitcnt vmcnt(5)
    s_cbranch_scc0 L_is282
    s_waitcnt vmcnt(4)
L_is282:
    buffer_load_dwordx4 v[100:103], v1, s[24:27], s44 offen offset:512 nt
    s_waitcnt lgkmcnt(1)
    v_readfirstlane_b32 s55, v2
    s_nop 1
    s_cmp_ge_u32 s55, 0x4600
    s_cselect_b32 s55, s55, 0
    s_bitcmp1_b32 s55, 1
    s_cselect_b64 vcc, -1, 0
    s_bitcmp1_b32 s55, 0
    v_perm_b32 v52, v62, v62, v44
    v_perm_b32 v53, v62, v62, v45
    v_perm_b32 v54, v62, v62, v46
    v_perm_b32 v55, v62, v62, v47
    s_waitcnt vmcnt(6)
    s_nop 0
    v_mfma_f32_16x16x32_bf16 v[16:19], v[52:55], v[104:107], v[16:19]
    s_cbranch_vccnz L_is283
    s_waitcnt vmcnt(5)
    s_cbranch_scc0 L_is283
    s_waitcnt vmcnt(4)
L_is283:
    buffer_load_dwordx4 v[104:107], v1, s[24:27], s44 offen offset:768 nt
    v_mov_b32 v3, 69
    ds_write_b32 v9, v3 offset:31268
    v_perm_b32 v56, v62, v62, v48
    v_perm_b32 v57, v62, v62, v49
    v_perm_b32 v58, v62, v62, v50
    v_perm_b32 v59, v62, v62, v51
    s_waitcnt vmcnt(6)
    s_nop 0
    v_mfma_f32_16x16x32_bf16 v[16:19], v[56:59], v[108:111], v[16:19]
    s_cbranch_vccnz L_is284
    s_waitcnt vmcnt(5)
    s_cbranch_scc0 L_is284
    s_waitcnt vmcnt(4)
L_is284:
    buffer_load_dwordx4 v[108:111], v1, s[24:27], s44 offen offset:1024 nt
    ds_read_b32 v2, v15 offset:31272
    v_perm_b32 v52, v63, v63, v44
    v_perm_b32 v53, v63, v63, v45
    v_perm_b32 v54, v63, v63, v46
    v_perm_b32 v55, v63, v63, v47
    s_waitcnt vmcnt(6)
    s_nop 0
    v_mfma_f32_16x16x32_bf16 v[16:19], v[52:55], v[120:123], v[16:19]
    s_cbranch_vccnz L_is285
    s_waitcnt vmcnt(5)
    s_cbranch_scc0 L_is285
    s_waitcnt vmcnt(4)
L_is285:
    buffer_load_dwordx4 v[120:123], v1, s[24:27], s44 offen offset:1280 nt
    v_perm_b32 v56, v63, v63, v48
    v_perm_b32 v57, v63, v63, v49
    v_perm_b32 v58, v63, v63, v50
    v_perm_b32 v59, v63, v63, v51
    s_waitcnt vmcnt(6)
    s_nop 0
    v_mfma_f32_16x16x32_bf16 v[16:19], v[56:59], v[112:115], v[16:19]
    s_cbranch_vccnz L_is286
    s_waitcnt vmcnt(5)
    s_cbranch_scc0 L_is286
    s_waitcnt vmcnt(4)
L_is286:
    buffer_load_dwordx4 v[112:115], v1, s[24:27], s44 offen offset:1536 nt
    s_waitcnt lgkmcnt(0)
    v_readfirstlane_b32 s55, v2
    s_nop 1
    s_cmp_ge_u32 s55, 0x4700
    s_cselect_b32 s55, s55, 0
    s_bitcmp1_b32 s55, 1
    s_cselect_b64 vcc, -1, 0
    s_bitcmp1_b32 s55, 0
    v_perm_b32 v52, v32, v32, v44
    v_perm_b32 v53, v32, v32, v45
    v_perm_b32 v54, v32, v32, v46
    v_perm_b32 v55, v32, v32, v47
    s_waitcnt vmcnt(6)
    s_nop 0
    v_mfma_f32_16x16x32_bf16 v[16:19], v[52:55], v[116:119], v[16:19]
    s_cbranch_vccnz L_is287
    s_waitcnt vmcnt(5)
    s_cbranch_scc0 L_is287
    s_waitcnt vmcnt(4)
L_is287:
    buffer_load_dwordx4 v[116:119], v1, s[24:27], s44 offen offset:1792 nt
    v_mov_b32 v3, 70
    ds_write_b32 v9, v3 offset:31268
    v_perm_b32 v56, v32, v32, v48
    v_perm_b32 v57, v32, v32, v49
    v_perm_b32 v58, v32, v32, v50
    v_perm_b32 v59, v32, v32, v51
    s_waitcnt vmcnt(6)
    s_nop 0
    v_mfma_f32_16x16x32_bf16 v[16:19], v[56:59], v[96:99], v[16:19]
    s_cbranch_vccnz L_is288
    s_waitcnt vmcnt(5)
    s_cbranch_scc0 L_is288
    s_waitcnt vmcnt(4)
L_is288:
    s_mov_b32 s44, 0x100000
    buffer_load_dwordx4 v[96:99], v1, s[24:27], s44 offen offset:0 nt
    ds_read_b32 v2, v15 offset:31272
    ds_read_b128 v[60:63], v5 offset:256
    v_perm_b32 v52, v33, v33, v44
    v_perm_b32 v53, v33, v33, v45
    v_perm_b32 v54, v33, v33, v46
    v_perm_b32 v55, v33, v33, v47
    s_waitcnt vmcnt(6)
    s_nop 0
    v_mfma_f32_16x16x32_bf16 v[16:19], v[52:55], v[100:103], v[16:19]
    s_cbranch_vccnz L_is289
    s_waitcnt vmcnt(5)
    s_cbranch_scc0 L_is289
    s_waitcnt vmcnt(4)
L_is289:
    buffer_load_dwordx4 v[100:103], v1, s[24:27], s44 offen offset:256 nt
    v_perm_b32 v56, v33, v33, v48
    v_perm_b32 v57, v33, v33, v49
    v_perm_b32 v58, v33, v33, v50
    v_perm_b32 v59, v33, v33, v51
    s_waitcnt vmcnt(6)
    s_nop 0
    v_mfma_f32_16x16x32_bf16 v[16:19], v[56:59], v[104:107], v[16:19]
    s_cbranch_vccnz L_is290
    s_waitcnt vmcnt(5)
    s_cbranch_scc0 L_is290
    s_waitcnt vmcnt(4)
L_is290:
    buffer_load_dwordx4 v[104:107], v1, s[24:27], s44 offen offset:512 nt
    s_waitcnt lgkmcnt(1)
    v_readfirstlane_b32 s55, v2
    s_nop 1
    s_cmp_ge_u32 s55, 0x4800
    s_cselect_b32 s55, s55, 0
    s_bitcmp1_b32 s55, 1
    s_cselect_b64 vcc, -1, 0
    s_bitcmp1_b32 s55, 0
    v_perm_b32 v52, v34, v34, v44
    v_perm_b32 v53, v34, v34, v45
    v_perm_b32 v54, v34, v34, v46
    v_perm_b32 v55, v34, v34, v47
    s_waitcnt vmcnt(6)
    s_nop 0
    v_mfma_f32_16x16x32_bf16 v[16:19], v[52:55], v[108:111], v[16:19]
    s_cbranch_vccnz L_is291
    s_waitcnt vmcnt(5)
    s_cbranch_scc0 L_is291
    s_waitcnt vmcnt(4)
L_is291:
    buffer_load_dwordx4 v[108:111], v1, s[24:27], s44 offen offset:768 nt
    v_mov_b32 v3, 71
    ds_write_b32 v9, v3 offset:31268
    v_perm_b32 v56, v34, v34, v48
    v_perm_b32 v57, v34, v34, v49
    v_perm_b32 v58, v34, v34, v50
    v_perm_b32 v59, v34, v34, v51
    s_waitcnt vmcnt(6)
    s_nop 0
    v_mfma_f32_16x16x32_bf16 v[16:19], v[56:59], v[120:123], v[16:19]
    s_cbranch_vccnz L_is292
    s_waitcnt vmcnt(5)
    s_cbranch_scc0 L_is292
    s_waitcnt vmcnt(4)
L_is292:
    buffer_load_dwordx4 v[120:123], v1, s[24:27], s44 offen offset:1024 nt
    ds_read_b32 v2, v15 offset:31272
    v_perm_b32 v52, v35, v35, v44
    v_perm_b32 v53, v35, v35, v45
    v_perm_b32 v54, v35, v35, v46
    v_perm_b32 v55, v35, v35, v47
    s_waitcnt vmcnt(6)
    s_nop 0
    v_mfma_f32_16x16x32_bf16 v[16:19], v[52:55], v[112:115], v[16:19]
    s_cbranch_vccnz L_is293
    s_waitcnt vmcnt(5)
    s_cbranch_scc0 L_is293
    s_waitcnt vmcnt(4)
L_is293:
    buffer_load_dwordx4 v[112:115], v1, s[24:27], s44 offen offset:1280 nt
    v_perm_b32 v56, v35, v35, v48
    v_perm_b32 v57, v35, v35, v49
    v_perm_b32 v58, v35, v35, v50
    v_perm_b32 v59, v35, v35, v51
    s_waitcnt vmcnt(6)
    s_nop 0
    v_mfma_f32_16x16x32_bf16 v[16:19], v[56:59], v[116:119], v[16:19]
    s_cbranch_vccnz L_is294
    s_waitcnt vmcnt(5)
    s_cbranch_scc0 L_is294
    s_waitcnt vmcnt(4)
L_is294:
    buffer_load_dwordx4 v[116:119], v1, s[24:27], s44 offen offset:1536 nt
    s_waitcnt lgkmcnt(0)
    v_readfirstlane_b32 s55, v2
    s_nop 1
    s_cmp_ge_u32 s55, 0x4900
    s_cselect_b32 s55, s55, 0
    s_bitcmp1_b32 s55, 1
    s_cselect_b64 vcc, -1, 0
    s_bitcmp1_b32 s55, 0
    v_perm_b32 v52, v60, v60, v44
    v_perm_b32 v53, v60, v60, v45
    v_perm_b32 v54, v60, v60, v46
    v_perm_b32 v55, v60, v60, v47
    s_waitcnt vmcnt(6)
    s_nop 0
    v_mfma_f32_16x16x32_bf16 v[16:19], v[52:55], v[96:99], v[16:19]
    s_cbranch_vccnz L_is295
    s_waitcnt vmcnt(5)
    s_cbranch_scc0 L_is295
    s_waitcnt vmcnt(4)
L_is295:
    buffer_load_dwordx4 v[96:99], v1, s[24:27], s44 offen offset:1792 nt
    v_mov_b32 v3, 72
    ds_write_b32 v9, v3 offset:31268
    v_perm_b32 v56, v60, v60, v48
    v_perm_b32 v57, v60, v60, v49
    v_perm_b32 v58, v60, v60, v50
    v_perm_b32 v59, v60, v60, v51
    s_waitcnt vmcnt(6)
    s_nop 0
    v_mfma_f32_16x16x32_bf16 v[16:19], v[56:59], v[100:103], v[16:19]
    s_cbranch_vccnz L_is296
    s_waitcnt vmcnt(5)
    s_cbranch_scc0 L_is296
    s_waitcnt vmcnt(4)
L_is296:
    s_mov_b32 s44, 0x120000
    buffer_load_dwordx4 v[100:103], v1, s[24:27], s44 offen offset:0 nt
    ds_read_b32 v2, v15 offset:31272
    ds_read_b128 v[32:35], v5 offset:320
    v_perm_b32 v52, v61, v61, v44
    v_perm_b32 v53, v61, v61, v45
    v_perm_b32 v54, v61, v61, v46
    v_perm_b32 v55, v61, v61, v47
    s_waitcnt vmcnt(6)
    s_nop 0
    v_mfma_f32_16x16x32_bf16 v[16:19], v[52:55], v[104:107], v[16:19]
    s_cbranch_vccnz L_is297
    s_waitcnt vmcnt(5)
    s_cbranch_scc0 L_is297
    s_waitcnt vmcnt(4)
L_is297:
    buffer_load_dwordx4 v[104:107], v1, s[24:27], s44 offen offset:256 nt
    v_perm_b32 v56, v61, v61, v48
    v_perm_b32 v57, v61, v61, v49
    v_perm_b32 v58, v61, v61, v50
    v_perm_b32 v59, v61, v61, v51
    s_waitcnt vmcnt(6)
    s_nop 0
    v_mfma_f32_16x16x32_bf16 v[16:19], v[56:59], v[108:111], v[16:19]
    s_cbranch_vccnz L_is298
    s_waitcnt vmcnt(5)
    s_cbranch_scc0 L_is298
    s_waitcnt vmcnt(4)
L_is298:
    buffer_load_dwordx4 v[108:111], v1, s[24:27], s44 offen offset:512 nt
    s_waitcnt lgkmcnt(1)
    v_readfirstlane_b32 s55, v2
    s_nop 1
    s_cmp_ge_u32 s55, 0x4a00
    s_cselect_b32 s55, s55, 0
    s_bitcmp1_b32 s55, 1
    s_cselect_b64 vcc, -1, 0
    s_bitcmp1_b32 s55, 0
    v_perm_b32 v52, v62, v62, v44
    v_perm_b32 v53, v62, v62, v45
    v_perm_b32 v54, v62, v62, v46
    v_perm_b32 v55, v62, v62, v47
    s_waitcnt vmcnt(6)
    s_nop 0
    v_mfma_f32_16x16x32_bf16 v[16:19], v[52:55], v[120:123], v[16:19]
    s_cbranch_vccnz L_is299
    s_waitcnt vmcnt(5)
    s_cbranch_scc0 L_is299
    s_waitcnt vmcnt(4)
L_is299:
    buffer_load_dwordx4 v[120:123], v1, s[24:27], s44 offen offset:768 nt
    v_mov_b32 v3, 73
    ds_write_b32 v9, v3 offset:31268
    v_perm_b32 v56, v62, v62, v48
    v_perm_b32 v57, v62, v62, v49
    v_perm_b32 v58, v62, v62, v50
    v_perm_b32 v59, v62, v62, v51
    s_waitcnt vmcnt(6)
    s_nop 0
    v_mfma_f32_16x16x32_bf16 v[16:19], v[56:59], v[112:115], v[16:19]
    s_cbranch_vccnz L_is300
    s_waitcnt vmcnt(5)
    s_cbranch_scc0 L_is300
    s_waitcnt vmcnt(4)
L_is300:
    buffer_load_dwordx4 v[112:115], v1, s[24:27], s44 offen offset:1024 nt
    ds_read_b32 v2, v15 offset:31272
    v_perm_b32 v52, v63, v63, v44
    v_perm_b32 v53, v63, v63, v45
    v_perm_b32 v54, v63, v63, v46
    v_perm_b32 v55, v63, v63, v47
    s_waitcnt vmcnt(6)
    s_nop 0
    v_mfma_f32_16x16x32_bf16 v[16:19], v[52:55], v[116:119], v[16:19]
    s_cbranch_vccnz L_is301
    s_waitcnt vmcnt(5)
    s_cbranch_scc0 L_is301
    s_waitcnt vmcnt(4)
L_is301:
    buffer_load_dwordx4 v[116:119], v1, s[24:27], s44 offen offset:1280 nt
    v_perm_b32 v56, v63, v63, v48
    v_perm_b32 v57, v63, v63, v49
    v_perm_b32 v58, v63, v63, v50
    v_perm_b32 v59, v63, v63, v51
    s_waitcnt vmcnt(6)
    s_nop 0
    v_mfma_f32_16x16x32_bf16 v[16:19], v[56:59], v[96:99], v[16:19]
    s_cbranch_vccnz L_is302
    s_waitcnt vmcnt(5)
    s_cbranch_scc0 L_is302
    s_waitcnt vmcnt(4)
L_is302:
    buffer_load_dwordx4 v[96:99], v1, s[24:27], s44 offen offset:1536 nt
    s_waitcnt lgkmcnt(0)
    v_readfirstlane_b32 s55, v2
    s_nop 1
    s_cmp_ge_u32 s55, 0x4b00
    s_cselect_b32 s55, s55, 0
    s_bitcmp1_b32 s55, 1
    s_cselect_b64 vcc, -1, 0
    s_bitcmp1_b32 s55, 0
    v_perm_b32 v52, v32, v32, v44
    v_perm_b32 v53, v32, v32, v45
    v_perm_b32 v54, v32, v32, v46
    v_perm_b32 v55, v32, v32, v47
    s_waitcnt vmcnt(6)
    s_nop 0
    v_mfma_f32_16x16x32_bf16 v[16:19], v[52:55], v[100:103], v[16:19]
    s_cbranch_vccnz L_is303
    s_waitcnt vmcnt(5)
    s_cbranch_scc0 L_is303
    s_waitcnt vmcnt(4)
L_is303:
    buffer_load_dwordx4 v[100:103], v1, s[24:27], s44 offen offset:1792 nt
    v_mov_b32 v3, 74
    ds_write_b32 v9, v3 offset:31268
    v_perm_b32 v56, v32, v32, v48
    v_perm_b32 v57, v32, v32, v49
    v_perm_b32 v58, v32, v32, v50
    v_perm_b32 v59, v32, v32, v51
    s_waitcnt vmcnt(6)
    s_nop 0
    v_mfma_f32_16x16x32_bf16 v[16:19], v[56:59], v[104:107], v[16:19]
    s_cbranch_vccnz L_is304
    s_waitcnt vmcnt(5)
    s_cbranch_scc0 L_is304
    s_waitcnt vmcnt(4)
L_is304:
    s_mov_b32 s44, 0x180000
    buffer_load_dwordx4 v[104:107], v1, s[24:27], s44 offen offset:0 nt
    ds_read_b32 v2, v15 offset:31272
    ds_read_b128 v[60:63], v5 offset:384
    v_perm_b32 v52, v33, v33, v44
    v_perm_b32 v53, v33, v33, v45
    v_perm_b32 v54, v33, v33, v46
    v_perm_b32 v55, v33, v33, v47
    s_waitcnt vmcnt(6)
    s_nop 0
    v_mfma_f32_16x16x32_bf16 v[16:19], v[52:55], v[108:111], v[16:19]
    s_cbranch_vccnz L_is305
    s_waitcnt vmcnt(5)
    s_cbranch_scc0 L_is305
    s_waitcnt vmcnt(4)
L_is305:
    buffer_load_dwordx4 v[108:111], v1, s[24:27], s44 offen offset:256 nt
    v_perm_b32 v56, v33, v33, v48
    v_perm_b32 v57, v33, v33, v49
    v_perm_b32 v58, v33, v33, v50
    v_perm_b32 v59, v33, v33, v51
    s_waitcnt vmcnt(6)
    s_nop 0
    v_mfma_f32_16x16x32_bf16 v[16:19], v[56:59], v[120:123], v[16:19]
    s_cbranch_vccnz L_is306
    s_waitcnt vmcnt(5)
    s_cbranch_scc0 L_is306
    s_waitcnt vmcnt(4)
L_is306:
    buffer_load_dwordx4 v[120:123], v1, s[24:27], s44 offen offset:512 nt
    s_waitcnt lgkmcnt(1)
    v_readfirstlane_b32 s55, v2
    s_nop 1
    s_cmp_ge_u32 s55, 0x4c00
    s_cselect_b32 s55, s55, 0
    s_bitcmp1_b32 s55, 1
    s_cselect_b64 vcc, -1, 0
    s_bitcmp1_b32 s55, 0
    v_perm_b32 v52, v34, v34, v44
    v_perm_b32 v53, v34, v34, v45
    v_perm_b32 v54, v34, v34, v46
    v_perm_b32 v55, v34, v34, v47
    s_waitcnt vmcnt(6)
    s_nop 0
    v_mfma_f32_16x16x32_bf16 v[16:19], v[52:55], v[112:115], v[16:19]
    s_cbranch_vccnz L_is307
    s_waitcnt vmcnt(5)
    s_cbranch_scc0 L_is307
    s_waitcnt vmcnt(4)
L_is307:
    buffer_load_dwordx4 v[112:115], v1, s[24:27], s44 offen offset:768 nt
    v_mov_b32 v3, 75
    ds_write_b32 v9, v3 offset:31268
    v_perm_b32 v56, v34, v34, v48
    v_perm_b32 v57, v34, v34, v49
    v_perm_b32 v58, v34, v34, v50
    v_perm_b32 v59, v34, v34, v51
    s_waitcnt vmcnt(6)
    s_nop 0
    v_mfma_f32_16x16x32_bf16 v[16:19], v[56:59], v[116:119], v[16:19]
    s_cbranch_vccnz L_is308
    s_waitcnt vmcnt(5)
    s_cbranch_scc0 L_is308
    s_waitcnt vmcnt(4)
L_is308:
    buffer_load_dwordx4 v[116:119], v1, s[24:27], s44 offen offset:1024 nt
    ds_read_b32 v2, v15 offset:31272
    v_perm_b32 v52, v35, v35, v44
    v_perm_b32 v53, v35, v35, v45
    v_perm_b32 v54, v35, v35, v46
    v_perm_b32 v55, v35, v35, v47
    s_waitcnt vmcnt(6)
    s_nop 0
    v_mfma_f32_16x16x32_bf16 v[16:19], v[52:55], v[96:99], v[16:19]
    s_cbranch_vccnz L_is309
    s_waitcnt vmcnt(5)
    s_cbranch_scc0 L_is309
    s_waitcnt vmcnt(4)
L_is309:
    buffer_load_dwordx4 v[96:99], v1, s[24:27], s44 offen offset:1280 nt
    v_perm_b32 v56, v35, v35, v48
    v_perm_b32 v57, v35, v35, v49
    v_perm_b32 v58, v35, v35, v50
    v_perm_b32 v59, v35, v35, v51
    s_waitcnt vmcnt(6)
    s_nop 0
    v_mfma_f32_16x16x32_bf16 v[16:19], v[56:59], v[100:103], v[16:19]
    s_cbranch_vccnz L_is310
    s_waitcnt vmcnt(5)
    s_cbranch_scc0 L_is310
    s_waitcnt vmcnt(4)
L_is310:
    buffer_load_dwordx4 v[100:103], v1, s[24:27], s44 offen offset:1536 nt
    s_waitcnt lgkmcnt(0)
    v_readfirstlane_b32 s55, v2
    s_nop 1
    s_cmp_ge_u32 s55, 0x4d00
    s_cselect_b32 s55, s55, 0
    s_bitcmp1_b32 s55, 1
    s_cselect_b64 vcc, -1, 0
    s_bitcmp1_b32 s55, 0
    v_perm_b32 v52, v60, v60, v44
    v_perm_b32 v53, v60, v60, v45
    v_perm_b32 v54, v60, v60, v46
    v_perm_b32 v55, v60, v60, v47
    s_waitcnt vmcnt(6)
    s_nop 0
    v_mfma_f32_16x16x32_bf16 v[16:19], v[52:55], v[104:107], v[16:19]
    s_cbranch_vccnz L_is311
    s_waitcnt vmcnt(5)
    s_cbranch_scc0 L_is311
    s_waitcnt vmcnt(4)
L_is311:
    buffer_load_dwordx4 v[104:107], v1, s[24:27], s44 offen offset:1792 nt
    v_mov_b32 v3, 76
    ds_write_b32 v9, v3 offset:31268
    v_perm_b32 v56, v60, v60, v48
    v_perm_b32 v57, v60, v60, v49
    v_perm_b32 v58, v60, v60, v50
    v_perm_b32 v59, v60, v60, v51
    s_waitcnt vmcnt(6)
    s_nop 0
    v_mfma_f32_16x16x32_bf16 v[16:19], v[56:59], v[108:111], v[16:19]
    s_cbranch_vccnz L_is312
    s_waitcnt vmcnt(5)
    s_cbranch_scc0 L_is312
    s_waitcnt vmcnt(4)
L_is312:
    s_mov_b32 s44, 0x1a0000
    buffer_load_dwordx4 v[108:111], v1, s[24:27], s44 offen offset:0 nt
    ds_read_b32 v2, v15 offset:31272
    ds_read_b128 v[32:35], v5 offset:448
    v_perm_b32 v52, v61, v61, v44
    v_perm_b32 v53, v61, v61, v45
    v_perm_b32 v54, v61, v61, v46
    v_perm_b32 v55, v61, v61, v47
    s_waitcnt vmcnt(6)
    s_nop 0
    v_mfma_f32_16x16x32_bf16 v[16:19], v[52:55], v[120:123], v[16:19]
    s_cbranch_vccnz L_is313
    s_waitcnt vmcnt(5)
    s_cbranch_scc0 L_is313
    s_waitcnt vmcnt(4)
L_is313:
    buffer_load_dwordx4 v[120:123], v1, s[24:27], s44 offen offset:256 nt
    v_perm_b32 v56, v61, v61, v48
    v_perm_b32 v57, v61, v61, v49
    v_perm_b32 v58, v61, v61, v50
    v_perm_b32 v59, v61, v61, v51
    s_waitcnt vmcnt(6)
    s_nop 0
    v_mfma_f32_16x16x32_bf16 v[16:19], v[56:59], v[112:115], v[16:19]
    s_cbranch_vccnz L_is314
    s_waitcnt vmcnt(5)
    s_cbranch_scc0 L_is314
    s_waitcnt vmcnt(4)
L_is314:
    buffer_load_dwordx4 v[112:115], v1, s[24:27], s44 offen offset:512 nt
    s_waitcnt lgkmcnt(1)
    v_readfirstlane_b32 s55, v2
    s_nop 1
    s_cmp_ge_u32 s55, 0x4e00
    s_cselect_b32 s55, s55, 0
    s_bitcmp1_b32 s55, 1
    s_cselect_b64 vcc, -1, 0
    s_bitcmp1_b32 s55, 0
    v_perm_b32 v52, v62, v62, v44
    v_perm_b32 v53, v62, v62, v45
    v_perm_b32 v54, v62, v62, v46
    v_perm_b32 v55, v62, v62, v47
    s_waitcnt vmcnt(6)
    s_nop 0
    v_mfma_f32_16x16x32_bf16 v[16:19], v[52:55], v[116:119], v[16:19]
    s_cbranch_vccnz L_is315
    s_waitcnt vmcnt(5)
    s_cbranch_scc0 L_is315
    s_waitcnt vmcnt(4)
L_is315:
    buffer_load_dwordx4 v[116:119], v1, s[24:27], s44 offen offset:768 nt
    v_mov_b32 v3, 77
    ds_write_b32 v9, v3 offset:31268
    v_perm_b32 v56, v62, v62, v48
    v_perm_b32 v57, v62, v62, v49
    v_perm_b32 v58, v62, v62, v50
    v_perm_b32 v59, v62, v62, v51
    s_waitcnt vmcnt(6)
    s_nop 0
    v_mfma_f32_16x16x32_bf16 v[16:19], v[56:59], v[96:99], v[16:19]
    s_cbranch_vccnz L_is316
    s_waitcnt vmcnt(5)
    s_cbranch_scc0 L_is316
    s_waitcnt vmcnt(4)
L_is316:
    buffer_load_dwordx4 v[96:99], v1, s[24:27], s44 offen offset:1024 nt
    ds_read_b32 v2, v15 offset:31272
    v_perm_b32 v52, v63, v63, v44
    v_perm_b32 v53, v63, v63, v45
    v_perm_b32 v54, v63, v63, v46
    v_perm_b32 v55, v63, v63, v47
    s_waitcnt vmcnt(6)
    s_nop 0
    v_mfma_f32_16x16x32_bf16 v[16:19], v[52:55], v[100:103], v[16:19]
    s_cbranch_vccnz L_is317
    s_waitcnt vmcnt(5)
    s_cbranch_scc0 L_is317
    s_waitcnt vmcnt(4)
L_is317:
    buffer_load_dwordx4 v[100:103], v1, s[24:27], s44 offen offset:1280 nt
    v_perm_b32 v56, v63, v63, v48
    v_perm_b32 v57, v63, v63, v49
    v_perm_b32 v58, v63, v63, v50
    v_perm_b32 v59, v63, v63, v51
    s_waitcnt vmcnt(6)
    s_nop 0
    v_mfma_f32_16x16x32_bf16 v[16:19], v[56:59], v[104:107], v[16:19]
    s_cbranch_vccnz L_is318
    s_waitcnt vmcnt(5)
    s_cbranch_scc0 L_is318
    s_waitcnt vmcnt(4)
L_is318:
    buffer_load_dwordx4 v[104:107], v1, s[24:27], s44 offen offset:1536 nt
    s_waitcnt lgkmcnt(0)
    v_readfirstlane_b32 s55, v2
    s_nop 1
    s_cmp_ge_u32 s55, 0x4f00
    s_cselect_b32 s55, s55, 0
    s_bitcmp1_b32 s55, 1
    s_cselect_b64 vcc, -1, 0
    s_bitcmp1_b32 s55, 0
    v_perm_b32 v52, v32, v32, v44
    v_perm_b32 v53, v32, v32, v45
    v_perm_b32 v54, v32, v32, v46
    v_perm_b32 v55, v32, v32, v47
    s_waitcnt vmcnt(6)
    s_nop 0
    v_mfma_f32_16x16x32_bf16 v[16:19], v[52:55], v[108:111], v[16:19]
    s_cbranch_vccnz L_is319
    s_waitcnt vmcnt(5)
    s_cbranch_scc0 L_is319
    s_waitcnt vmcnt(4)
L_is319:
    buffer_load_dwordx4 v[108:111], v1, s[24:27], s44 offen offset:1792 nt
    v_mov_b32 v3, 78
    ds_write_b32 v9, v3 offset:31268
    v_perm_b32 v56, v32, v32, v48
    v_perm_b32 v57, v32, v32, v49
    v_perm_b32 v58, v32, v32, v50
    v_perm_b32 v59, v32, v32, v51
    s_waitcnt vmcnt(6)
    s_nop 0
    v_mfma_f32_16x16x32_bf16 v[16:19], v[56:59], v[120:123], v[16:19]
    s_cbranch_vccnz L_is320
    s_waitcnt vmcnt(5)
    s_cbranch_scc0 L_is320
    s_waitcnt vmcnt(4)
L_is320:
    s_mov_b32 s44, 0x2000000
    buffer_load_dwordx4 v[120:123], v1, s[24:27], s44 offen offset:0 nt
    ds_read_b32 v2, v15 offset:31272
    ds_read_b128 v[60:63], v5 offset:1152
    v_perm_b32 v52, v33, v33, v44
    v_perm_b32 v53, v33, v33, v45
    v_perm_b32 v54, v33, v33, v46
    v_perm_b32 v55, v33, v33, v47
    s_waitcnt vmcnt(6)
    s_nop 0
    v_mfma_f32_16x16x32_bf16 v[16:19], v[52:55], v[112:115], v[16:19]
    s_cbranch_vccnz L_is321
    s_waitcnt vmcnt(5)
    s_cbranch_scc0 L_is321
    s_waitcnt vmcnt(4)
L_is321:
    buffer_load_dwordx4 v[112:115], v1, s[24:27], s44 offen offset:256 nt
    v_perm_b32 v56, v33, v33, v48
    v_perm_b32 v57, v33, v33, v49
    v_perm_b32 v58, v33, v33, v50
    v_perm_b32 v59, v33, v33, v51
    s_waitcnt vmcnt(6)
    s_nop 0
    v_mfma_f32_16x16x32_bf16 v[16:19], v[56:59], v[116:119], v[16:19]
    s_cbranch_vccnz L_is322
    s_waitcnt vmcnt(5)
    s_cbranch_scc0 L_is322
    s_waitcnt vmcnt(4)
L_is322:
    buffer_load_dwordx4 v[116:119], v1, s[24:27], s44 offen offset:512 nt
    s_waitcnt lgkmcnt(1)
    v_readfirstlane_b32 s55, v2
    s_nop 1
    s_cmp_ge_u32 s55, 0x5000
    s_cselect_b32 s55, s55, 0
    s_bitcmp1_b32 s55, 1
    s_cselect_b64 vcc, -1, 0
    s_bitcmp1_b32 s55, 0
    v_perm_b32 v52, v34, v34, v44
    v_perm_b32 v53, v34, v34, v45
    v_perm_b32 v54, v34, v34, v46
    v_perm_b32 v55, v34, v34, v47
    s_waitcnt vmcnt(6)
    s_nop 0
    v_mfma_f32_16x16x32_bf16 v[16:19], v[52:55], v[96:99], v[16:19]
    s_cbranch_vccnz L_is323
    s_waitcnt vmcnt(5)
    s_cbranch_scc0 L_is323
    s_waitcnt vmcnt(4)
L_is323:
    buffer_load_dwordx4 v[96:99], v1, s[24:27], s44 offen offset:768 nt
    v_mov_b32 v3, 79
    ds_write_b32 v9, v3 offset:31268
    v_perm_b32 v56, v34, v34, v48
    v_perm_b32 v57, v34, v34, v49
    v_perm_b32 v58, v34, v34, v50
    v_perm_b32 v59, v34, v34, v51
    s_waitcnt vmcnt(6)
    s_nop 0
    v_mfma_f32_16x16x32_bf16 v[16:19], v[56:59], v[100:103], v[16:19]
    s_cbranch_vccnz L_is324
    s_waitcnt vmcnt(5)
    s_cbranch_scc0 L_is324
    s_waitcnt vmcnt(4)
L_is324:
    buffer_load_dwordx4 v[100:103], v1, s[24:27], s44 offen offset:1024 nt
    ds_read_b32 v2, v15 offset:31272
    v_perm_b32 v52, v35, v35, v44
    v_perm_b32 v53, v35, v35, v45
    v_perm_b32 v54, v35, v35, v46
    v_perm_b32 v55, v35, v35, v47
    s_waitcnt vmcnt(6)
    s_nop 0
    v_mfma_f32_16x16x32_bf16 v[16:19], v[52:55], v[104:107], v[16:19]
    s_cbranch_vccnz L_is325
    s_waitcnt vmcnt(5)
    s_cbranch_scc0 L_is325
    s_waitcnt vmcnt(4)
L_is325:
    buffer_load_dwordx4 v[104:107], v1, s[24:27], s44 offen offset:1280 nt
    v_perm_b32 v56, v35, v35, v48
    v_perm_b32 v57, v35, v35, v49
    v_perm_b32 v58, v35, v35, v50
    v_perm_b32 v59, v35, v35, v51
    s_waitcnt vmcnt(6)
    s_nop 0
    v_mfma_f32_16x16x32_bf16 v[16:19], v[56:59], v[108:111], v[16:19]
    s_cbranch_vccnz L_is326
    s_waitcnt vmcnt(5)
    s_cbranch_scc0 L_is326
    s_waitcnt vmcnt(4)
L_is326:
    buffer_load_dwordx4 v[108:111], v1, s[24:27], s44 offen offset:1536 nt
    s_waitcnt lgkmcnt(0)
    v_readfirstlane_b32 s55, v2
    s_nop 1
    s_cmp_ge_u32 s55, 0x5100
    s_cselect_b32 s55, s55, 0
    s_bitcmp1_b32 s55, 1
    s_cselect_b64 vcc, -1, 0
    s_bitcmp1_b32 s55, 0
    v_perm_b32 v52, v60, v60, v44
    v_perm_b32 v53, v60, v60, v45
    v_perm_b32 v54, v60, v60, v46
    v_perm_b32 v55, v60, v60, v47
    s_waitcnt vmcnt(6)
    s_nop 0
    v_mfma_f32_16x16x32_bf16 v[20:23], v[52:55], v[120:123], 0
    s_cbranch_vccnz L_is327
    s_waitcnt vmcnt(5)
    s_cbranch_scc0 L_is327
    s_waitcnt vmcnt(4)
L_is327:
    buffer_load_dwordx4 v[120:123], v1, s[24:27], s44 offen offset:1792 nt
    v_mov_b32 v3, 80
    ds_write_b32 v9, v3 offset:31268
    v_perm_b32 v56, v60, v60, v48
    v_perm_b32 v57, v60, v60, v49
    v_perm_b32 v58, v60, v60, v50
    v_perm_b32 v59, v60, v60, v51
    s_waitcnt vmcnt(6)
    s_nop 0
    v_mfma_f32_16x16x32_bf16 v[20:23], v[56:59], v[112:115], v[20:23]
    s_cbranch_vccnz L_is328
    s_waitcnt vmcnt(5)
    s_cbranch_scc0 L_is328
    s_waitcnt vmcnt(4)
L_is328:
    s_mov_b32 s44, 0x2020000
    buffer_load_dwordx4 v[112:115], v1, s[24:27], s44 offen offset:0 nt
    ds_read_b32 v2, v15 offset:31272
    ds_read_b128 v[32:35], v5 offset:1216
    v_perm_b32 v52, v61, v61, v44
    v_perm_b32 v53, v61, v61, v45
    v_perm_b32 v54, v61, v61, v46
    v_perm_b32 v55, v61, v61, v47
    s_waitcnt vmcnt(6)
    s_nop 0
    v_mfma_f32_16x16x32_bf16 v[20:23], v[52:55], v[116:119], v[20:23]
    s_cbranch_vccnz L_is329
    s_waitcnt vmcnt(5)
    s_cbranch_scc0 L_is329
    s_waitcnt vmcnt(4)
L_is329:
    buffer_load_dwordx4 v[116:119], v1, s[24:27], s44 offen offset:256 nt
    v_perm_b32 v56, v61, v61, v48
    v_perm_b32 v57, v61, v61, v49
    v_perm_b32 v58, v61, v61, v50
    v_perm_b32 v59, v61, v61, v51
    v_permlane32_swap_b32 v16, v18
    v_permlane32_swap_b32 v17, v19
    v_add_f32 v16, v16, v18
    v_add_f32 v17, v17, v19
    ds_write_b64 v8, v[16:17] offset:0
    s_waitcnt vmcnt(6)
    v_mfma_f32_16x16x32_bf16 v[20:23], v[56:59], v[96:99], v[20:23]
    s_cbranch_vccnz L_is330
    s_waitcnt vmcnt(5)
    s_cbranch_scc0 L_is330
    s_waitcnt vmcnt(4)
L_is330:
    buffer_load_dwordx4 v[96:99], v1, s[24:27], s44 offen offset:512 nt
    s_waitcnt lgkmcnt(2)
    v_readfirstlane_b32 s55, v2
    s_nop 1
    s_cmp_ge_u32 s55, 0x5200
    s_cselect_b32 s55, s55, 0
    s_bitcmp1_b32 s55, 1
    s_cselect_b64 vcc, -1, 0
    s_bitcmp1_b32 s55, 0
    v_perm_b32 v52, v62, v62, v44
    v_perm_b32 v53, v62, v62, v45
    v_perm_b32 v54, v62, v62, v46
    v_perm_b32 v55, v62, v62, v47
    s_waitcnt vmcnt(6)
    s_nop 0
    v_mfma_f32_16x16x32_bf16 v[20:23], v[52:55], v[100:103], v[20:23]
    s_cbranch_vccnz L_is331
    s_waitcnt vmcnt(5)
    s_cbranch_scc0 L_is331
    s_waitcnt vmcnt(4)
L_is331:
    buffer_load_dwordx4 v[100:103], v1, s[24:27], s44 offen offset:768 nt
    v_mov_b32 v3, 81
    ds_write_b32 v9, v3 offset:31268
    v_perm_b32 v56, v62, v62, v48
    v_perm_b32 v57, v62, v62, v49
    v_perm_b32 v58, v62, v62, v50
    v_perm_b32 v59, v62, v62, v51
    s_waitcnt vmcnt(6)
    s_nop 0
    v_mfma_f32_16x16x32_bf16 v[20:23], v[56:59], v[104:107], v[20:23]
    s_cbranch_vccnz L_is332
    s_waitcnt vmcnt(5)
    s_cbranch_scc0 L_is332
    s_waitcnt vmcnt(4)
L_is332:
    buffer_load_dwordx4 v[104:107], v1, s[24:27], s44 offen offset:1024 nt
    ds_read_b32 v2, v15 offset:31272
    v_perm_b32 v52, v63, v63, v44
    v_perm_b32 v53, v63, v63, v45
    v_perm_b32 v54, v63, v63, v46
    v_perm_b32 v55, v63, v63, v47
    s_waitcnt vmcnt(6)
    s_nop 0
    v_mfma_f32_16x16x32_bf16 v[20:23], v[52:55], v[108:111], v[20:23]
    s_cbranch_vccnz L_is333
    s_waitcnt vmcnt(5)
    s_cbranch_scc0 L_is333
    s_waitcnt vmcnt(4)
L_is333:
    buffer_load_dwordx4 v[108:111], v1, s[24:27], s44 offen offset:1280 nt
    v_perm_b32 v56, v63, v63, v48
    v_perm_b32 v57, v63, v63, v49
    v_perm_b32 v58, v63, v63, v50
    v_perm_b32 v59, v63, v63, v51
    s_waitcnt vmcnt(6)
    s_nop 0
    v_mfma_f32_16x16x32_bf16 v[20:23], v[56:59], v[120:123], v[20:23]
    s_cbranch_vccnz L_is334
    s_waitcnt vmcnt(5)
    s_cbranch_scc0 L_is334
    s_waitcnt vmcnt(4)
L_is334:
    buffer_load_dwordx4 v[120:123], v1, s[24:27], s44 offen offset:1536 nt
    s_waitcnt lgkmcnt(0)
    v_readfirstlane_b32 s55, v2
    s_nop 1
    s_cmp_ge_u32 s55, 0x5300
    s_cselect_b32 s55, s55, 0
    s_bitcmp1_b32 s55, 1
    s_cselect_b64 vcc, -1, 0
    s_bitcmp1_b32 s55, 0
    v_perm_b32 v52, v32, v32, v44
    v_perm_b32 v53, v32, v32, v45
    v_perm_b32 v54, v32, v32, v46
    v_perm_b32 v55, v32, v32, v47
    s_waitcnt vmcnt(6)
    s_nop 0
    v_mfma_f32_16x16x32_bf16 v[20:23], v[52:55], v[112:115], v[20:23]
    s_cbranch_vccnz L_is335
    s_waitcnt vmcnt(5)
    s_cbranch_scc0 L_is335
    s_waitcnt vmcnt(4)
L_is335:
    buffer_load_dwordx4 v[112:115], v1, s[24:27], s44 offen offset:1792 nt
    v_mov_b32 v3, 82
    ds_write_b32 v9, v3 offset:31268
    v_perm_b32 v56, v32, v32, v48
    v_perm_b32 v57, v32, v32, v49
    v_perm_b32 v58, v32, v32, v50
    v_perm_b32 v59, v32, v32, v51
    s_waitcnt vmcnt(6)
    s_nop 0
    v_mfma_f32_16x16x32_bf16 v[20:23], v[56:59], v[116:119], v[20:23]
    s_cbranch_vccnz L_is336
    s_waitcnt vmcnt(5)
    s_cbranch_scc0 L_is336
    s_waitcnt vmcnt(4)
L_is336:
    s_mov_b32 s44, 0x2080000
    buffer_load_dwordx4 v[116:119], v1, s[24:27], s44 offen offset:0 nt
    ds_read_b32 v2, v15 offset:31272
    ds_read_b128 v[60:63], v5 offset:1280
    v_perm_b32 v52, v33, v33, v44
    v_perm_b32 v53, v33, v33, v45
    v_perm_b32 v54, v33, v33, v46
    v_perm_b32 v55, v33, v33, v47
    s_waitcnt vmcnt(6)
    s_nop 0
    v_mfma_f32_16x16x32_bf16 v[20:23], v[52:55], v[96:99], v[20:23]
    s_cbranch_vccnz L_is337
    s_waitcnt vmcnt(5)
    s_cbranch_scc0 L_is337
    s_waitcnt vmcnt(4)
L_is337:
    buffer_load_dwordx4 v[96:99], v1, s[24:27], s44 offen offset:256 nt
    v_perm_b32 v56, v33, v33, v48
    v_perm_b32 v57, v33, v33, v49
    v_perm_b32 v58, v33, v33, v50
    v_perm_b32 v59, v33, v33, v51
    s_waitcnt vmcnt(6)
    s_nop 0
    v_mfma_f32_16x16x32_bf16 v[20:23], v[56:59], v[100:103], v[20:23]
    s_cbranch_vccnz L_is338
    s_waitcnt vmcnt(5)
    s_cbranch_scc0 L_is338
    s_waitcnt vmcnt(4)
L_is338:
    buffer_load_dwordx4 v[100:103], v1, s[24:27], s44 offen offset:512 nt
    s_waitcnt lgkmcnt(1)
    v_readfirstlane_b32 s55, v2
    s_nop 1
    s_cmp_ge_u32 s55, 0x5400
    s_cselect_b32 s55, s55, 0
    s_bitcmp1_b32 s55, 1
    s_cselect_b64 vcc, -1, 0
    s_bitcmp1_b32 s55, 0
    v_perm_b32 v52, v34, v34, v44
    v_perm_b32 v53, v34, v34, v45
    v_perm_b32 v54, v34, v34, v46
    v_perm_b32 v55, v34, v34, v47
    s_waitcnt vmcnt(6)
    s_nop 0
    v_mfma_f32_16x16x32_bf16 v[20:23], v[52:55], v[104:107], v[20:23]
    s_cbranch_vccnz L_is339
    s_waitcnt vmcnt(5)
    s_cbranch_scc0 L_is339
    s_waitcnt vmcnt(4)
L_is339:
    buffer_load_dwordx4 v[104:107], v1, s[24:27], s44 offen offset:768 nt
    v_mov_b32 v3, 83
    ds_write_b32 v9, v3 offset:31268
    v_perm_b32 v56, v34, v34, v48
    v_perm_b32 v57, v34, v34, v49
    v_perm_b32 v58, v34, v34, v50
    v_perm_b32 v59, v34, v34, v51
    s_waitcnt vmcnt(6)
    s_nop 0
    v_mfma_f32_16x16x32_bf16 v[20:23], v[56:59], v[108:111], v[20:23]
    s_cbranch_vccnz L_is340
    s_waitcnt vmcnt(5)
    s_cbranch_scc0 L_is340
    s_waitcnt vmcnt(4)
L_is340:
    buffer_load_dwordx4 v[108:111], v1, s[24:27], s44 offen offset:1024 nt
    ds_read_b32 v2, v15 offset:31272
    v_perm_b32 v52, v35, v35, v44
    v_perm_b32 v53, v35, v35, v45
    v_perm_b32 v54, v35, v35, v46
    v_perm_b32 v55, v35, v35, v47
    s_waitcnt vmcnt(6)
    s_nop 0
    v_mfma_f32_16x16x32_bf16 v[20:23], v[52:55], v[120:123], v[20:23]
    s_cbranch_vccnz L_is341
    s_waitcnt vmcnt(5)
    s_cbranch_scc0 L_is341
    s_waitcnt vmcnt(4)
L_is341:
    buffer_load_dwordx4 v[120:123], v1, s[24:27], s44 offen offset:1280 nt
    v_perm_b32 v56, v35, v35, v48
    v_perm_b32 v57, v35, v35, v49
    v_perm_b32 v58, v35, v35, v50
    v_perm_b32 v59, v35, v35, v51
    s_waitcnt vmcnt(6)
    s_nop 0
    v_mfma_f32_16x16x32_bf16 v[20:23], v[56:59], v[112:115], v[20:23]
    s_cbranch_vccnz L_is342
    s_waitcnt vmcnt(5)
    s_cbranch_scc0 L_is342
    s_waitcnt vmcnt(4)
L_is342:
    buffer_load_dwordx4 v[112:115], v1, s[24:27], s44 offen offset:1536 nt
    s_waitcnt lgkmcnt(0)
    v_readfirstlane_b32 s55, v2
    s_nop 1
    s_cmp_ge_u32 s55, 0x5500
    s_cselect_b32 s55, s55, 0
    s_bitcmp1_b32 s55, 1
    s_cselect_b64 vcc, -1, 0
    s_bitcmp1_b32 s55, 0
    v_perm_b32 v52, v60, v60, v44
    v_perm_b32 v53, v60, v60, v45
    v_perm_b32 v54, v60, v60, v46
    v_perm_b32 v55, v60, v60, v47
    s_waitcnt vmcnt(6)
    s_nop 0
    v_mfma_f32_16x16x32_bf16 v[20:23], v[52:55], v[116:119], v[20:23]
    s_cbranch_vccnz L_is343
    s_waitcnt vmcnt(5)
    s_cbranch_scc0 L_is343
    s_waitcnt vmcnt(4)
L_is343:
    buffer_load_dwordx4 v[116:119], v1, s[24:27], s44 offen offset:1792 nt
    v_mov_b32 v3, 84
    ds_write_b32 v9, v3 offset:31268
    v_perm_b32 v56, v60, v60, v48
    v_perm_b32 v57, v60, v60, v49
    v_perm_b32 v58, v60, v60, v50
    v_perm_b32 v59, v60, v60, v51
    s_waitcnt vmcnt(6)
    s_nop 0
    v_mfma_f32_16x16x32_bf16 v[20:23], v[56:59], v[96:99], v[20:23]
    s_cbranch_vccnz L_is344
    s_waitcnt vmcnt(5)
    s_cbranch_scc0 L_is344
    s_waitcnt vmcnt(4)
L_is344:
    s_mov_b32 s44, 0x20a0000
    buffer_load_dwordx4 v[96:99], v1, s[24:27], s44 offen offset:0 nt
    ds_read_b32 v2, v15 offset:31272
    ds_read_b128 v[32:35], v5 offset:1344
    v_perm_b32 v52, v61, v61, v44
    v_perm_b32 v53, v61, v61, v45
    v_perm_b32 v54, v61, v61, v46
    v_perm_b32 v55, v61, v61, v47
    s_waitcnt vmcnt(6)
    s_nop 0
    v_mfma_f32_16x16x32_bf16 v[20:23], v[52:55], v[100:103], v[20:23]
    s_cbranch_vccnz L_is345
    s_waitcnt vmcnt(5)
    s_cbranch_scc0 L_is345
    s_waitcnt vmcnt(4)
L_is345:
    buffer_load_dwordx4 v[100:103], v1, s[24:27], s44 offen offset:256 nt
    v_perm_b32 v56, v61, v61, v48
    v_perm_b32 v57, v61, v61, v49
    v_perm_b32 v58, v61, v61, v50
    v_perm_b32 v59, v61, v61, v51
    s_waitcnt vmcnt(6)
    s_nop 0
    v_mfma_f32_16x16x32_bf16 v[20:23], v[56:59], v[104:107], v[20:23]
    s_cbranch_vccnz L_is346
    s_waitcnt vmcnt(5)
    s_cbranch_scc0 L_is346
    s_waitcnt vmcnt(4)
L_is346:
    buffer_load_dwordx4 v[104:107], v1, s[24:27], s44 offen offset:512 nt
    s_waitcnt lgkmcnt(1)
    v_readfirstlane_b32 s55, v2
    s_nop 1
    s_cmp_ge_u32 s55, 0x5600
    s_cselect_b32 s55, s55, 0
    s_bitcmp1_b32 s55, 1
    s_cselect_b64 vcc, -1, 0
    s_bitcmp1_b32 s55, 0
    v_perm_b32 v52, v62, v62, v44
    v_perm_b32 v53, v62, v62, v45
    v_perm_b32 v54, v62, v62, v46
    v_perm_b32 v55, v62, v62, v47
    s_waitcnt vmcnt(6)
    s_nop 0
    v_mfma_f32_16x16x32_bf16 v[20:23], v[52:55], v[108:111], v[20:23]
    s_cbranch_vccnz L_is347
    s_waitcnt vmcnt(5)
    s_cbranch_scc0 L_is347
    s_waitcnt vmcnt(4)
L_is347:
    buffer_load_dwordx4 v[108:111], v1, s[24:27], s44 offen offset:768 nt
    v_mov_b32 v3, 85
    ds_write_b32 v9, v3 offset:31268
    v_perm_b32 v56, v62, v62, v48
    v_perm_b32 v57, v62, v62, v49
    v_perm_b32 v58, v62, v62, v50
    v_perm_b32 v59, v62, v62, v51
    s_waitcnt vmcnt(6)
    s_nop 0
    v_mfma_f32_16x16x32_bf16 v[20:23], v[56:59], v[120:123], v[20:23]
    s_cbranch_vccnz L_is348
    s_waitcnt vmcnt(5)
    s_cbranch_scc0 L_is348
    s_waitcnt vmcnt(4)
L_is348:
    buffer_load_dwordx4 v[120:123], v1, s[24:27], s44 offen offset:1024 nt
    ds_read_b32 v2, v15 offset:31272
    v_perm_b32 v52, v63, v63, v44
    v_perm_b32 v53, v63, v63, v45
    v_perm_b32 v54, v63, v63, v46
    v_perm_b32 v55, v63, v63, v47
    s_waitcnt vmcnt(6)
    s_nop 0
    v_mfma_f32_16x16x32_bf16 v[20:23], v[52:55], v[112:115], v[20:23]
    s_cbranch_vccnz L_is349
    s_waitcnt vmcnt(5)
    s_cbranch_scc0 L_is349
    s_waitcnt vmcnt(4)
L_is349:
    buffer_load_dwordx4 v[112:115], v1, s[24:27], s44 offen offset:1280 nt
    v_perm_b32 v56, v63, v63, v48
    v_perm_b32 v57, v63, v63, v49
    v_perm_b32 v58, v63, v63, v50
    v_perm_b32 v59, v63, v63, v51
    s_waitcnt vmcnt(6)
    s_nop 0
    v_mfma_f32_16x16x32_bf16 v[20:23], v[56:59], v[116:119], v[20:23]
    s_cbranch_vccnz L_is350
    s_waitcnt vmcnt(5)
    s_cbranch_scc0 L_is350
    s_waitcnt vmcnt(4)
L_is350:
    buffer_load_dwordx4 v[116:119], v1, s[24:27], s44 offen offset:1536 nt
    s_waitcnt lgkmcnt(0)
    v_readfirstlane_b32 s55, v2
    s_nop 1
    s_cmp_ge_u32 s55, 0x5700
    s_cselect_b32 s55, s55, 0
    s_bitcmp1_b32 s55, 1
    s_cselect_b64 vcc, -1, 0
    s_bitcmp1_b32 s55, 0
    v_perm_b32 v52, v32, v32, v44
    v_perm_b32 v53, v32, v32, v45
    v_perm_b32 v54, v32, v32, v46
    v_perm_b32 v55, v32, v32, v47
    s_waitcnt vmcnt(6)
    s_nop 0
    v_mfma_f32_16x16x32_bf16 v[20:23], v[52:55], v[96:99], v[20:23]
    s_cbranch_vccnz L_is351
    s_waitcnt vmcnt(5)
    s_cbranch_scc0 L_is351
    s_waitcnt vmcnt(4)
L_is351:
    buffer_load_dwordx4 v[96:99], v1, s[24:27], s44 offen offset:1792 nt
    v_mov_b32 v3, 86
    ds_write_b32 v9, v3 offset:31268
    v_perm_b32 v56, v32, v32, v48
    v_perm_b32 v57, v32, v32, v49
    v_perm_b32 v58, v32, v32, v50
    v_perm_b32 v59, v32, v32, v51
    s_waitcnt vmcnt(6)
    s_nop 0
    v_mfma_f32_16x16x32_bf16 v[20:23], v[56:59], v[100:103], v[20:23]
    s_cbranch_vccnz L_is352
    s_waitcnt vmcnt(5)
    s_cbranch_scc0 L_is352
    s_waitcnt vmcnt(4)
L_is352:
    s_mov_b32 s44, 0x2100000
    buffer_load_dwordx4 v[100:103], v1, s[24:27], s44 offen offset:0 nt
    ds_read_b32 v2, v15 offset:31272
    ds_read_b128 v[60:63], v5 offset:1408
    v_perm_b32 v52, v33, v33, v44
    v_perm_b32 v53, v33, v33, v45
    v_perm_b32 v54, v33, v33, v46
    v_perm_b32 v55, v33, v33, v47
    s_waitcnt vmcnt(6)
    s_nop 0
    v_mfma_f32_16x16x32_bf16 v[20:23], v[52:55], v[104:107], v[20:23]
    s_cbranch_vccnz L_is353
    s_waitcnt vmcnt(5)
    s_cbranch_scc0 L_is353
    s_waitcnt vmcnt(4)
L_is353:
    buffer_load_dwordx4 v[104:107], v1, s[24:27], s44 offen offset:256 nt
    v_perm_b32 v56, v33, v33, v48
    v_perm_b32 v57, v33, v33, v49
    v_perm_b32 v58, v33, v33, v50
    v_perm_b32 v59, v33, v33, v51
    s_waitcnt vmcnt(6)
    s_nop 0
    v_mfma_f32_16x16x32_bf16 v[20:23], v[56:59], v[108:111], v[20:23]
    s_cbranch_vccnz L_is354
    s_waitcnt vmcnt(5)
    s_cbranch_scc0 L_is354
    s_waitcnt vmcnt(4)
L_is354:
    buffer_load_dwordx4 v[108:111], v1, s[24:27], s44 offen offset:512 nt
    s_waitcnt lgkmcnt(1)
    v_readfirstlane_b32 s55, v2
    s_nop 1
    s_cmp_ge_u32 s55, 0x5800
    s_cselect_b32 s55, s55, 0
    s_bitcmp1_b32 s55, 1
    s_cselect_b64 vcc, -1, 0
    s_bitcmp1_b32 s55, 0
    v_perm_b32 v52, v34, v34, v44
    v_perm_b32 v53, v34, v34, v45
    v_perm_b32 v54, v34, v34, v46
    v_perm_b32 v55, v34, v34, v47
    s_waitcnt vmcnt(6)
    s_nop 0
    v_mfma_f32_16x16x32_bf16 v[20:23], v[52:55], v[120:123], v[20:23]
    s_cbranch_vccnz L_is355
    s_waitcnt vmcnt(5)
    s_cbranch_scc0 L_is355
    s_waitcnt vmcnt(4)
L_is355:
    buffer_load_dwordx4 v[120:123], v1, s[24:27], s44 offen offset:768 nt
    v_mov_b32 v3, 87
    ds_write_b32 v9, v3 offset:31268
    v_perm_b32 v56, v34, v34, v48
    v_perm_b32 v57, v34, v34, v49
    v_perm_b32 v58, v34, v34, v50
    v_perm_b32 v59, v34, v34, v51
    s_waitcnt vmcnt(6)
    s_nop 0
    v_mfma_f32_16x16x32_bf16 v[20:23], v[56:59], v[112:115], v[20:23]
    s_cbranch_vccnz L_is356
    s_waitcnt vmcnt(5)
    s_cbranch_scc0 L_is356
    s_waitcnt vmcnt(4)
L_is356:
    buffer_load_dwordx4 v[112:115], v1, s[24:27], s44 offen offset:1024 nt
    ds_read_b32 v2, v15 offset:31272
    v_perm_b32 v52, v35, v35, v44
    v_perm_b32 v53, v35, v35, v45
    v_perm_b32 v54, v35, v35, v46
    v_perm_b32 v55, v35, v35, v47
    s_waitcnt vmcnt(6)
    s_nop 0
    v_mfma_f32_16x16x32_bf16 v[20:23], v[52:55], v[116:119], v[20:23]
    s_cbranch_vccnz L_is357
    s_waitcnt vmcnt(5)
    s_cbranch_scc0 L_is357
    s_waitcnt vmcnt(4)
L_is357:
    buffer_load_dwordx4 v[116:119], v1, s[24:27], s44 offen offset:1280 nt
    v_perm_b32 v56, v35, v35, v48
    v_perm_b32 v57, v35, v35, v49
    v_perm_b32 v58, v35, v35, v50
    v_perm_b32 v59, v35, v35, v51
    s_waitcnt vmcnt(6)
    s_nop 0
    v_mfma_f32_16x16x32_bf16 v[20:23], v[56:59], v[96:99], v[20:23]
    s_cbranch_vccnz L_is358
    s_waitcnt vmcnt(5)
    s_cbranch_scc0 L_is358
    s_waitcnt vmcnt(4)
L_is358:
    buffer_load_dwordx4 v[96:99], v1, s[24:27], s44 offen offset:1536 nt
    s_waitcnt lgkmcnt(0)
    v_readfirstlane_b32 s55, v2
    s_nop 1
    s_cmp_ge_u32 s55, 0x5900
    s_cselect_b32 s55, s55, 0
    s_bitcmp1_b32 s55, 1
    s_cselect_b64 vcc, -1, 0
    s_bitcmp1_b32 s55, 0
    v_perm_b32 v52, v60, v60, v44
    v_perm_b32 v53, v60, v60, v45
    v_perm_b32 v54, v60, v60, v46
    v_perm_b32 v55, v60, v60, v47
    s_waitcnt vmcnt(6)
    s_nop 0
    v_mfma_f32_16x16x32_bf16 v[20:23], v[52:55], v[100:103], v[20:23]
    s_cbranch_vccnz L_is359
    s_waitcnt vmcnt(5)
    s_cbranch_scc0 L_is359
    s_waitcnt vmcnt(4)
L_is359:
    buffer_load_dwordx4 v[100:103], v1, s[24:27], s44 offen offset:1792 nt
    v_mov_b32 v3, 88
    ds_write_b32 v9, v3 offset:31268
    v_perm_b32 v56, v60, v60, v48
    v_perm_b32 v57, v60, v60, v49
    v_perm_b32 v58, v60, v60, v50
    v_perm_b32 v59, v60, v60, v51
    s_waitcnt vmcnt(6)
    s_nop 0
    v_mfma_f32_16x16x32_bf16 v[20:23], v[56:59], v[104:107], v[20:23]
    s_cbranch_vccnz L_is360
    s_waitcnt vmcnt(5)
    s_cbranch_scc0 L_is360
    s_waitcnt vmcnt(4)
L_is360:
    s_mov_b32 s44, 0x2120000
    buffer_load_dwordx4 v[104:107], v1, s[24:27], s44 offen offset:0 nt
    ds_read_b32 v2, v15 offset:31272
    ds_read_b128 v[32:35], v5 offset:1472
    v_perm_b32 v52, v61, v61, v44
    v_perm_b32 v53, v61, v61, v45
    v_perm_b32 v54, v61, v61, v46
    v_perm_b32 v55, v61, v61, v47
    s_waitcnt vmcnt(6)
    s_nop 0
    v_mfma_f32_16x16x32_bf16 v[20:23], v[52:55], v[108:111], v[20:23]
    s_cbranch_vccnz L_is361
    s_waitcnt vmcnt(5)
    s_cbranch_scc0 L_is361
    s_waitcnt vmcnt(4)
L_is361:
    buffer_load_dwordx4 v[108:111], v1, s[24:27], s44 offen offset:256 nt
    v_perm_b32 v56, v61, v61, v48
    v_perm_b32 v57, v61, v61, v49
    v_perm_b32 v58, v61, v61, v50
    v_perm_b32 v59, v61, v61, v51
    s_waitcnt vmcnt(6)
    s_nop 0
    v_mfma_f32_16x16x32_bf16 v[20:23], v[56:59], v[120:123], v[20:23]
    s_cbranch_vccnz L_is362
    s_waitcnt vmcnt(5)
    s_cbranch_scc0 L_is362
    s_waitcnt vmcnt(4)
L_is362:
    buffer_load_dwordx4 v[120:123], v1, s[24:27], s44 offen offset:512 nt
    s_waitcnt lgkmcnt(1)
    v_readfirstlane_b32 s55, v2
    s_nop 1
    s_cmp_ge_u32 s55, 0x5a00
    s_cselect_b32 s55, s55, 0
    s_bitcmp1_b32 s55, 1
    s_cselect_b64 vcc, -1, 0
    s_bitcmp1_b32 s55, 0
    v_perm_b32 v52, v62, v62, v44
    v_perm_b32 v53, v62, v62, v45
    v_perm_b32 v54, v62, v62, v46
    v_perm_b32 v55, v62, v62, v47
    s_waitcnt vmcnt(6)
    s_nop 0
    v_mfma_f32_16x16x32_bf16 v[20:23], v[52:55], v[112:115], v[20:23]
    s_cbranch_vccnz L_is363
    s_waitcnt vmcnt(5)
    s_cbranch_scc0 L_is363
    s_waitcnt vmcnt(4)
L_is363:
    buffer_load_dwordx4 v[112:115], v1, s[24:27], s44 offen offset:768 nt
    v_mov_b32 v3, 89
    ds_write_b32 v9, v3 offset:31268
    v_perm_b32 v56, v62, v62, v48
    v_perm_b32 v57, v62, v62, v49
    v_perm_b32 v58, v62, v62, v50
    v_perm_b32 v59, v62, v62, v51
    s_waitcnt vmcnt(6)
    s_nop 0
    v_mfma_f32_16x16x32_bf16 v[20:23], v[56:59], v[116:119], v[20:23]
    s_cbranch_vccnz L_is364
    s_waitcnt vmcnt(5)
    s_cbranch_scc0 L_is364
    s_waitcnt vmcnt(4)
L_is364:
    buffer_load_dwordx4 v[116:119], v1, s[24:27], s44 offen offset:1024 nt
    ds_read_b32 v2, v15 offset:31272
    v_perm_b32 v52, v63, v63, v44
    v_perm_b32 v53, v63, v63, v45
    v_perm_b32 v54, v63, v63, v46
    v_perm_b32 v55, v63, v63, v47
    s_waitcnt vmcnt(6)
    s_nop 0
    v_mfma_f32_16x16x32_bf16 v[20:23], v[52:55], v[96:99], v[20:23]
    s_cbranch_vccnz L_is365
    s_waitcnt vmcnt(5)
    s_cbranch_scc0 L_is365
    s_waitcnt vmcnt(4)
L_is365:
    buffer_load_dwordx4 v[96:99], v1, s[24:27], s44 offen offset:1280 nt
    v_perm_b32 v56, v63, v63, v48
    v_perm_b32 v57, v63, v63, v49
    v_perm_b32 v58, v63, v63, v50
    v_perm_b32 v59, v63, v63, v51
    s_waitcnt vmcnt(6)
    s_nop 0
    v_mfma_f32_16x16x32_bf16 v[20:23], v[56:59], v[100:103], v[20:23]
    s_cbranch_vccnz L_is366
    s_waitcnt vmcnt(5)
    s_cbranch_scc0 L_is366
    s_waitcnt vmcnt(4)
L_is366:
    buffer_load_dwordx4 v[100:103], v1, s[24:27], s44 offen offset:1536 nt
    s_waitcnt lgkmcnt(0)
    v_readfirstlane_b32 s55, v2
    s_nop 1
    s_cmp_ge_u32 s55, 0x5b00
    s_cselect_b32 s55, s55, 0
    s_bitcmp1_b32 s55, 1
    s_cselect_b64 vcc, -1, 0
    s_bitcmp1_b32 s55, 0
    v_perm_b32 v52, v32, v32, v44
    v_perm_b32 v53, v32, v32, v45
    v_perm_b32 v54, v32, v32, v46
    v_perm_b32 v55, v32, v32, v47
    s_waitcnt vmcnt(6)
    s_nop 0
    v_mfma_f32_16x16x32_bf16 v[20:23], v[52:55], v[104:107], v[20:23]
    s_cbranch_vccnz L_is367
    s_waitcnt vmcnt(5)
    s_cbranch_scc0 L_is367
    s_waitcnt vmcnt(4)
L_is367:
    buffer_load_dwordx4 v[104:107], v1, s[24:27], s44 offen offset:1792 nt
    v_mov_b32 v3, 90
    ds_write_b32 v9, v3 offset:31268
    v_perm_b32 v56, v32, v32, v48
    v_perm_b32 v57, v32, v32, v49
    v_perm_b32 v58, v32, v32, v50
    v_perm_b32 v59, v32, v32, v51
    s_waitcnt vmcnt(6)
    s_nop 0
    v_mfma_f32_16x16x32_bf16 v[20:23], v[56:59], v[108:111], v[20:23]
    s_cbranch_vccnz L_is368
    s_waitcnt vmcnt(5)
    s_cbranch_scc0 L_is368
    s_waitcnt vmcnt(4)
L_is368:
    s_mov_b32 s44, 0x2180000
    buffer_load_dwordx4 v[108:111], v1, s[24:27], s44 offen offset:0 nt
    ds_read_b32 v2, v15 offset:31272
    ds_read_b128 v[60:63], v5 offset:1536
    v_perm_b32 v52, v33, v33, v44
    v_perm_b32 v53, v33, v33, v45
    v_perm_b32 v54, v33, v33, v46
    v_perm_b32 v55, v33, v33, v47
    s_waitcnt vmcnt(6)
    s_nop 0
    v_mfma_f32_16x16x32_bf16 v[20:23], v[52:55], v[120:123], v[20:23]
    s_cbranch_vccnz L_is369
    s_waitcnt vmcnt(5)
    s_cbranch_scc0 L_is369
    s_waitcnt vmcnt(4)
L_is369:
    buffer_load_dwordx4 v[120:123], v1, s[24:27], s44 offen offset:256 nt
    v_perm_b32 v56, v33, v33, v48
    v_perm_b32 v57, v33, v33, v49
    v_perm_b32 v58, v33, v33, v50
    v_perm_b32 v59, v33, v33, v51
    s_waitcnt vmcnt(6)
    s_nop 0
    v_mfma_f32_16x16x32_bf16 v[20:23], v[56:59], v[112:115], v[20:23]
    s_cbranch_vccnz L_is370
    s_waitcnt vmcnt(5)
    s_cbranch_scc0 L_is370
    s_waitcnt vmcnt(4)
L_is370:
    buffer_load_dwordx4 v[112:115], v1, s[24:27], s44 offen offset:512 nt
    s_waitcnt lgkmcnt(1)
    v_readfirstlane_b32 s55, v2
    s_nop 1
    s_cmp_ge_u32 s55, 0x5c00
    s_cselect_b32 s55, s55, 0
    s_bitcmp1_b32 s55, 1
    s_cselect_b64 vcc, -1, 0
    s_bitcmp1_b32 s55, 0
    v_perm_b32 v52, v34, v34, v44
    v_perm_b32 v53, v34, v34, v45
    v_perm_b32 v54, v34, v34, v46
    v_perm_b32 v55, v34, v34, v47
    s_waitcnt vmcnt(6)
    s_nop 0
    v_mfma_f32_16x16x32_bf16 v[20:23], v[52:55], v[116:119], v[20:23]
    s_cbranch_vccnz L_is371
    s_waitcnt vmcnt(5)
    s_cbranch_scc0 L_is371
    s_waitcnt vmcnt(4)
L_is371:
    buffer_load_dwordx4 v[116:119], v1, s[24:27], s44 offen offset:768 nt
    v_mov_b32 v3, 91
    ds_write_b32 v9, v3 offset:31268
    v_perm_b32 v56, v34, v34, v48
    v_perm_b32 v57, v34, v34, v49
    v_perm_b32 v58, v34, v34, v50
    v_perm_b32 v59, v34, v34, v51
    s_waitcnt vmcnt(6)
    s_nop 0
    v_mfma_f32_16x16x32_bf16 v[20:23], v[56:59], v[96:99], v[20:23]
    s_cbranch_vccnz L_is372
    s_waitcnt vmcnt(5)
    s_cbranch_scc0 L_is372
    s_waitcnt vmcnt(4)
L_is372:
    buffer_load_dwordx4 v[96:99], v1, s[24:27], s44 offen offset:1024 nt
    ds_read_b32 v2, v15 offset:31272
    v_perm_b32 v52, v35, v35, v44
    v_perm_b32 v53, v35, v35, v45
    v_perm_b32 v54, v35, v35, v46
    v_perm_b32 v55, v35, v35, v47
    s_waitcnt vmcnt(6)
    s_nop 0
    v_mfma_f32_16x16x32_bf16 v[20:23], v[52:55], v[100:103], v[20:23]
    s_cbranch_vccnz L_is373
    s_waitcnt vmcnt(5)
    s_cbranch_scc0 L_is373
    s_waitcnt vmcnt(4)
L_is373:
    buffer_load_dwordx4 v[100:103], v1, s[24:27], s44 offen offset:1280 nt
    v_perm_b32 v56, v35, v35, v48
    v_perm_b32 v57, v35, v35, v49
    v_perm_b32 v58, v35, v35, v50
    v_perm_b32 v59, v35, v35, v51
    s_waitcnt vmcnt(6)
    s_nop 0
    v_mfma_f32_16x16x32_bf16 v[20:23], v[56:59], v[104:107], v[20:23]
    s_cbranch_vccnz L_is374
    s_waitcnt vmcnt(5)
    s_cbranch_scc0 L_is374
    s_waitcnt vmcnt(4)
L_is374:
    buffer_load_dwordx4 v[104:107], v1, s[24:27], s44 offen offset:1536 nt
    s_waitcnt lgkmcnt(0)
    v_readfirstlane_b32 s55, v2
    s_nop 1
    s_cmp_ge_u32 s55, 0x5d00
    s_cselect_b32 s55, s55, 0
    s_bitcmp1_b32 s55, 1
    s_cselect_b64 vcc, -1, 0
    s_bitcmp1_b32 s55, 0
    v_perm_b32 v52, v60, v60, v44
    v_perm_b32 v53, v60, v60, v45
    v_perm_b32 v54, v60, v60, v46
    v_perm_b32 v55, v60, v60, v47
    s_waitcnt vmcnt(6)
    s_nop 0
    v_mfma_f32_16x16x32_bf16 v[20:23], v[52:55], v[108:111], v[20:23]
    s_cbranch_vccnz L_is375
    s_waitcnt vmcnt(5)
    s_cbranch_scc0 L_is375
    s_waitcnt vmcnt(4)
L_is375:
    buffer_load_dwordx4 v[108:111], v1, s[24:27], s44 offen offset:1792 nt
    v_mov_b32 v3, 92
    ds_write_b32 v9, v3 offset:31268
    v_perm_b32 v56, v60, v60, v48
    v_perm_b32 v57, v60, v60, v49
    v_perm_b32 v58, v60, v60, v50
    v_perm_b32 v59, v60, v60, v51
    s_waitcnt vmcnt(6)
    s_nop 0
    v_mfma_f32_16x16x32_bf16 v[20:23], v[56:59], v[120:123], v[20:23]
    s_cbranch_vccnz L_is376
    s_waitcnt vmcnt(5)
    s_cbranch_scc0 L_is376
    s_waitcnt vmcnt(4)
L_is376:
    s_mov_b32 s44, 0x21a0000
    buffer_load_dwordx4 v[120:123], v1, s[24:27], s44 offen offset:0 nt
    ds_read_b32 v2, v15 offset:31272
    ds_read_b128 v[32:35], v5 offset:1600
    v_perm_b32 v52, v61, v61, v44
    v_perm_b32 v53, v61, v61, v45
    v_perm_b32 v54, v61, v61, v46
    v_perm_b32 v55, v61, v61, v47
    s_waitcnt vmcnt(6)
    s_nop 0
    v_mfma_f32_16x16x32_bf16 v[20:23], v[52:55], v[112:115], v[20:23]
    s_cbranch_vccnz L_is377
    s_waitcnt vmcnt(5)
    s_cbranch_scc0 L_is377
    s_waitcnt vmcnt(4)
L_is377:
    buffer_load_dwordx4 v[112:115], v1, s[24:27], s44 offen offset:256 nt
    v_perm_b32 v56, v61, v61, v48
    v_perm_b32 v57, v61, v61, v49
    v_perm_b32 v58, v61, v61, v50
    v_perm_b32 v59, v61, v61, v51
    s_waitcnt vmcnt(6)
    s_nop 0
    v_mfma_f32_16x16x32_bf16 v[20:23], v[56:59], v[116:119], v[20:23]
    s_cbranch_vccnz L_is378
    s_waitcnt vmcnt(5)
    s_cbranch_scc0 L_is378
    s_waitcnt vmcnt(4)
L_is378:
    buffer_load_dwordx4 v[116:119], v1, s[24:27], s44 offen offset:512 nt
    s_waitcnt lgkmcnt(1)
    v_readfirstlane_b32 s55, v2
    s_nop 1
    s_cmp_ge_u32 s55, 0x5e00
    s_cselect_b32 s55, s55, 0
    s_bitcmp1_b32 s55, 1
    s_cselect_b64 vcc, -1, 0
    s_bitcmp1_b32 s55, 0
    v_perm_b32 v52, v62, v62, v44
    v_perm_b32 v53, v62, v62, v45
    v_perm_b32 v54, v62, v62, v46
    v_perm_b32 v55, v62, v62, v47
    s_waitcnt vmcnt(6)
    s_nop 0
    v_mfma_f32_16x16x32_bf16 v[20:23], v[52:55], v[96:99], v[20:23]
    s_cbranch_vccnz L_is379
    s_waitcnt vmcnt(5)
    s_cbranch_scc0 L_is379
    s_waitcnt vmcnt(4)
L_is379:
    buffer_load_dwordx4 v[96:99], v1, s[24:27], s44 offen offset:768 nt
    v_mov_b32 v3, 93
    ds_write_b32 v9, v3 offset:31268
    v_perm_b32 v56, v62, v62, v48
    v_perm_b32 v57, v62, v62, v49
    v_perm_b32 v58, v62, v62, v50
    v_perm_b32 v59, v62, v62, v51
    s_waitcnt vmcnt(6)
    s_nop 0
    v_mfma_f32_16x16x32_bf16 v[20:23], v[56:59], v[100:103], v[20:23]
    s_cbranch_vccnz L_is380
    s_waitcnt vmcnt(5)
    s_cbranch_scc0 L_is380
    s_waitcnt vmcnt(4)
L_is380:
    buffer_load_dwordx4 v[100:103], v1, s[24:27], s44 offen offset:1024 nt
    ds_read_b32 v2, v15 offset:31272
    v_perm_b32 v52, v63, v63, v44
    v_perm_b32 v53, v63, v63, v45
    v_perm_b32 v54, v63, v63, v46
    v_perm_b32 v55, v63, v63, v47
    s_waitcnt vmcnt(6)
    s_nop 0
    v_mfma_f32_16x16x32_bf16 v[20:23], v[52:55], v[104:107], v[20:23]
    s_cbranch_vccnz L_is381
    s_waitcnt vmcnt(5)
    s_cbranch_scc0 L_is381
    s_waitcnt vmcnt(4)
L_is381:
    buffer_load_dwordx4 v[104:107], v1, s[24:27], s44 offen offset:1280 nt
    ds_read_b128 v[64:67], v15 offset:31248
    v_perm_b32 v56, v63, v63, v48
    v_perm_b32 v57, v63, v63, v49
    v_perm_b32 v58, v63, v63, v50
    v_perm_b32 v59, v63, v63, v51
    s_waitcnt vmcnt(6)
    s_nop 0
    v_mfma_f32_16x16x32_bf16 v[20:23], v[56:59], v[108:111], v[20:23]
    s_cbranch_vccnz L_is382
    s_waitcnt vmcnt(5)
    s_cbranch_scc0 L_is382
    s_waitcnt vmcnt(4)
L_is382:
    buffer_load_dwordx4 v[108:111], v1, s[24:27], s44 offen offset:1536 nt
    s_waitcnt lgkmcnt(1)
    v_readfirstlane_b32 s55, v2
    s_nop 1
    s_cmp_ge_u32 s55, 0x5f00
    s_cselect_b32 s55, s55, 0
    s_bitcmp1_b32 s55, 1
    s_cselect_b64 vcc, -1, 0
    s_bitcmp1_b32 s55, 0
    v_perm_b32 v52, v32, v32, v44
    v_perm_b32 v53, v32, v32, v45
    v_perm_b32 v54, v32, v32, v46
    v_perm_b32 v55, v32, v32, v47
    s_waitcnt vmcnt(6)
    s_nop 0
    v_mfma_f32_16x16x32_bf16 v[20:23], v[52:55], v[120:123], v[20:23]
    s_cbranch_vccnz L_is383
    s_waitcnt vmcnt(5)
    s_cbranch_scc0 L_is383
    s_waitcnt vmcnt(4)
L_is383:
    buffer_load_dwordx4 v[120:123], v1, s[24:27], s44 offen offset:1792 nt
    v_mov_b32 v3, 94
    ds_write_b32 v9, v3 offset:31268
    v_perm_b32 v56, v32, v32, v48
    v_perm_b32 v57, v32, v32, v49
    v_perm_b32 v58, v32, v32, v50
    v_perm_b32 v59, v32, v32, v51
    s_waitcnt vmcnt(6)
    s_nop 0
    v_mfma_f32_16x16x32_bf16 v[20:23], v[56:59], v[112:115], v[20:23]
    s_cbranch_vccnz L_is384
    s_waitcnt vmcnt(5)
    s_cbranch_scc0 L_is384
    s_waitcnt vmcnt(4)
L_is384:
    s_mov_b32 s44, 0x8000000
    buffer_load_dwordx4 v[112:115], v1, s[24:27], s44 offen offset:0 nt
    ds_read_b32 v2, v15 offset:31272
    s_waitcnt lgkmcnt(2)
L_wchk1:
    v_and_b32 v64, v64, v65
    v_and_b32 v66, v66, v67
    v_and_b32 v64, v64, v66
    s_nop 0
    v_readfirstlane_b32 s55, v64
    s_nop 1
    s_cmp_lg_u32 s55, 0
    s_cbranch_scc1 L_wok1
    s_sleep 2
    ds_read_b128 v[64:67], v15 offset:31248
    s_waitcnt lgkmcnt(0)
    s_branch L_wchk1
L_wok1:
    s_cmp_lg_u32 0, 0
    ds_read_b128 v[60:63], v5 offset:2304
    v_perm_b32 v52, v33, v33, v44
    v_perm_b32 v53, v33, v33, v45
    v_perm_b32 v54, v33, v33, v46
    v_perm_b32 v55, v33, v33, v47
    s_waitcnt vmcnt(6)
    s_nop 0
    v_mfma_f32_16x16x32_bf16 v[20:23], v[52:55], v[116:119], v[20:23]
    s_cbranch_vccnz L_is385
    s_waitcnt vmcnt(5)
    s_cbranch_scc0 L_is385
    s_waitcnt vmcnt(4)
L_is385:
    buffer_load_dwordx4 v[116:119], v1, s[24:27], s44 offen offset:256 nt
    v_perm_b32 v56, v33, v33, v48
    v_perm_b32 v57, v33, v33, v49
    v_perm_b32 v58, v33, v33, v50
    v_perm_b32 v59, v33, v33, v51
    s_waitcnt vmcnt(6)
    s_nop 0
    v_mfma_f32_16x16x32_bf16 v[20:23], v[56:59], v[96:99], v[20:23]
    s_cbranch_vccnz L_is386
    s_waitcnt vmcnt(5)
    s_cbranch_scc0 L_is386
    s_waitcnt vmcnt(4)
L_is386:
    buffer_load_dwordx4 v[96:99], v1, s[24:27], s44 offen offset:512 nt
    s_waitcnt lgkmcnt(1)
    v_readfirstlane_b32 s55, v2
    s_nop 1
    s_cmp_ge_u32 s55, 0x6000
    s_cselect_b32 s55, s55, 0
    s_bitcmp1_b32 s55, 1
    s_cselect_b64 vcc, -1, 0
    s_bitcmp1_b32 s55, 0
    v_perm_b32 v52, v34, v34, v44
    v_perm_b32 v53, v34, v34, v45
    v_perm_b32 v54, v34, v34, v46
    v_perm_b32 v55, v34, v34, v47
    s_waitcnt vmcnt(6)
    s_nop 0
    v_mfma_f32_16x16x32_bf16 v[20:23], v[52:55], v[100:103], v[20:23]
    s_cbranch_vccnz L_is387
    s_waitcnt vmcnt(5)
    s_cbranch_scc0 L_is387
    s_waitcnt vmcnt(4)
L_is387:
    buffer_load_dwordx4 v[100:103], v1, s[24:27], s44 offen offset:768 nt
    v_mov_b32 v3, 95
    ds_write_b32 v9, v3 offset:31268
    v_perm_b32 v56, v34, v34, v48
    v_perm_b32 v57, v34, v34, v49
    v_perm_b32 v58, v34, v34, v50
    v_perm_b32 v59, v34, v34, v51
    s_waitcnt vmcnt(6)
    s_nop 0
    v_mfma_f32_16x16x32_bf16 v[20:23], v[56:59], v[104:107], v[20:23]
    s_cbranch_vccnz L_is388
    s_waitcnt vmcnt(5)
    s_cbranch_scc0 L_is388
    s_waitcnt vmcnt(4)
L_is388:
    buffer_load_dwordx4 v[104:107], v1, s[24:27], s44 offen offset:1024 nt
    ds_read_b32 v2, v15 offset:31272
    v_perm_b32 v52, v35, v35, v44
    v_perm_b32 v53, v35, v35, v45
    v_perm_b32 v54, v35, v35, v46
    v_perm_b32 v55, v35, v35, v47
    s_waitcnt vmcnt(6)
    s_nop 0
    v_mfma_f32_16x16x32_bf16 v[20:23], v[52:55], v[108:111], v[20:23]
    s_cbranch_vccnz L_is389
    s_waitcnt vmcnt(5)
    s_cbranch_scc0 L_is389
    s_waitcnt vmcnt(4)
L_is389:
    buffer_load_dwordx4 v[108:111], v1, s[24:27], s44 offen offset:1280 nt
    v_perm_b32 v56, v35, v35, v48
    v_perm_b32 v57, v35, v35, v49
    v_perm_b32 v58, v35, v35, v50
    v_perm_b32 v59, v35, v35, v51
    s_waitcnt vmcnt(6)
    s_nop 0
    v_mfma_f32_16x16x32_bf16 v[20:23], v[56:59], v[120:123], v[20:23]
    s_cbranch_vccnz L_is390
    s_waitcnt vmcnt(5)
    s_cbranch_scc0 L_is390
    s_waitcnt vmcnt(4)
L_is390:
    buffer_load_dwordx4 v[120:123], v1, s[24:27], s44 offen offset:1536 nt
    s_waitcnt lgkmcnt(0)
    v_readfirstlane_b32 s55, v2
    s_nop 1
    s_cmp_ge_u32 s55, 0x6100
    s_cselect_b32 s55, s55, 0
    s_bitcmp1_b32 s55, 1
    s_cselect_b64 vcc, -1, 0
    s_bitcmp1_b32 s55, 0
    v_perm_b32 v52, v60, v60, v44
    v_perm_b32 v53, v60, v60, v45
    v_perm_b32 v54, v60, v60, v46
    v_perm_b32 v55, v60, v60, v47
    s_waitcnt vmcnt(6)
    s_nop 0
    v_mfma_f32_16x16x32_bf16 v[24:27], v[52:55], v[112:115], 0
    s_cbranch_vccnz L_is391
    s_waitcnt vmcnt(5)
    s_cbranch_scc0 L_is391
    s_waitcnt vmcnt(4)
L_is391:
    buffer_load_dwordx4 v[112:115], v1, s[24:27], s44 offen offset:1792 nt
    v_mov_b32 v3, 96
    ds_write_b32 v9, v3 offset:31268
    v_perm_b32 v56, v60, v60, v48
    v_perm_b32 v57, v60, v60, v49
    v_perm_b32 v58, v60, v60, v50
    v_perm_b32 v59, v60, v60, v51
    s_waitcnt vmcnt(6)
    s_nop 0
    v_mfma_f32_16x16x32_bf16 v[24:27], v[56:59], v[116:119], v[24:27]
    s_cbranch_vccnz L_is392
    s_waitcnt vmcnt(5)
    s_cbranch_scc0 L_is392
    s_waitcnt vmcnt(4)
L_is392:
    s_mov_b32 s44, 0x8020000
    buffer_load_dwordx4 v[116:119], v1, s[24:27], s44 offen offset:0 nt
    ds_read_b32 v2, v15 offset:31272
    ds_read_b128 v[32:35], v5 offset:2368
    v_perm_b32 v52, v61, v61, v44
    v_perm_b32 v53, v61, v61, v45
    v_perm_b32 v54, v61, v61, v46
    v_perm_b32 v55, v61, v61, v47
    s_waitcnt vmcnt(6)
    s_nop 0
    v_mfma_f32_16x16x32_bf16 v[24:27], v[52:55], v[96:99], v[24:27]
    s_cbranch_vccnz L_is393
    s_waitcnt vmcnt(5)
    s_cbranch_scc0 L_is393
    s_waitcnt vmcnt(4)
L_is393:
    buffer_load_dwordx4 v[96:99], v1, s[24:27], s44 offen offset:256 nt
    v_perm_b32 v56, v61, v61, v48
    v_perm_b32 v57, v61, v61, v49
    v_perm_b32 v58, v61, v61, v50
    v_perm_b32 v59, v61, v61, v51
    v_permlane32_swap_b32 v20, v22
    v_permlane32_swap_b32 v21, v23
    v_add_f32 v20, v20, v22
    v_add_f32 v21, v21, v23
    ds_write_b64 v8, v[20:21] offset:2048
    s_waitcnt vmcnt(6)
    v_mfma_f32_16x16x32_bf16 v[24:27], v[56:59], v[100:103], v[24:27]
    s_cbranch_vccnz L_is394
    s_waitcnt vmcnt(5)
    s_cbranch_scc0 L_is394
    s_waitcnt vmcnt(4)
L_is394:
    buffer_load_dwordx4 v[100:103], v1, s[24:27], s44 offen offset:512 nt
    s_waitcnt lgkmcnt(2)
    v_readfirstlane_b32 s55, v2
    s_nop 1
    s_cmp_ge_u32 s55, 0x6200
    s_cselect_b32 s55, s55, 0
    s_bitcmp1_b32 s55, 1
    s_cselect_b64 vcc, -1, 0
    s_bitcmp1_b32 s55, 0
    v_perm_b32 v52, v62, v62, v44
    v_perm_b32 v53, v62, v62, v45
    v_perm_b32 v54, v62, v62, v46
    v_perm_b32 v55, v62, v62, v47
    s_waitcnt vmcnt(6)
    s_nop 0
    v_mfma_f32_16x16x32_bf16 v[24:27], v[52:55], v[104:107], v[24:27]
    s_cbranch_vccnz L_is395
    s_waitcnt vmcnt(5)
    s_cbranch_scc0 L_is395
    s_waitcnt vmcnt(4)
L_is395:
    buffer_load_dwordx4 v[104:107], v1, s[24:27], s44 offen offset:768 nt
    v_mov_b32 v3, 97
    ds_write_b32 v9, v3 offset:31268
    v_perm_b32 v56, v62, v62, v48
    v_perm_b32 v57, v62, v62, v49
    v_perm_b32 v58, v62, v62, v50
    v_perm_b32 v59, v62, v62, v51
    s_waitcnt vmcnt(6)
    s_nop 0
    v_mfma_f32_16x16x32_bf16 v[24:27], v[56:59], v[108:111], v[24:27]
    s_cbranch_vccnz L_is396
    s_waitcnt vmcnt(5)
    s_cbranch_scc0 L_is396
    s_waitcnt vmcnt(4)
L_is396:
    buffer_load_dwordx4 v[108:111], v1, s[24:27], s44 offen offset:1024 nt
    ds_read_b32 v2, v15 offset:31272
    v_perm_b32 v52, v63, v63, v44
    v_perm_b32 v53, v63, v63, v45
    v_perm_b32 v54, v63, v63, v46
    v_perm_b32 v55, v63, v63, v47
    s_waitcnt vmcnt(6)
    s_nop 0
    v_mfma_f32_16x16x32_bf16 v[24:27], v[52:55], v[120:123], v[24:27]
    s_cbranch_vccnz L_is397
    s_waitcnt vmcnt(5)
    s_cbranch_scc0 L_is397
    s_waitcnt vmcnt(4)
L_is397:
    buffer_load_dwordx4 v[120:123], v1, s[24:27], s44 offen offset:1280 nt
    v_perm_b32 v56, v63, v63, v48
    v_perm_b32 v57, v63, v63, v49
    v_perm_b32 v58, v63, v63, v50
    v_perm_b32 v59, v63, v63, v51
    s_waitcnt vmcnt(6)
    s_nop 0
    v_mfma_f32_16x16x32_bf16 v[24:27], v[56:59], v[112:115], v[24:27]
    s_cbranch_vccnz L_is398
    s_waitcnt vmcnt(5)
    s_cbranch_scc0 L_is398
    s_waitcnt vmcnt(4)
L_is398:
    buffer_load_dwordx4 v[112:115], v1, s[24:27], s44 offen offset:1536 nt
    s_waitcnt lgkmcnt(0)
    v_readfirstlane_b32 s55, v2
    s_nop 1
    s_cmp_ge_u32 s55, 0x6300
    s_cselect_b32 s55, s55, 0
    s_bitcmp1_b32 s55, 1
    s_cselect_b64 vcc, -1, 0
    s_bitcmp1_b32 s55, 0
    v_perm_b32 v52, v32, v32, v44
    v_perm_b32 v53, v32, v32, v45
    v_perm_b32 v54, v32, v32, v46
    v_perm_b32 v55, v32, v32, v47
    s_waitcnt vmcnt(6)
    s_nop 0
    v_mfma_f32_16x16x32_bf16 v[24:27], v[52:55], v[116:119], v[24:27]
    s_cbranch_vccnz L_is399
    s_waitcnt vmcnt(5)
    s_cbranch_scc0 L_is399
    s_waitcnt vmcnt(4)
L_is399:
    buffer_load_dwordx4 v[116:119], v1, s[24:27], s44 offen offset:1792 nt
    v_mov_b32 v3, 98
    ds_write_b32 v9, v3 offset:31268
    v_perm_b32 v56, v32, v32, v48
    v_perm_b32 v57, v32, v32, v49
    v_perm_b32 v58, v32, v32, v50
    v_perm_b32 v59, v32, v32, v51
    s_waitcnt vmcnt(6)
    s_nop 0
    v_mfma_f32_16x16x32_bf16 v[24:27], v[56:59], v[96:99], v[24:27]
    s_cbranch_vccnz L_is400
    s_waitcnt vmcnt(5)
    s_cbranch_scc0 L_is400
    s_waitcnt vmcnt(4)
L_is400:
    s_mov_b32 s44, 0x8080000
    buffer_load_dwordx4 v[96:99], v1, s[24:27], s44 offen offset:0 nt
    ds_read_b32 v2, v15 offset:31272
    ds_read_b128 v[60:63], v5 offset:2432
    v_perm_b32 v52, v33, v33, v44
    v_perm_b32 v53, v33, v33, v45
    v_perm_b32 v54, v33, v33, v46
    v_perm_b32 v55, v33, v33, v47
    s_waitcnt vmcnt(6)
    s_nop 0
    v_mfma_f32_16x16x32_bf16 v[24:27], v[52:55], v[100:103], v[24:27]
    s_cbranch_vccnz L_is401
    s_waitcnt vmcnt(5)
    s_cbranch_scc0 L_is401
    s_waitcnt vmcnt(4)
L_is401:
    buffer_load_dwordx4 v[100:103], v1, s[24:27], s44 offen offset:256 nt
    v_perm_b32 v56, v33, v33, v48
    v_perm_b32 v57, v33, v33, v49
    v_perm_b32 v58, v33, v33, v50
    v_perm_b32 v59, v33, v33, v51
    s_waitcnt vmcnt(6)
    s_nop 0
    v_mfma_f32_16x16x32_bf16 v[24:27], v[56:59], v[104:107], v[24:27]
    s_cbranch_vccnz L_is402
    s_waitcnt vmcnt(5)
    s_cbranch_scc0 L_is402
    s_waitcnt vmcnt(4)
L_is402:
    buffer_load_dwordx4 v[104:107], v1, s[24:27], s44 offen offset:512 nt
    s_waitcnt lgkmcnt(1)
    v_readfirstlane_b32 s55, v2
    s_nop 1
    s_cmp_ge_u32 s55, 0x6400
    s_cselect_b32 s55, s55, 0
    s_bitcmp1_b32 s55, 1
    s_cselect_b64 vcc, -1, 0
    s_bitcmp1_b32 s55, 0
    v_perm_b32 v52, v34, v34, v44
    v_perm_b32 v53, v34, v34, v45
    v_perm_b32 v54, v34, v34, v46
    v_perm_b32 v55, v34, v34, v47
    s_waitcnt vmcnt(6)
    s_nop 0
    v_mfma_f32_16x16x32_bf16 v[24:27], v[52:55], v[108:111], v[24:27]
    s_cbranch_vccnz L_is403
    s_waitcnt vmcnt(5)
    s_cbranch_scc0 L_is403
    s_waitcnt vmcnt(4)
L_is403:
    buffer_load_dwordx4 v[108:111], v1, s[24:27], s44 offen offset:768 nt
    v_mov_b32 v3, 99
    ds_write_b32 v9, v3 offset:31268
    v_perm_b32 v56, v34, v34, v48
    v_perm_b32 v57, v34, v34, v49
    v_perm_b32 v58, v34, v34, v50
    v_perm_b32 v59, v34, v34, v51
    s_waitcnt vmcnt(6)
    s_nop 0
    v_mfma_f32_16x16x32_bf16 v[24:27], v[56:59], v[120:123], v[24:27]
    s_cbranch_vccnz L_is404
    s_waitcnt vmcnt(5)
    s_cbranch_scc0 L_is404
    s_waitcnt vmcnt(4)
L_is404:
    buffer_load_dwordx4 v[120:123], v1, s[24:27], s44 offen offset:1024 nt
    ds_read_b32 v2, v15 offset:31272
    v_perm_b32 v52, v35, v35, v44
    v_perm_b32 v53, v35, v35, v45
    v_perm_b32 v54, v35, v35, v46
    v_perm_b32 v55, v35, v35, v47
    s_waitcnt vmcnt(6)
    s_nop 0
    v_mfma_f32_16x16x32_bf16 v[24:27], v[52:55], v[112:115], v[24:27]
    s_cbranch_vccnz L_is405
    s_waitcnt vmcnt(5)
    s_cbranch_scc0 L_is405
    s_waitcnt vmcnt(4)
L_is405:
    buffer_load_dwordx4 v[112:115], v1, s[24:27], s44 offen offset:1280 nt
    v_perm_b32 v56, v35, v35, v48
    v_perm_b32 v57, v35, v35, v49
    v_perm_b32 v58, v35, v35, v50
    v_perm_b32 v59, v35, v35, v51
    s_waitcnt vmcnt(6)
    s_nop 0
    v_mfma_f32_16x16x32_bf16 v[24:27], v[56:59], v[116:119], v[24:27]
    s_cbranch_vccnz L_is406
    s_waitcnt vmcnt(5)
    s_cbranch_scc0 L_is406
    s_waitcnt vmcnt(4)
L_is406:
    buffer_load_dwordx4 v[116:119], v1, s[24:27], s44 offen offset:1536 nt
    s_waitcnt lgkmcnt(0)
    v_readfirstlane_b32 s55, v2
    s_nop 1
    s_cmp_ge_u32 s55, 0x6500
    s_cselect_b32 s55, s55, 0
    s_bitcmp1_b32 s55, 1
    s_cselect_b64 vcc, -1, 0
    s_bitcmp1_b32 s55, 0
    v_perm_b32 v52, v60, v60, v44
    v_perm_b32 v53, v60, v60, v45
    v_perm_b32 v54, v60, v60, v46
    v_perm_b32 v55, v60, v60, v47
    s_waitcnt vmcnt(6)
    s_nop 0
    v_mfma_f32_16x16x32_bf16 v[24:27], v[52:55], v[96:99], v[24:27]
    s_cbranch_vccnz L_is407
    s_waitcnt vmcnt(5)
    s_cbranch_scc0 L_is407
    s_waitcnt vmcnt(4)
L_is407:
    buffer_load_dwordx4 v[96:99], v1, s[24:27], s44 offen offset:1792 nt
    v_mov_b32 v3, 100
    ds_write_b32 v9, v3 offset:31268
    v_perm_b32 v56, v60, v60, v48
    v_perm_b32 v57, v60, v60, v49
    v_perm_b32 v58, v60, v60, v50
    v_perm_b32 v59, v60, v60, v51
    s_waitcnt vmcnt(6)
    s_nop 0
    v_mfma_f32_16x16x32_bf16 v[24:27], v[56:59], v[100:103], v[24:27]
    s_cbranch_vccnz L_is408
    s_waitcnt vmcnt(5)
    s_cbranch_scc0 L_is408
    s_waitcnt vmcnt(4)
L_is408:
    s_mov_b32 s44, 0x80a0000
    buffer_load_dwordx4 v[100:103], v1, s[24:27], s44 offen offset:0 nt
    ds_read_b32 v2, v15 offset:31272
    ds_read_b128 v[32:35], v5 offset:2496
    v_perm_b32 v52, v61, v61, v44
    v_perm_b32 v53, v61, v61, v45
    v_perm_b32 v54, v61, v61, v46
    v_perm_b32 v55, v61, v61, v47
    s_waitcnt vmcnt(6)
    s_nop 0
    v_mfma_f32_16x16x32_bf16 v[24:27], v[52:55], v[104:107], v[24:27]
    s_cbranch_vccnz L_is409
    s_waitcnt vmcnt(5)
    s_cbranch_scc0 L_is409
    s_waitcnt vmcnt(4)
L_is409:
    buffer_load_dwordx4 v[104:107], v1, s[24:27], s44 offen offset:256 nt
    v_perm_b32 v56, v61, v61, v48
    v_perm_b32 v57, v61, v61, v49
    v_perm_b32 v58, v61, v61, v50
    v_perm_b32 v59, v61, v61, v51
    s_waitcnt vmcnt(6)
    s_nop 0
    v_mfma_f32_16x16x32_bf16 v[24:27], v[56:59], v[108:111], v[24:27]
    s_cbranch_vccnz L_is410
    s_waitcnt vmcnt(5)
    s_cbranch_scc0 L_is410
    s_waitcnt vmcnt(4)
L_is410:
    buffer_load_dwordx4 v[108:111], v1, s[24:27], s44 offen offset:512 nt
    s_waitcnt lgkmcnt(1)
    v_readfirstlane_b32 s55, v2
    s_nop 1
    s_cmp_ge_u32 s55, 0x6600
    s_cselect_b32 s55, s55, 0
    s_bitcmp1_b32 s55, 1
    s_cselect_b64 vcc, -1, 0
    s_bitcmp1_b32 s55, 0
    v_perm_b32 v52, v62, v62, v44
    v_perm_b32 v53, v62, v62, v45
    v_perm_b32 v54, v62, v62, v46
    v_perm_b32 v55, v62, v62, v47
    s_waitcnt vmcnt(6)
    s_nop 0
    v_mfma_f32_16x16x32_bf16 v[24:27], v[52:55], v[120:123], v[24:27]
    s_cbranch_vccnz L_is411
    s_waitcnt vmcnt(5)
    s_cbranch_scc0 L_is411
    s_waitcnt vmcnt(4)
L_is411:
    buffer_load_dwordx4 v[120:123], v1, s[24:27], s44 offen offset:768 nt
    v_mov_b32 v3, 101
    ds_write_b32 v9, v3 offset:31268
    v_perm_b32 v56, v62, v62, v48
    v_perm_b32 v57, v62, v62, v49
    v_perm_b32 v58, v62, v62, v50
    v_perm_b32 v59, v62, v62, v51
    s_waitcnt vmcnt(6)
    s_nop 0
    v_mfma_f32_16x16x32_bf16 v[24:27], v[56:59], v[112:115], v[24:27]
    s_cbranch_vccnz L_is412
    s_waitcnt vmcnt(5)
    s_cbranch_scc0 L_is412
    s_waitcnt vmcnt(4)
L_is412:
    buffer_load_dwordx4 v[112:115], v1, s[24:27], s44 offen offset:1024 nt
    ds_read_b32 v2, v15 offset:31272
    v_perm_b32 v52, v63, v63, v44
    v_perm_b32 v53, v63, v63, v45
    v_perm_b32 v54, v63, v63, v46
    v_perm_b32 v55, v63, v63, v47
    s_waitcnt vmcnt(6)
    s_nop 0
    v_mfma_f32_16x16x32_bf16 v[24:27], v[52:55], v[116:119], v[24:27]
    s_cbranch_vccnz L_is413
    s_waitcnt vmcnt(5)
    s_cbranch_scc0 L_is413
    s_waitcnt vmcnt(4)
L_is413:
    buffer_load_dwordx4 v[116:119], v1, s[24:27], s44 offen offset:1280 nt
    v_perm_b32 v56, v63, v63, v48
    v_perm_b32 v57, v63, v63, v49
    v_perm_b32 v58, v63, v63, v50
    v_perm_b32 v59, v63, v63, v51
    s_waitcnt vmcnt(6)
    s_nop 0
    v_mfma_f32_16x16x32_bf16 v[24:27], v[56:59], v[96:99], v[24:27]
    s_cbranch_vccnz L_is414
    s_waitcnt vmcnt(5)
    s_cbranch_scc0 L_is414
    s_waitcnt vmcnt(4)
L_is414:
    buffer_load_dwordx4 v[96:99], v1, s[24:27], s44 offen offset:1536 nt
    s_waitcnt lgkmcnt(0)
    v_readfirstlane_b32 s55, v2
    s_nop 1
    s_cmp_ge_u32 s55, 0x6700
    s_cselect_b32 s55, s55, 0
    s_bitcmp1_b32 s55, 1
    s_cselect_b64 vcc, -1, 0
    s_bitcmp1_b32 s55, 0
    v_perm_b32 v52, v32, v32, v44
    v_perm_b32 v53, v32, v32, v45
    v_perm_b32 v54, v32, v32, v46
    v_perm_b32 v55, v32, v32, v47
    s_waitcnt vmcnt(6)
    s_nop 0
    v_mfma_f32_16x16x32_bf16 v[24:27], v[52:55], v[100:103], v[24:27]
    s_cbranch_vccnz L_is415
    s_waitcnt vmcnt(5)
    s_cbranch_scc0 L_is415
    s_waitcnt vmcnt(4)
L_is415:
    buffer_load_dwordx4 v[100:103], v1, s[24:27], s44 offen offset:1792 nt
    v_mov_b32 v3, 102
    ds_write_b32 v9, v3 offset:31268
    v_perm_b32 v56, v32, v32, v48
    v_perm_b32 v57, v32, v32, v49
    v_perm_b32 v58, v32, v32, v50
    v_perm_b32 v59, v32, v32, v51
    s_waitcnt vmcnt(6)
    s_nop 0
    v_mfma_f32_16x16x32_bf16 v[24:27], v[56:59], v[104:107], v[24:27]
    s_cbranch_vccnz L_is416
    s_waitcnt vmcnt(5)
    s_cbranch_scc0 L_is416
    s_waitcnt vmcnt(4)
L_is416:
    s_mov_b32 s44, 0x8100000
    buffer_load_dwordx4 v[104:107], v1, s[24:27], s44 offen offset:0 nt
    ds_read_b32 v2, v15 offset:31272
    ds_read_b128 v[60:63], v5 offset:2560
    v_perm_b32 v52, v33, v33, v44
    v_perm_b32 v53, v33, v33, v45
    v_perm_b32 v54, v33, v33, v46
    v_perm_b32 v55, v33, v33, v47
    s_waitcnt vmcnt(6)
    s_nop 0
    v_mfma_f32_16x16x32_bf16 v[24:27], v[52:55], v[108:111], v[24:27]
    s_cbranch_vccnz L_is417
    s_waitcnt vmcnt(5)
    s_cbranch_scc0 L_is417
    s_waitcnt vmcnt(4)
L_is417:
    buffer_load_dwordx4 v[108:111], v1, s[24:27], s44 offen offset:256 nt
    v_perm_b32 v56, v33, v33, v48
    v_perm_b32 v57, v33, v33, v49
    v_perm_b32 v58, v33, v33, v50
    v_perm_b32 v59, v33, v33, v51
    s_waitcnt vmcnt(6)
    s_nop 0
    v_mfma_f32_16x16x32_bf16 v[24:27], v[56:59], v[120:123], v[24:27]
    s_cbranch_vccnz L_is418
    s_waitcnt vmcnt(5)
    s_cbranch_scc0 L_is418
    s_waitcnt vmcnt(4)
L_is418:
    buffer_load_dwordx4 v[120:123], v1, s[24:27], s44 offen offset:512 nt
    s_waitcnt lgkmcnt(1)
    v_readfirstlane_b32 s55, v2
    s_nop 1
    s_cmp_ge_u32 s55, 0x6800
    s_cselect_b32 s55, s55, 0
    s_bitcmp1_b32 s55, 1
    s_cselect_b64 vcc, -1, 0
    s_bitcmp1_b32 s55, 0
    v_perm_b32 v52, v34, v34, v44
    v_perm_b32 v53, v34, v34, v45
    v_perm_b32 v54, v34, v34, v46
    v_perm_b32 v55, v34, v34, v47
    s_waitcnt vmcnt(6)
    s_nop 0
    v_mfma_f32_16x16x32_bf16 v[24:27], v[52:55], v[112:115], v[24:27]
    s_cbranch_vccnz L_is419
    s_waitcnt vmcnt(5)
    s_cbranch_scc0 L_is419
    s_waitcnt vmcnt(4)
L_is419:
    buffer_load_dwordx4 v[112:115], v1, s[24:27], s44 offen offset:768 nt
    v_mov_b32 v3, 103
    ds_write_b32 v9, v3 offset:31268
    v_perm_b32 v56, v34, v34, v48
    v_perm_b32 v57, v34, v34, v49
    v_perm_b32 v58, v34, v34, v50
    v_perm_b32 v59, v34, v34, v51
    s_waitcnt vmcnt(6)
    s_nop 0
    v_mfma_f32_16x16x32_bf16 v[24:27], v[56:59], v[116:119], v[24:27]
    s_cbranch_vccnz L_is420
    s_waitcnt vmcnt(5)
    s_cbranch_scc0 L_is420
    s_waitcnt vmcnt(4)
L_is420:
    buffer_load_dwordx4 v[116:119], v1, s[24:27], s44 offen offset:1024 nt
    ds_read_b32 v2, v15 offset:31272
    v_perm_b32 v52, v35, v35, v44
    v_perm_b32 v53, v35, v35, v45
    v_perm_b32 v54, v35, v35, v46
    v_perm_b32 v55, v35, v35, v47
    s_waitcnt vmcnt(6)
    s_nop 0
    v_mfma_f32_16x16x32_bf16 v[24:27], v[52:55], v[96:99], v[24:27]
    s_cbranch_vccnz L_is421
    s_waitcnt vmcnt(5)
    s_cbranch_scc0 L_is421
    s_waitcnt vmcnt(4)
L_is421:
    buffer_load_dwordx4 v[96:99], v1, s[24:27], s44 offen offset:1280 nt
    v_perm_b32 v56, v35, v35, v48
    v_perm_b32 v57, v35, v35, v49
    v_perm_b32 v58, v35, v35, v50
    v_perm_b32 v59, v35, v35, v51
    s_waitcnt vmcnt(6)
    s_nop 0
    v_mfma_f32_16x16x32_bf16 v[24:27], v[56:59], v[100:103], v[24:27]
    s_cbranch_vccnz L_is422
    s_waitcnt vmcnt(5)
    s_cbranch_scc0 L_is422
    s_waitcnt vmcnt(4)
L_is422:
    buffer_load_dwordx4 v[100:103], v1, s[24:27], s44 offen offset:1536 nt
    s_waitcnt lgkmcnt(0)
    v_readfirstlane_b32 s55, v2
    s_nop 1
    s_cmp_ge_u32 s55, 0x6900
    s_cselect_b32 s55, s55, 0
    s_bitcmp1_b32 s55, 1
    s_cselect_b64 vcc, -1, 0
    s_bitcmp1_b32 s55, 0
    v_perm_b32 v52, v60, v60, v44
    v_perm_b32 v53, v60, v60, v45
    v_perm_b32 v54, v60, v60, v46
    v_perm_b32 v55, v60, v60, v47
    s_waitcnt vmcnt(6)
    s_nop 0
    v_mfma_f32_16x16x32_bf16 v[24:27], v[52:55], v[104:107], v[24:27]
    s_cbranch_vccnz L_is423
    s_waitcnt vmcnt(5)
    s_cbranch_scc0 L_is423
    s_waitcnt vmcnt(4)
L_is423:
    buffer_load_dwordx4 v[104:107], v1, s[24:27], s44 offen offset:1792 nt
    v_mov_b32 v3, 104
    ds_write_b32 v9, v3 offset:31268
    v_perm_b32 v56, v60, v60, v48
    v_perm_b32 v57, v60, v60, v49
    v_perm_b32 v58, v60, v60, v50
    v_perm_b32 v59, v60, v60, v51
    s_waitcnt vmcnt(6)
    s_nop 0
    v_mfma_f32_16x16x32_bf16 v[24:27], v[56:59], v[108:111], v[24:27]
    s_cbranch_vccnz L_is424
    s_waitcnt vmcnt(5)
    s_cbranch_scc0 L_is424
    s_waitcnt vmcnt(4)
L_is424:
    s_mov_b32 s44, 0x8120000
    buffer_load_dwordx4 v[108:111], v1, s[24:27], s44 offen offset:0 nt
    ds_read_b32 v2, v15 offset:31272
    ds_read_b128 v[32:35], v5 offset:2624
    v_perm_b32 v52, v61, v61, v44
    v_perm_b32 v53, v61, v61, v45
    v_perm_b32 v54, v61, v61, v46
    v_perm_b32 v55, v61, v61, v47
    s_waitcnt vmcnt(6)
    s_nop 0
    v_mfma_f32_16x16x32_bf16 v[24:27], v[52:55], v[120:123], v[24:27]
    s_cbranch_vccnz L_is425
    s_waitcnt vmcnt(5)
    s_cbranch_scc0 L_is425
    s_waitcnt vmcnt(4)
L_is425:
    buffer_load_dwordx4 v[120:123], v1, s[24:27], s44 offen offset:256 nt
    v_perm_b32 v56, v61, v61, v48
    v_perm_b32 v57, v61, v61, v49
    v_perm_b32 v58, v61, v61, v50
    v_perm_b32 v59, v61, v61, v51
    s_waitcnt vmcnt(6)
    s_nop 0
    v_mfma_f32_16x16x32_bf16 v[24:27], v[56:59], v[112:115], v[24:27]
    s_cbranch_vccnz L_is426
    s_waitcnt vmcnt(5)
    s_cbranch_scc0 L_is426
    s_waitcnt vmcnt(4)
L_is426:
    buffer_load_dwordx4 v[112:115], v1, s[24:27], s44 offen offset:512 nt
    s_waitcnt lgkmcnt(1)
    v_readfirstlane_b32 s55, v2
    s_nop 1
    s_cmp_ge_u32 s55, 0x6a00
    s_cselect_b32 s55, s55, 0
    s_bitcmp1_b32 s55, 1
    s_cselect_b64 vcc, -1, 0
    s_bitcmp1_b32 s55, 0
    v_perm_b32 v52, v62, v62, v44
    v_perm_b32 v53, v62, v62, v45
    v_perm_b32 v54, v62, v62, v46
    v_perm_b32 v55, v62, v62, v47
    s_waitcnt vmcnt(6)
    s_nop 0
    v_mfma_f32_16x16x32_bf16 v[24:27], v[52:55], v[116:119], v[24:27]
    s_cbranch_vccnz L_is427
    s_waitcnt vmcnt(5)
    s_cbranch_scc0 L_is427
    s_waitcnt vmcnt(4)
L_is427:
    buffer_load_dwordx4 v[116:119], v1, s[24:27], s44 offen offset:768 nt
    v_mov_b32 v3, 105
    ds_write_b32 v9, v3 offset:31268
    v_perm_b32 v56, v62, v62, v48
    v_perm_b32 v57, v62, v62, v49
    v_perm_b32 v58, v62, v62, v50
    v_perm_b32 v59, v62, v62, v51
    s_waitcnt vmcnt(6)
    s_nop 0
    v_mfma_f32_16x16x32_bf16 v[24:27], v[56:59], v[96:99], v[24:27]
    s_cbranch_vccnz L_is428
    s_waitcnt vmcnt(5)
    s_cbranch_scc0 L_is428
    s_waitcnt vmcnt(4)
L_is428:
    buffer_load_dwordx4 v[96:99], v1, s[24:27], s44 offen offset:1024 nt
    ds_read_b32 v2, v15 offset:31272
    v_perm_b32 v52, v63, v63, v44
    v_perm_b32 v53, v63, v63, v45
    v_perm_b32 v54, v63, v63, v46
    v_perm_b32 v55, v63, v63, v47
    s_waitcnt vmcnt(6)
    s_nop 0
    v_mfma_f32_16x16x32_bf16 v[24:27], v[52:55], v[100:103], v[24:27]
    s_cbranch_vccnz L_is429
    s_waitcnt vmcnt(5)
    s_cbranch_scc0 L_is429
    s_waitcnt vmcnt(4)
L_is429:
    buffer_load_dwordx4 v[100:103], v1, s[24:27], s44 offen offset:1280 nt
    v_perm_b32 v56, v63, v63, v48
    v_perm_b32 v57, v63, v63, v49
    v_perm_b32 v58, v63, v63, v50
    v_perm_b32 v59, v63, v63, v51
    s_waitcnt vmcnt(6)
    s_nop 0
    v_mfma_f32_16x16x32_bf16 v[24:27], v[56:59], v[104:107], v[24:27]
    s_cbranch_vccnz L_is430
    s_waitcnt vmcnt(5)
    s_cbranch_scc0 L_is430
    s_waitcnt vmcnt(4)
L_is430:
    buffer_load_dwordx4 v[104:107], v1, s[24:27], s44 offen offset:1536 nt
    s_waitcnt lgkmcnt(0)
    v_readfirstlane_b32 s55, v2
    s_nop 1
    s_cmp_ge_u32 s55, 0x6b00
    s_cselect_b32 s55, s55, 0
    s_bitcmp1_b32 s55, 1
    s_cselect_b64 vcc, -1, 0
    s_bitcmp1_b32 s55, 0
    v_perm_b32 v52, v32, v32, v44
    v_perm_b32 v53, v32, v32, v45
    v_perm_b32 v54, v32, v32, v46
    v_perm_b32 v55, v32, v32, v47
    s_waitcnt vmcnt(6)
    s_nop 0
    v_mfma_f32_16x16x32_bf16 v[24:27], v[52:55], v[108:111], v[24:27]
    s_cbranch_vccnz L_is431
    s_waitcnt vmcnt(5)
    s_cbranch_scc0 L_is431
    s_waitcnt vmcnt(4)
L_is431:
    buffer_load_dwordx4 v[108:111], v1, s[24:27], s44 offen offset:1792 nt
    v_mov_b32 v3, 106
    ds_write_b32 v9, v3 offset:31268
    v_perm_b32 v56, v32, v32, v48
    v_perm_b32 v57, v32, v32, v49
    v_perm_b32 v58, v32, v32, v50
    v_perm_b32 v59, v32, v32, v51
    s_waitcnt vmcnt(6)
    s_nop 0
    v_mfma_f32_16x16x32_bf16 v[24:27], v[56:59], v[120:123], v[24:27]
    s_cbranch_vccnz L_is432
    s_waitcnt vmcnt(5)
    s_cbranch_scc0 L_is432
    s_waitcnt vmcnt(4)
L_is432:
    s_mov_b32 s44, 0x8180000
    buffer_load_dwordx4 v[120:123], v1, s[24:27], s44 offen offset:0 nt
    ds_read_b32 v2, v15 offset:31272
    ds_read_b128 v[60:63], v5 offset:2688
    v_perm_b32 v52, v33, v33, v44
    v_perm_b32 v53, v33, v33, v45
    v_perm_b32 v54, v33, v33, v46
    v_perm_b32 v55, v33, v33, v47
    s_waitcnt vmcnt(6)
    s_nop 0
    v_mfma_f32_16x16x32_bf16 v[24:27], v[52:55], v[112:115], v[24:27]
    s_cbranch_vccnz L_is433
    s_waitcnt vmcnt(5)
    s_cbranch_scc0 L_is433
    s_waitcnt vmcnt(4)
L_is433:
    buffer_load_dwordx4 v[112:115], v1, s[24:27], s44 offen offset:256 nt
    v_perm_b32 v56, v33, v33, v48
    v_perm_b32 v57, v33, v33, v49
    v_perm_b32 v58, v33, v33, v50
    v_perm_b32 v59, v33, v33, v51
    s_waitcnt vmcnt(6)
    s_nop 0
    v_mfma_f32_16x16x32_bf16 v[24:27], v[56:59], v[116:119], v[24:27]
    s_cbranch_vccnz L_is434
    s_waitcnt vmcnt(5)
    s_cbranch_scc0 L_is434
    s_waitcnt vmcnt(4)
L_is434:
    buffer_load_dwordx4 v[116:119], v1, s[24:27], s44 offen offset:512 nt
    s_waitcnt lgkmcnt(1)
    v_readfirstlane_b32 s55, v2
    s_nop 1
    s_cmp_ge_u32 s55, 0x6c00
    s_cselect_b32 s55, s55, 0
    s_bitcmp1_b32 s55, 1
    s_cselect_b64 vcc, -1, 0
    s_bitcmp1_b32 s55, 0
    v_perm_b32 v52, v34, v34, v44
    v_perm_b32 v53, v34, v34, v45
    v_perm_b32 v54, v34, v34, v46
    v_perm_b32 v55, v34, v34, v47
    s_waitcnt vmcnt(6)
    s_nop 0
    v_mfma_f32_16x16x32_bf16 v[24:27], v[52:55], v[96:99], v[24:27]
    s_cbranch_vccnz L_is435
    s_waitcnt vmcnt(5)
    s_cbranch_scc0 L_is435
    s_waitcnt vmcnt(4)
L_is435:
    buffer_load_dwordx4 v[96:99], v1, s[24:27], s44 offen offset:768 nt
    v_mov_b32 v3, 107
    ds_write_b32 v9, v3 offset:31268
    v_perm_b32 v56, v34, v34, v48
    v_perm_b32 v57, v34, v34, v49
    v_perm_b32 v58, v34, v34, v50
    v_perm_b32 v59, v34, v34, v51
    s_waitcnt vmcnt(6)
    s_nop 0
    v_mfma_f32_16x16x32_bf16 v[24:27], v[56:59], v[100:103], v[24:27]
    s_cbranch_vccnz L_is436
    s_waitcnt vmcnt(5)
    s_cbranch_scc0 L_is436
    s_waitcnt vmcnt(4)
L_is436:
    buffer_load_dwordx4 v[100:103], v1, s[24:27], s44 offen offset:1024 nt
    ds_read_b32 v2, v15 offset:31272
    v_perm_b32 v52, v35, v35, v44
    v_perm_b32 v53, v35, v35, v45
    v_perm_b32 v54, v35, v35, v46
    v_perm_b32 v55, v35, v35, v47
    s_waitcnt vmcnt(6)
    s_nop 0
    v_mfma_f32_16x16x32_bf16 v[24:27], v[52:55], v[104:107], v[24:27]
    s_cbranch_vccnz L_is437
    s_waitcnt vmcnt(5)
    s_cbranch_scc0 L_is437
    s_waitcnt vmcnt(4)
L_is437:
    buffer_load_dwordx4 v[104:107], v1, s[24:27], s44 offen offset:1280 nt
    v_perm_b32 v56, v35, v35, v48
    v_perm_b32 v57, v35, v35, v49
    v_perm_b32 v58, v35, v35, v50
    v_perm_b32 v59, v35, v35, v51
    s_waitcnt vmcnt(6)
    s_nop 0
    v_mfma_f32_16x16x32_bf16 v[24:27], v[56:59], v[108:111], v[24:27]
    s_cbranch_vccnz L_is438
    s_waitcnt vmcnt(5)
    s_cbranch_scc0 L_is438
    s_waitcnt vmcnt(4)
L_is438:
    buffer_load_dwordx4 v[108:111], v1, s[24:27], s44 offen offset:1536 nt
    s_waitcnt lgkmcnt(0)
    v_readfirstlane_b32 s55, v2
    s_nop 1
    s_cmp_ge_u32 s55, 0x6d00
    s_cselect_b32 s55, s55, 0
    s_bitcmp1_b32 s55, 1
    s_cselect_b64 vcc, -1, 0
    s_bitcmp1_b32 s55, 0
    v_perm_b32 v52, v60, v60, v44
    v_perm_b32 v53, v60, v60, v45
    v_perm_b32 v54, v60, v60, v46
    v_perm_b32 v55, v60, v60, v47
    s_waitcnt vmcnt(6)
    s_nop 0
    v_mfma_f32_16x16x32_bf16 v[24:27], v[52:55], v[120:123], v[24:27]
    s_cbranch_vccnz L_is439
    s_waitcnt vmcnt(5)
    s_cbranch_scc0 L_is439
    s_waitcnt vmcnt(4)
L_is439:
    buffer_load_dwordx4 v[120:123], v1, s[24:27], s44 offen offset:1792 nt
    v_mov_b32 v3, 108
    ds_write_b32 v9, v3 offset:31268
    v_perm_b32 v56, v60, v60, v48
    v_perm_b32 v57, v60, v60, v49
    v_perm_b32 v58, v60, v60, v50
    v_perm_b32 v59, v60, v60, v51
    s_waitcnt vmcnt(6)
    s_nop 0
    v_mfma_f32_16x16x32_bf16 v[24:27], v[56:59], v[112:115], v[24:27]
    s_cbranch_vccnz L_is440
    s_waitcnt vmcnt(5)
    s_cbranch_scc0 L_is440
    s_waitcnt vmcnt(4)
L_is440:
    s_mov_b32 s44, 0x81a0000
    buffer_load_dwordx4 v[112:115], v1, s[24:27], s44 offen offset:0 nt
    ds_read_b32 v2, v15 offset:31272
    ds_read_b128 v[32:35], v5 offset:2752
    v_perm_b32 v52, v61, v61, v44
    v_perm_b32 v53, v61, v61, v45
    v_perm_b32 v54, v61, v61, v46
    v_perm_b32 v55, v61, v61, v47
    s_waitcnt vmcnt(6)
    s_nop 0
    v_mfma_f32_16x16x32_bf16 v[24:27], v[52:55], v[116:119], v[24:27]
    s_cbranch_vccnz L_is441
    s_waitcnt vmcnt(5)
    s_cbranch_scc0 L_is441
    s_waitcnt vmcnt(4)
L_is441:
    buffer_load_dwordx4 v[116:119], v1, s[24:27], s44 offen offset:256 nt
    v_perm_b32 v56, v61, v61, v48
    v_perm_b32 v57, v61, v61, v49
    v_perm_b32 v58, v61, v61, v50
    v_perm_b32 v59, v61, v61, v51
    s_waitcnt vmcnt(6)
    s_nop 0
    v_mfma_f32_16x16x32_bf16 v[24:27], v[56:59], v[96:99], v[24:27]
    s_cbranch_vccnz L_is442
    s_waitcnt vmcnt(5)
    s_cbranch_scc0 L_is442
    s_waitcnt vmcnt(4)
L_is442:
    buffer_load_dwordx4 v[96:99], v1, s[24:27], s44 offen offset:512 nt
    s_waitcnt lgkmcnt(1)
    v_readfirstlane_b32 s55, v2
    s_nop 1
    s_cmp_ge_u32 s55, 0x6e00
    s_cselect_b32 s55, s55, 0
    s_bitcmp1_b32 s55, 1
    s_cselect_b64 vcc, -1, 0
    s_bitcmp1_b32 s55, 0
    v_perm_b32 v52, v62, v62, v44
    v_perm_b32 v53, v62, v62, v45
    v_perm_b32 v54, v62, v62, v46
    v_perm_b32 v55, v62, v62, v47
    s_waitcnt vmcnt(6)
    s_nop 0
    v_mfma_f32_16x16x32_bf16 v[24:27], v[52:55], v[100:103], v[24:27]
    s_cbranch_vccnz L_is443
    s_waitcnt vmcnt(5)
    s_cbranch_scc0 L_is443
    s_waitcnt vmcnt(4)
L_is443:
    buffer_load_dwordx4 v[100:103], v1, s[24:27], s44 offen offset:768 nt
    v_mov_b32 v3, 109
    ds_write_b32 v9, v3 offset:31268
    v_perm_b32 v56, v62, v62, v48
    v_perm_b32 v57, v62, v62, v49
    v_perm_b32 v58, v62, v62, v50
    v_perm_b32 v59, v62, v62, v51
    s_waitcnt vmcnt(6)
    s_nop 0
    v_mfma_f32_16x16x32_bf16 v[24:27], v[56:59], v[104:107], v[24:27]
    s_cbranch_vccnz L_is444
    s_waitcnt vmcnt(5)
    s_cbranch_scc0 L_is444
    s_waitcnt vmcnt(4)
L_is444:
    buffer_load_dwordx4 v[104:107], v1, s[24:27], s44 offen offset:1024 nt
    ds_read_b32 v2, v15 offset:31272
    v_perm_b32 v52, v63, v63, v44
    v_perm_b32 v53, v63, v63, v45
    v_perm_b32 v54, v63, v63, v46
    v_perm_b32 v55, v63, v63, v47
    s_waitcnt vmcnt(6)
    s_nop 0
    v_mfma_f32_16x16x32_bf16 v[24:27], v[52:55], v[108:111], v[24:27]
    s_cbranch_vccnz L_is445
    s_waitcnt vmcnt(5)
    s_cbranch_scc0 L_is445
    s_waitcnt vmcnt(4)
L_is445:
    buffer_load_dwordx4 v[108:111], v1, s[24:27], s44 offen offset:1280 nt
    v_perm_b32 v56, v63, v63, v48
    v_perm_b32 v57, v63, v63, v49
    v_perm_b32 v58, v63, v63, v50
    v_perm_b32 v59, v63, v63, v51
    s_waitcnt vmcnt(6)
    s_nop 0
    v_mfma_f32_16x16x32_bf16 v[24:27], v[56:59], v[120:123], v[24:27]
    s_cbranch_vccnz L_is446
    s_waitcnt vmcnt(5)
    s_cbranch_scc0 L_is446
    s_waitcnt vmcnt(4)
L_is446:
    buffer_load_dwordx4 v[120:123], v1, s[24:27], s44 offen offset:1536 nt
    s_waitcnt lgkmcnt(0)
    v_readfirstlane_b32 s55, v2
    s_nop 1
    s_cmp_ge_u32 s55, 0x6f00
    s_cselect_b32 s55, s55, 0
    s_bitcmp1_b32 s55, 1
    s_cselect_b64 vcc, -1, 0
    s_bitcmp1_b32 s55, 0
    v_perm_b32 v52, v32, v32, v44
    v_perm_b32 v53, v32, v32, v45
    v_perm_b32 v54, v32, v32, v46
    v_perm_b32 v55, v32, v32, v47
    s_waitcnt vmcnt(6)
    s_nop 0
    v_mfma_f32_16x16x32_bf16 v[24:27], v[52:55], v[112:115], v[24:27]
    s_cbranch_vccnz L_is447
    s_waitcnt vmcnt(5)
    s_cbranch_scc0 L_is447
    s_waitcnt vmcnt(4)
L_is447:
    buffer_load_dwordx4 v[112:115], v1, s[24:27], s44 offen offset:1792 nt
    v_mov_b32 v3, 110
    ds_write_b32 v9, v3 offset:31268
    v_perm_b32 v56, v32, v32, v48
    v_perm_b32 v57, v32, v32, v49
    v_perm_b32 v58, v32, v32, v50
    v_perm_b32 v59, v32, v32, v51
    s_waitcnt vmcnt(6)
    s_nop 0
    v_mfma_f32_16x16x32_bf16 v[24:27], v[56:59], v[116:119], v[24:27]
    s_cbranch_vccnz L_is448
    s_waitcnt vmcnt(5)
    s_cbranch_scc0 L_is448
    s_waitcnt vmcnt(4)
L_is448:
    s_mov_b32 s44, 0xa000000
    buffer_load_dwordx4 v[116:119], v1, s[24:27], s44 offen offset:0 nt
    ds_read_b32 v2, v15 offset:31272
    ds_read_b128 v[60:63], v5 offset:3456
    v_perm_b32 v52, v33, v33, v44
    v_perm_b32 v53, v33, v33, v45
    v_perm_b32 v54, v33, v33, v46
    v_perm_b32 v55, v33, v33, v47
    s_waitcnt vmcnt(6)
    s_nop 0
    v_mfma_f32_16x16x32_bf16 v[24:27], v[52:55], v[96:99], v[24:27]
    s_cbranch_vccnz L_is449
    s_waitcnt vmcnt(5)
    s_cbranch_scc0 L_is449
    s_waitcnt vmcnt(4)
L_is449:
    buffer_load_dwordx4 v[96:99], v1, s[24:27], s44 offen offset:256 nt
    v_perm_b32 v56, v33, v33, v48
    v_perm_b32 v57, v33, v33, v49
    v_perm_b32 v58, v33, v33, v50
    v_perm_b32 v59, v33, v33, v51
    s_waitcnt vmcnt(6)
    s_nop 0
    v_mfma_f32_16x16x32_bf16 v[24:27], v[56:59], v[100:103], v[24:27]
    s_cbranch_vccnz L_is450
    s_waitcnt vmcnt(5)
    s_cbranch_scc0 L_is450
    s_waitcnt vmcnt(4)
L_is450:
    buffer_load_dwordx4 v[100:103], v1, s[24:27], s44 offen offset:512 nt
    s_waitcnt lgkmcnt(1)
    v_readfirstlane_b32 s55, v2
    s_nop 1
    s_cmp_ge_u32 s55, 0x7000
    s_cselect_b32 s55, s55, 0
    s_bitcmp1_b32 s55, 1
    s_cselect_b64 vcc, -1, 0
    s_bitcmp1_b32 s55, 0
    v_perm_b32 v52, v34, v34, v44
    v_perm_b32 v53, v34, v34, v45
    v_perm_b32 v54, v34, v34, v46
    v_perm_b32 v55, v34, v34, v47
    s_waitcnt vmcnt(6)
    s_nop 0
    v_mfma_f32_16x16x32_bf16 v[24:27], v[52:55], v[104:107], v[24:27]
    s_cbranch_vccnz L_is451
    s_waitcnt vmcnt(5)
    s_cbranch_scc0 L_is451
    s_waitcnt vmcnt(4)
L_is451:
    buffer_load_dwordx4 v[104:107], v1, s[24:27], s44 offen offset:768 nt
    v_mov_b32 v3, 111
    ds_write_b32 v9, v3 offset:31268
    v_perm_b32 v56, v34, v34, v48
    v_perm_b32 v57, v34, v34, v49
    v_perm_b32 v58, v34, v34, v50
    v_perm_b32 v59, v34, v34, v51
    s_waitcnt vmcnt(6)
    s_nop 0
    v_mfma_f32_16x16x32_bf16 v[24:27], v[56:59], v[108:111], v[24:27]
    s_cbranch_vccnz L_is452
    s_waitcnt vmcnt(5)
    s_cbranch_scc0 L_is452
    s_waitcnt vmcnt(4)
L_is452:
    buffer_load_dwordx4 v[108:111], v1, s[24:27], s44 offen offset:1024 nt
    ds_read_b32 v2, v15 offset:31272
    v_perm_b32 v52, v35, v35, v44
    v_perm_b32 v53, v35, v35, v45
    v_perm_b32 v54, v35, v35, v46
    v_perm_b32 v55, v35, v35, v47
    s_waitcnt vmcnt(6)
    s_nop 0
    v_mfma_f32_16x16x32_bf16 v[24:27], v[52:55], v[120:123], v[24:27]
    s_cbranch_vccnz L_is453
    s_waitcnt vmcnt(5)
    s_cbranch_scc0 L_is453
    s_waitcnt vmcnt(4)
L_is453:
    buffer_load_dwordx4 v[120:123], v1, s[24:27], s44 offen offset:1280 nt
    v_perm_b32 v56, v35, v35, v48
    v_perm_b32 v57, v35, v35, v49
    v_perm_b32 v58, v35, v35, v50
    v_perm_b32 v59, v35, v35, v51
    s_waitcnt vmcnt(6)
    s_nop 0
    v_mfma_f32_16x16x32_bf16 v[24:27], v[56:59], v[112:115], v[24:27]
    s_cbranch_vccnz L_is454
    s_waitcnt vmcnt(5)
    s_cbranch_scc0 L_is454
    s_waitcnt vmcnt(4)
L_is454:
    buffer_load_dwordx4 v[112:115], v1, s[24:27], s44 offen offset:1536 nt
    s_waitcnt lgkmcnt(0)
    v_readfirstlane_b32 s55, v2
    s_nop 1
    s_cmp_ge_u32 s55, 0x7100
    s_cselect_b32 s55, s55, 0
    s_bitcmp1_b32 s55, 1
    s_cselect_b64 vcc, -1, 0
    s_bitcmp1_b32 s55, 0
    v_perm_b32 v52, v60, v60, v44
    v_perm_b32 v53, v60, v60, v45
    v_perm_b32 v54, v60, v60, v46
    v_perm_b32 v55, v60, v60, v47
    s_waitcnt vmcnt(6)
    s_nop 0
    v_mfma_f32_16x16x32_bf16 v[28:31], v[52:55], v[116:119], 0
    s_cbranch_vccnz L_is455
    s_waitcnt vmcnt(5)
    s_cbranch_scc0 L_is455
    s_waitcnt vmcnt(4)
L_is455:
    buffer_load_dwordx4 v[116:119], v1, s[24:27], s44 offen offset:1792 nt
    v_mov_b32 v3, 112
    ds_write_b32 v9, v3 offset:31268
    v_perm_b32 v56, v60, v60, v48
    v_perm_b32 v57, v60, v60, v49
    v_perm_b32 v58, v60, v60, v50
    v_perm_b32 v59, v60, v60, v51
    s_waitcnt vmcnt(6)
    s_nop 0
    v_mfma_f32_16x16x32_bf16 v[28:31], v[56:59], v[96:99], v[28:31]
    s_cbranch_vccnz L_is456
    s_waitcnt vmcnt(5)
    s_cbranch_scc0 L_is456
    s_waitcnt vmcnt(4)
L_is456:
    s_mov_b32 s44, 0xa020000
    buffer_load_dwordx4 v[96:99], v1, s[24:27], s44 offen offset:0 nt
    ds_read_b32 v2, v15 offset:31272
    ds_read_b128 v[32:35], v5 offset:3520
    v_perm_b32 v52, v61, v61, v44
    v_perm_b32 v53, v61, v61, v45
    v_perm_b32 v54, v61, v61, v46
    v_perm_b32 v55, v61, v61, v47
    s_waitcnt vmcnt(6)
    s_nop 0
    v_mfma_f32_16x16x32_bf16 v[28:31], v[52:55], v[100:103], v[28:31]
    s_cbranch_vccnz L_is457
    s_waitcnt vmcnt(5)
    s_cbranch_scc0 L_is457
    s_waitcnt vmcnt(4)
L_is457:
    buffer_load_dwordx4 v[100:103], v1, s[24:27], s44 offen offset:256 nt
    v_perm_b32 v56, v61, v61, v48
    v_perm_b32 v57, v61, v61, v49
    v_perm_b32 v58, v61, v61, v50
    v_perm_b32 v59, v61, v61, v51
    v_permlane32_swap_b32 v24, v26
    v_permlane32_swap_b32 v25, v27
    v_add_f32 v24, v24, v26
    v_add_f32 v25, v25, v27
    ds_write_b64 v8, v[24:25] offset:4096
    s_waitcnt vmcnt(6)
    v_mfma_f32_16x16x32_bf16 v[28:31], v[56:59], v[104:107], v[28:31]
    s_cbranch_vccnz L_is458
    s_waitcnt vmcnt(5)
    s_cbranch_scc0 L_is458
    s_waitcnt vmcnt(4)
L_is458:
    buffer_load_dwordx4 v[104:107], v1, s[24:27], s44 offen offset:512 nt
    s_waitcnt lgkmcnt(2)
    v_readfirstlane_b32 s55, v2
    s_nop 1
    s_cmp_ge_u32 s55, 0x7200
    s_cselect_b32 s55, s55, 0
    s_bitcmp1_b32 s55, 1
    s_cselect_b64 vcc, -1, 0
    s_bitcmp1_b32 s55, 0
    v_perm_b32 v52, v62, v62, v44
    v_perm_b32 v53, v62, v62, v45
    v_perm_b32 v54, v62, v62, v46
    v_perm_b32 v55, v62, v62, v47
    s_waitcnt vmcnt(6)
    s_nop 0
    v_mfma_f32_16x16x32_bf16 v[28:31], v[52:55], v[108:111], v[28:31]
    s_cbranch_vccnz L_is459
    s_waitcnt vmcnt(5)
    s_cbranch_scc0 L_is459
    s_waitcnt vmcnt(4)
L_is459:
    buffer_load_dwordx4 v[108:111], v1, s[24:27], s44 offen offset:768 nt
    v_mov_b32 v3, 113
    ds_write_b32 v9, v3 offset:31268
    v_perm_b32 v56, v62, v62, v48
    v_perm_b32 v57, v62, v62, v49
    v_perm_b32 v58, v62, v62, v50
    v_perm_b32 v59, v62, v62, v51
    s_waitcnt vmcnt(6)
    s_nop 0
    v_mfma_f32_16x16x32_bf16 v[28:31], v[56:59], v[120:123], v[28:31]
    s_cbranch_vccnz L_is460
    s_waitcnt vmcnt(5)
    s_cbranch_scc0 L_is460
    s_waitcnt vmcnt(4)
L_is460:
    buffer_load_dwordx4 v[120:123], v1, s[24:27], s44 offen offset:1024 nt
    ds_read_b32 v2, v15 offset:31272
    v_perm_b32 v52, v63, v63, v44
    v_perm_b32 v53, v63, v63, v45
    v_perm_b32 v54, v63, v63, v46
    v_perm_b32 v55, v63, v63, v47
    s_waitcnt vmcnt(6)
    s_nop 0
    v_mfma_f32_16x16x32_bf16 v[28:31], v[52:55], v[112:115], v[28:31]
    s_cbranch_vccnz L_is461
    s_waitcnt vmcnt(5)
    s_cbranch_scc0 L_is461
    s_waitcnt vmcnt(4)
L_is461:
    buffer_load_dwordx4 v[112:115], v1, s[24:27], s44 offen offset:1280 nt
    v_perm_b32 v56, v63, v63, v48
    v_perm_b32 v57, v63, v63, v49
    v_perm_b32 v58, v63, v63, v50
    v_perm_b32 v59, v63, v63, v51
    s_waitcnt vmcnt(6)
    s_nop 0
    v_mfma_f32_16x16x32_bf16 v[28:31], v[56:59], v[116:119], v[28:31]
    s_cbranch_vccnz L_is462
    s_waitcnt vmcnt(5)
    s_cbranch_scc0 L_is462
    s_waitcnt vmcnt(4)
L_is462:
    buffer_load_dwordx4 v[116:119], v1, s[24:27], s44 offen offset:1536 nt
    s_waitcnt lgkmcnt(0)
    v_readfirstlane_b32 s55, v2
    s_nop 1
    s_cmp_ge_u32 s55, 0x7300
    s_cselect_b32 s55, s55, 0
    s_bitcmp1_b32 s55, 1
    s_cselect_b64 vcc, -1, 0
    s_bitcmp1_b32 s55, 0
    v_perm_b32 v52, v32, v32, v44
    v_perm_b32 v53, v32, v32, v45
    v_perm_b32 v54, v32, v32, v46
    v_perm_b32 v55, v32, v32, v47
    s_waitcnt vmcnt(6)
    s_nop 0
    v_mfma_f32_16x16x32_bf16 v[28:31], v[52:55], v[96:99], v[28:31]
    s_cbranch_vccnz L_is463
    s_waitcnt vmcnt(5)
    s_cbranch_scc0 L_is463
    s_waitcnt vmcnt(4)
L_is463:
    buffer_load_dwordx4 v[96:99], v1, s[24:27], s44 offen offset:1792 nt
    v_mov_b32 v3, 114
    ds_write_b32 v9, v3 offset:31268
    v_perm_b32 v56, v32, v32, v48
    v_perm_b32 v57, v32, v32, v49
    v_perm_b32 v58, v32, v32, v50
    v_perm_b32 v59, v32, v32, v51
    s_waitcnt vmcnt(6)
    s_nop 0
    v_mfma_f32_16x16x32_bf16 v[28:31], v[56:59], v[100:103], v[28:31]
    s_cbranch_vccnz L_is464
    s_waitcnt vmcnt(5)
    s_cbranch_scc0 L_is464
    s_waitcnt vmcnt(4)
L_is464:
    s_mov_b32 s44, 0xa080000
    buffer_load_dwordx4 v[100:103], v1, s[24:27], s44 offen offset:0 nt
    ds_read_b32 v2, v15 offset:31272
    ds_read_b128 v[60:63], v5 offset:3584
    v_perm_b32 v52, v33, v33, v44
    v_perm_b32 v53, v33, v33, v45
    v_perm_b32 v54, v33, v33, v46
    v_perm_b32 v55, v33, v33, v47
    s_waitcnt vmcnt(6)
    s_nop 0
    v_mfma_f32_16x16x32_bf16 v[28:31], v[52:55], v[104:107], v[28:31]
    s_cbranch_vccnz L_is465
    s_waitcnt vmcnt(5)
    s_cbranch_scc0 L_is465
    s_waitcnt vmcnt(4)
L_is465:
    buffer_load_dwordx4 v[104:107], v1, s[24:27], s44 offen offset:256 nt
    v_perm_b32 v56, v33, v33, v48
    v_perm_b32 v57, v33, v33, v49
    v_perm_b32 v58, v33, v33, v50
    v_perm_b32 v59, v33, v33, v51
    s_waitcnt vmcnt(6)
    s_nop 0
    v_mfma_f32_16x16x32_bf16 v[28:31], v[56:59], v[108:111], v[28:31]
    s_cbranch_vccnz L_is466
    s_waitcnt vmcnt(5)
    s_cbranch_scc0 L_is466
    s_waitcnt vmcnt(4)
L_is466:
    buffer_load_dwordx4 v[108:111], v1, s[24:27], s44 offen offset:512 nt
    s_waitcnt lgkmcnt(1)
    v_readfirstlane_b32 s55, v2
    s_nop 1
    s_cmp_ge_u32 s55, 0x7400
    s_cselect_b32 s55, s55, 0
    s_bitcmp1_b32 s55, 1
    s_cselect_b64 vcc, -1, 0
    s_bitcmp1_b32 s55, 0
    v_perm_b32 v52, v34, v34, v44
    v_perm_b32 v53, v34, v34, v45
    v_perm_b32 v54, v34, v34, v46
    v_perm_b32 v55, v34, v34, v47
    s_waitcnt vmcnt(6)
    s_nop 0
    v_mfma_f32_16x16x32_bf16 v[28:31], v[52:55], v[120:123], v[28:31]
    s_cbranch_vccnz L_is467
    s_waitcnt vmcnt(5)
    s_cbranch_scc0 L_is467
    s_waitcnt vmcnt(4)
L_is467:
    buffer_load_dwordx4 v[120:123], v1, s[24:27], s44 offen offset:768 nt
    v_mov_b32 v3, 115
    ds_write_b32 v9, v3 offset:31268
    v_perm_b32 v56, v34, v34, v48
    v_perm_b32 v57, v34, v34, v49
    v_perm_b32 v58, v34, v34, v50
    v_perm_b32 v59, v34, v34, v51
    s_waitcnt vmcnt(6)
    s_nop 0
    v_mfma_f32_16x16x32_bf16 v[28:31], v[56:59], v[112:115], v[28:31]
    s_cbranch_vccnz L_is468
    s_waitcnt vmcnt(5)
    s_cbranch_scc0 L_is468
    s_waitcnt vmcnt(4)
L_is468:
    buffer_load_dwordx4 v[112:115], v1, s[24:27], s44 offen offset:1024 nt
    ds_read_b32 v2, v15 offset:31272
    v_perm_b32 v52, v35, v35, v44
    v_perm_b32 v53, v35, v35, v45
    v_perm_b32 v54, v35, v35, v46
    v_perm_b32 v55, v35, v35, v47
    s_waitcnt vmcnt(6)
    s_nop 0
    v_mfma_f32_16x16x32_bf16 v[28:31], v[52:55], v[116:119], v[28:31]
    s_cbranch_vccnz L_is469
    s_waitcnt vmcnt(5)
    s_cbranch_scc0 L_is469
    s_waitcnt vmcnt(4)
L_is469:
    buffer_load_dwordx4 v[116:119], v1, s[24:27], s44 offen offset:1280 nt
    v_perm_b32 v56, v35, v35, v48
    v_perm_b32 v57, v35, v35, v49
    v_perm_b32 v58, v35, v35, v50
    v_perm_b32 v59, v35, v35, v51
    s_waitcnt vmcnt(6)
    s_nop 0
    v_mfma_f32_16x16x32_bf16 v[28:31], v[56:59], v[96:99], v[28:31]
    s_cbranch_vccnz L_is470
    s_waitcnt vmcnt(5)
    s_cbranch_scc0 L_is470
    s_waitcnt vmcnt(4)
L_is470:
    buffer_load_dwordx4 v[96:99], v1, s[24:27], s44 offen offset:1536 nt
    s_waitcnt lgkmcnt(0)
    v_readfirstlane_b32 s55, v2
    s_nop 1
    s_cmp_ge_u32 s55, 0x7500
    s_cselect_b32 s55, s55, 0
    s_bitcmp1_b32 s55, 1
    s_cselect_b64 vcc, -1, 0
    s_bitcmp1_b32 s55, 0
    v_perm_b32 v52, v60, v60, v44
    v_perm_b32 v53, v60, v60, v45
    v_perm_b32 v54, v60, v60, v46
    v_perm_b32 v55, v60, v60, v47
    s_waitcnt vmcnt(6)
    s_nop 0
    v_mfma_f32_16x16x32_bf16 v[28:31], v[52:55], v[100:103], v[28:31]
    s_cbranch_vccnz L_is471
    s_waitcnt vmcnt(5)
    s_cbranch_scc0 L_is471
    s_waitcnt vmcnt(4)
L_is471:
    buffer_load_dwordx4 v[100:103], v1, s[24:27], s44 offen offset:1792 nt
    v_mov_b32 v3, 116
    ds_write_b32 v9, v3 offset:31268
    v_perm_b32 v56, v60, v60, v48
    v_perm_b32 v57, v60, v60, v49
    v_perm_b32 v58, v60, v60, v50
    v_perm_b32 v59, v60, v60, v51
    s_waitcnt vmcnt(6)
    s_nop 0
    v_mfma_f32_16x16x32_bf16 v[28:31], v[56:59], v[104:107], v[28:31]
    s_cbranch_vccnz L_is472
    s_waitcnt vmcnt(5)
    s_cbranch_scc0 L_is472
    s_waitcnt vmcnt(4)
L_is472:
    s_mov_b32 s44, 0xa0a0000
    buffer_load_dwordx4 v[104:107], v1, s[24:27], s44 offen offset:0 nt
    ds_read_b32 v2, v15 offset:31272
    ds_read_b128 v[32:35], v5 offset:3648
    v_perm_b32 v52, v61, v61, v44
    v_perm_b32 v53, v61, v61, v45
    v_perm_b32 v54, v61, v61, v46
    v_perm_b32 v55, v61, v61, v47
    s_waitcnt vmcnt(6)
    s_nop 0
    v_mfma_f32_16x16x32_bf16 v[28:31], v[52:55], v[108:111], v[28:31]
    s_cbranch_vccnz L_is473
    s_waitcnt vmcnt(5)
    s_cbranch_scc0 L_is473
    s_waitcnt vmcnt(4)
L_is473:
    buffer_load_dwordx4 v[108:111], v1, s[24:27], s44 offen offset:256 nt
    v_perm_b32 v56, v61, v61, v48
    v_perm_b32 v57, v61, v61, v49
    v_perm_b32 v58, v61, v61, v50
    v_perm_b32 v59, v61, v61, v51
    s_waitcnt vmcnt(6)
    s_nop 0
    v_mfma_f32_16x16x32_bf16 v[28:31], v[56:59], v[120:123], v[28:31]
    s_cbranch_vccnz L_is474
    s_waitcnt vmcnt(5)
    s_cbranch_scc0 L_is474
    s_waitcnt vmcnt(4)
L_is474:
    buffer_load_dwordx4 v[120:123], v1, s[24:27], s44 offen offset:512 nt
    s_waitcnt lgkmcnt(1)
    v_readfirstlane_b32 s55, v2
    s_nop 1
    s_cmp_ge_u32 s55, 0x7600
    s_cselect_b32 s55, s55, 0
    s_bitcmp1_b32 s55, 1
    s_cselect_b64 vcc, -1, 0
    s_bitcmp1_b32 s55, 0
    v_perm_b32 v52, v62, v62, v44
    v_perm_b32 v53, v62, v62, v45
    v_perm_b32 v54, v62, v62, v46
    v_perm_b32 v55, v62, v62, v47
    s_waitcnt vmcnt(6)
    s_nop 0
    v_mfma_f32_16x16x32_bf16 v[28:31], v[52:55], v[112:115], v[28:31]
    s_cbranch_vccnz L_is475
    s_waitcnt vmcnt(5)
    s_cbranch_scc0 L_is475
    s_waitcnt vmcnt(4)
L_is475:
    buffer_load_dwordx4 v[112:115], v1, s[24:27], s44 offen offset:768 nt
    v_mov_b32 v3, 117
    ds_write_b32 v9, v3 offset:31268
    v_perm_b32 v56, v62, v62, v48
    v_perm_b32 v57, v62, v62, v49
    v_perm_b32 v58, v62, v62, v50
    v_perm_b32 v59, v62, v62, v51
    s_waitcnt vmcnt(6)
    s_nop 0
    v_mfma_f32_16x16x32_bf16 v[28:31], v[56:59], v[116:119], v[28:31]
    s_cbranch_vccnz L_is476
    s_waitcnt vmcnt(5)
    s_cbranch_scc0 L_is476
    s_waitcnt vmcnt(4)
L_is476:
    buffer_load_dwordx4 v[116:119], v1, s[24:27], s44 offen offset:1024 nt
    ds_read_b32 v2, v15 offset:31272
    v_perm_b32 v52, v63, v63, v44
    v_perm_b32 v53, v63, v63, v45
    v_perm_b32 v54, v63, v63, v46
    v_perm_b32 v55, v63, v63, v47
    s_waitcnt vmcnt(6)
    s_nop 0
    v_mfma_f32_16x16x32_bf16 v[28:31], v[52:55], v[96:99], v[28:31]
    s_cbranch_vccnz L_is477
    s_waitcnt vmcnt(5)
    s_cbranch_scc0 L_is477
    s_waitcnt vmcnt(4)
L_is477:
    buffer_load_dwordx4 v[96:99], v1, s[24:27], s44 offen offset:1280 nt
    v_perm_b32 v56, v63, v63, v48
    v_perm_b32 v57, v63, v63, v49
    v_perm_b32 v58, v63, v63, v50
    v_perm_b32 v59, v63, v63, v51
    s_waitcnt vmcnt(6)
    s_nop 0
    v_mfma_f32_16x16x32_bf16 v[28:31], v[56:59], v[100:103], v[28:31]
    s_cbranch_vccnz L_is478
    s_waitcnt vmcnt(5)
    s_cbranch_scc0 L_is478
    s_waitcnt vmcnt(4)
L_is478:
    buffer_load_dwordx4 v[100:103], v1, s[24:27], s44 offen offset:1536 nt
    s_waitcnt lgkmcnt(0)
    v_readfirstlane_b32 s55, v2
    s_nop 1
    s_cmp_ge_u32 s55, 0x7700
    s_cselect_b32 s55, s55, 0
    s_bitcmp1_b32 s55, 1
    s_cselect_b64 vcc, -1, 0
    s_bitcmp1_b32 s55, 0
    v_perm_b32 v52, v32, v32, v44
    v_perm_b32 v53, v32, v32, v45
    v_perm_b32 v54, v32, v32, v46
    v_perm_b32 v55, v32, v32, v47
    s_waitcnt vmcnt(6)
    s_nop 0
    v_mfma_f32_16x16x32_bf16 v[28:31], v[52:55], v[104:107], v[28:31]
    s_cbranch_vccnz L_is479
    s_waitcnt vmcnt(5)
    s_cbranch_scc0 L_is479
    s_waitcnt vmcnt(4)
L_is479:
    buffer_load_dwordx4 v[104:107], v1, s[24:27], s44 offen offset:1792 nt
    v_mov_b32 v3, 118
    ds_write_b32 v9, v3 offset:31268
    v_perm_b32 v56, v32, v32, v48
    v_perm_b32 v57, v32, v32, v49
    v_perm_b32 v58, v32, v32, v50
    v_perm_b32 v59, v32, v32, v51
    s_waitcnt vmcnt(6)
    s_nop 0
    v_mfma_f32_16x16x32_bf16 v[28:31], v[56:59], v[108:111], v[28:31]
    s_cbranch_vccnz L_is480
    s_waitcnt vmcnt(5)
    s_cbranch_scc0 L_is480
    s_waitcnt vmcnt(4)
L_is480:
    s_mov_b32 s44, 0xa100000
    buffer_load_dwordx4 v[108:111], v1, s[24:27], s44 offen offset:0 nt
    ds_read_b32 v2, v15 offset:31272
    ds_read_b128 v[60:63], v5 offset:3712
    v_perm_b32 v52, v33, v33, v44
    v_perm_b32 v53, v33, v33, v45
    v_perm_b32 v54, v33, v33, v46
    v_perm_b32 v55, v33, v33, v47
    s_waitcnt vmcnt(6)
    s_nop 0
    v_mfma_f32_16x16x32_bf16 v[28:31], v[52:55], v[120:123], v[28:31]
    s_cbranch_vccnz L_is481
    s_waitcnt vmcnt(5)
    s_cbranch_scc0 L_is481
    s_waitcnt vmcnt(4)
L_is481:
    buffer_load_dwordx4 v[120:123], v1, s[24:27], s44 offen offset:256 nt
    v_perm_b32 v56, v33, v33, v48
    v_perm_b32 v57, v33, v33, v49
    v_perm_b32 v58, v33, v33, v50
    v_perm_b32 v59, v33, v33, v51
    s_waitcnt vmcnt(6)
    s_nop 0
    v_mfma_f32_16x16x32_bf16 v[28:31], v[56:59], v[112:115], v[28:31]
    s_cbranch_vccnz L_is482
    s_waitcnt vmcnt(5)
    s_cbranch_scc0 L_is482
    s_waitcnt vmcnt(4)
L_is482:
    buffer_load_dwordx4 v[112:115], v1, s[24:27], s44 offen offset:512 nt
    s_waitcnt lgkmcnt(1)
    v_readfirstlane_b32 s55, v2
    s_nop 1
    s_cmp_ge_u32 s55, 0x7800
    s_cselect_b32 s55, s55, 0
    s_bitcmp1_b32 s55, 1
    s_cselect_b64 vcc, -1, 0
    s_bitcmp1_b32 s55, 0
    v_perm_b32 v52, v34, v34, v44
    v_perm_b32 v53, v34, v34, v45
    v_perm_b32 v54, v34, v34, v46
    v_perm_b32 v55, v34, v34, v47
    s_waitcnt vmcnt(6)
    s_nop 0
    v_mfma_f32_16x16x32_bf16 v[28:31], v[52:55], v[116:119], v[28:31]
    s_cbranch_vccnz L_is483
    s_waitcnt vmcnt(5)
    s_cbranch_scc0 L_is483
    s_waitcnt vmcnt(4)
L_is483:
    buffer_load_dwordx4 v[116:119], v1, s[24:27], s44 offen offset:768 nt
    v_mov_b32 v3, 119
    ds_write_b32 v9, v3 offset:31268
    v_perm_b32 v56, v34, v34, v48
    v_perm_b32 v57, v34, v34, v49
    v_perm_b32 v58, v34, v34, v50
    v_perm_b32 v59, v34, v34, v51
    s_waitcnt vmcnt(6)
    s_nop 0
    v_mfma_f32_16x16x32_bf16 v[28:31], v[56:59], v[96:99], v[28:31]
    s_cbranch_vccnz L_is484
    s_waitcnt vmcnt(5)
    s_cbranch_scc0 L_is484
    s_waitcnt vmcnt(4)
L_is484:
    buffer_load_dwordx4 v[96:99], v1, s[24:27], s44 offen offset:1024 nt
    ds_read_b32 v2, v15 offset:31272
    v_perm_b32 v52, v35, v35, v44
    v_perm_b32 v53, v35, v35, v45
    v_perm_b32 v54, v35, v35, v46
    v_perm_b32 v55, v35, v35, v47
    s_waitcnt vmcnt(6)
    s_nop 0
    v_mfma_f32_16x16x32_bf16 v[28:31], v[52:55], v[100:103], v[28:31]
    s_cbranch_vccnz L_is485
    s_waitcnt vmcnt(5)
    s_cbranch_scc0 L_is485
    s_waitcnt vmcnt(4)
L_is485:
    buffer_load_dwordx4 v[100:103], v1, s[24:27], s44 offen offset:1280 nt
    v_perm_b32 v56, v35, v35, v48
    v_perm_b32 v57, v35, v35, v49
    v_perm_b32 v58, v35, v35, v50
    v_perm_b32 v59, v35, v35, v51
    s_waitcnt vmcnt(6)
    s_nop 0
    v_mfma_f32_16x16x32_bf16 v[28:31], v[56:59], v[104:107], v[28:31]
    s_cbranch_vccnz L_is486
    s_waitcnt vmcnt(5)
    s_cbranch_scc0 L_is486
    s_waitcnt vmcnt(4)
L_is486:
    buffer_load_dwordx4 v[104:107], v1, s[24:27], s44 offen offset:1536 nt
    s_waitcnt lgkmcnt(0)
    v_readfirstlane_b32 s55, v2
    s_nop 1
    s_cmp_ge_u32 s55, 0x7900
    s_cselect_b32 s55, s55, 0
    s_bitcmp1_b32 s55, 1
    s_cselect_b64 vcc, -1, 0
    s_bitcmp1_b32 s55, 0
    v_perm_b32 v52, v60, v60, v44
    v_perm_b32 v53, v60, v60, v45
    v_perm_b32 v54, v60, v60, v46
    v_perm_b32 v55, v60, v60, v47
    s_waitcnt vmcnt(6)
    s_nop 0
    v_mfma_f32_16x16x32_bf16 v[28:31], v[52:55], v[108:111], v[28:31]
    s_cbranch_vccnz L_is487
    s_waitcnt vmcnt(5)
    s_cbranch_scc0 L_is487
    s_waitcnt vmcnt(4)
L_is487:
    buffer_load_dwordx4 v[108:111], v1, s[24:27], s44 offen offset:1792 nt
    v_mov_b32 v3, 120
    ds_write_b32 v9, v3 offset:31268
    v_perm_b32 v56, v60, v60, v48
    v_perm_b32 v57, v60, v60, v49
    v_perm_b32 v58, v60, v60, v50
    v_perm_b32 v59, v60, v60, v51
    s_waitcnt vmcnt(6)
    s_nop 0
    v_mfma_f32_16x16x32_bf16 v[28:31], v[56:59], v[120:123], v[28:31]
    s_cbranch_vccnz L_is488
    s_waitcnt vmcnt(5)
    s_cbranch_scc0 L_is488
    s_waitcnt vmcnt(4)
L_is488:
    s_mov_b32 s44, 0xa120000
    buffer_load_dwordx4 v[120:123], v1, s[24:27], s44 offen offset:0 nt
    ds_read_b32 v2, v15 offset:31272
    ds_read_b128 v[32:35], v5 offset:3776
    v_perm_b32 v52, v61, v61, v44
    v_perm_b32 v53, v61, v61, v45
    v_perm_b32 v54, v61, v61, v46
    v_perm_b32 v55, v61, v61, v47
    s_waitcnt vmcnt(6)
    s_nop 0
    v_mfma_f32_16x16x32_bf16 v[28:31], v[52:55], v[112:115], v[28:31]
    s_cbranch_vccnz L_is489
    s_waitcnt vmcnt(5)
    s_cbranch_scc0 L_is489
    s_waitcnt vmcnt(4)
L_is489:
    buffer_load_dwordx4 v[112:115], v1, s[24:27], s44 offen offset:256 nt
    v_perm_b32 v56, v61, v61, v48
    v_perm_b32 v57, v61, v61, v49
    v_perm_b32 v58, v61, v61, v50
    v_perm_b32 v59, v61, v61, v51
    s_waitcnt vmcnt(6)
    s_nop 0
    v_mfma_f32_16x16x32_bf16 v[28:31], v[56:59], v[116:119], v[28:31]
    s_cbranch_vccnz L_is490
    s_waitcnt vmcnt(5)
    s_cbranch_scc0 L_is490
    s_waitcnt vmcnt(4)
L_is490:
    buffer_load_dwordx4 v[116:119], v1, s[24:27], s44 offen offset:512 nt
    s_waitcnt lgkmcnt(1)
    v_readfirstlane_b32 s55, v2
    s_nop 1
    s_cmp_ge_u32 s55, 0x7a00
    s_cselect_b32 s55, s55, 0
    s_bitcmp1_b32 s55, 1
    s_cselect_b64 vcc, -1, 0
    s_bitcmp1_b32 s55, 0
    v_perm_b32 v52, v62, v62, v44
    v_perm_b32 v53, v62, v62, v45
    v_perm_b32 v54, v62, v62, v46
    v_perm_b32 v55, v62, v62, v47
    s_waitcnt vmcnt(6)
    s_nop 0
    v_mfma_f32_16x16x32_bf16 v[28:31], v[52:55], v[96:99], v[28:31]
    s_cbranch_vccnz L_is491
    s_waitcnt vmcnt(5)
    s_cbranch_scc0 L_is491
    s_waitcnt vmcnt(4)
L_is491:
    buffer_load_dwordx4 v[96:99], v1, s[24:27], s44 offen offset:768 nt
    v_mov_b32 v3, 121
    ds_write_b32 v9, v3 offset:31268
    v_perm_b32 v56, v62, v62, v48
    v_perm_b32 v57, v62, v62, v49
    v_perm_b32 v58, v62, v62, v50
    v_perm_b32 v59, v62, v62, v51
    s_waitcnt vmcnt(6)
    s_nop 0
    v_mfma_f32_16x16x32_bf16 v[28:31], v[56:59], v[100:103], v[28:31]
    s_cbranch_vccnz L_is492
    s_waitcnt vmcnt(5)
    s_cbranch_scc0 L_is492
    s_waitcnt vmcnt(4)
L_is492:
    buffer_load_dwordx4 v[100:103], v1, s[24:27], s44 offen offset:1024 nt
    ds_read_b32 v2, v15 offset:31272
    v_perm_b32 v52, v63, v63, v44
    v_perm_b32 v53, v63, v63, v45
    v_perm_b32 v54, v63, v63, v46
    v_perm_b32 v55, v63, v63, v47
    s_waitcnt vmcnt(6)
    s_nop 0
    v_mfma_f32_16x16x32_bf16 v[28:31], v[52:55], v[104:107], v[28:31]
    s_cbranch_vccnz L_is493
    s_waitcnt vmcnt(5)
    s_cbranch_scc0 L_is493
    s_waitcnt vmcnt(4)
L_is493:
    buffer_load_dwordx4 v[104:107], v1, s[24:27], s44 offen offset:1280 nt
    v_perm_b32 v56, v63, v63, v48
    v_perm_b32 v57, v63, v63, v49
    v_perm_b32 v58, v63, v63, v50
    v_perm_b32 v59, v63, v63, v51
    s_waitcnt vmcnt(6)
    s_nop 0
    v_mfma_f32_16x16x32_bf16 v[28:31], v[56:59], v[108:111], v[28:31]
    s_cbranch_vccnz L_is494
    s_waitcnt vmcnt(5)
    s_cbranch_scc0 L_is494
    s_waitcnt vmcnt(4)
L_is494:
    buffer_load_dwordx4 v[108:111], v1, s[24:27], s44 offen offset:1536 nt
    s_waitcnt lgkmcnt(0)
    v_readfirstlane_b32 s55, v2
    s_nop 1
    s_cmp_ge_u32 s55, 0x7b00
    s_cselect_b32 s55, s55, 0
    s_bitcmp1_b32 s55, 1
    s_cselect_b64 vcc, -1, 0
    s_bitcmp1_b32 s55, 0
    v_perm_b32 v52, v32, v32, v44
    v_perm_b32 v53, v32, v32, v45
    v_perm_b32 v54, v32, v32, v46
    v_perm_b32 v55, v32, v32, v47
    s_waitcnt vmcnt(6)
    s_nop 0
    v_mfma_f32_16x16x32_bf16 v[28:31], v[52:55], v[120:123], v[28:31]
    s_cbranch_vccnz L_is495
    s_waitcnt vmcnt(5)
    s_cbranch_scc0 L_is495
    s_waitcnt vmcnt(4)
L_is495:
    buffer_load_dwordx4 v[120:123], v1, s[24:27], s44 offen offset:1792 nt
    v_mov_b32 v3, 122
    ds_write_b32 v9, v3 offset:31268
    v_perm_b32 v56, v32, v32, v48
    v_perm_b32 v57, v32, v32, v49
    v_perm_b32 v58, v32, v32, v50
    v_perm_b32 v59, v32, v32, v51
    s_waitcnt vmcnt(6)
    s_nop 0
    v_mfma_f32_16x16x32_bf16 v[28:31], v[56:59], v[112:115], v[28:31]
    s_cbranch_vccnz L_is496
    s_waitcnt vmcnt(5)
    s_cbranch_scc0 L_is496
    s_waitcnt vmcnt(4)
L_is496:
    s_mov_b32 s44, 0xa180000
    buffer_load_dwordx4 v[112:115], v1, s[24:27], s44 offen offset:0 nt
    ds_read_b32 v2, v15 offset:31272
    ds_read_b128 v[60:63], v5 offset:3840
    v_perm_b32 v52, v33, v33, v44
    v_perm_b32 v53, v33, v33, v45
    v_perm_b32 v54, v33, v33, v46
    v_perm_b32 v55, v33, v33, v47
    s_waitcnt vmcnt(6)
    s_nop 0
    v_mfma_f32_16x16x32_bf16 v[28:31], v[52:55], v[116:119], v[28:31]
    s_cbranch_vccnz L_is497
    s_waitcnt vmcnt(5)
    s_cbranch_scc0 L_is497
    s_waitcnt vmcnt(4)
L_is497:
    buffer_load_dwordx4 v[116:119], v1, s[24:27], s44 offen offset:256 nt
    v_perm_b32 v56, v33, v33, v48
    v_perm_b32 v57, v33, v33, v49
    v_perm_b32 v58, v33, v33, v50
    v_perm_b32 v59, v33, v33, v51
    s_waitcnt vmcnt(6)
    s_nop 0
    v_mfma_f32_16x16x32_bf16 v[28:31], v[56:59], v[96:99], v[28:31]
    s_cbranch_vccnz L_is498
    s_waitcnt vmcnt(5)
    s_cbranch_scc0 L_is498
    s_waitcnt vmcnt(4)
L_is498:
    buffer_load_dwordx4 v[96:99], v1, s[24:27], s44 offen offset:512 nt
    s_waitcnt lgkmcnt(1)
    v_readfirstlane_b32 s55, v2
    s_nop 1
    s_cmp_ge_u32 s55, 0x7c00
    s_cselect_b32 s55, s55, 0
    s_bitcmp1_b32 s55, 1
    s_cselect_b64 vcc, -1, 0
    s_bitcmp1_b32 s55, 0
    v_perm_b32 v52, v34, v34, v44
    v_perm_b32 v53, v34, v34, v45
    v_perm_b32 v54, v34, v34, v46
    v_perm_b32 v55, v34, v34, v47
    s_waitcnt vmcnt(6)
    s_nop 0
    v_mfma_f32_16x16x32_bf16 v[28:31], v[52:55], v[100:103], v[28:31]
    s_cbranch_vccnz L_is499
    s_waitcnt vmcnt(5)
    s_cbranch_scc0 L_is499
    s_waitcnt vmcnt(4)
L_is499:
    buffer_load_dwordx4 v[100:103], v1, s[24:27], s44 offen offset:768 nt
    v_mov_b32 v3, 123
    ds_write_b32 v9, v3 offset:31268
    v_perm_b32 v56, v34, v34, v48
    v_perm_b32 v57, v34, v34, v49
    v_perm_b32 v58, v34, v34, v50
    v_perm_b32 v59, v34, v34, v51
    s_waitcnt vmcnt(6)
    s_nop 0
    v_mfma_f32_16x16x32_bf16 v[28:31], v[56:59], v[104:107], v[28:31]
    s_cbranch_vccnz L_is500
    s_waitcnt vmcnt(5)
    s_cbranch_scc0 L_is500
    s_waitcnt vmcnt(4)
L_is500:
    buffer_load_dwordx4 v[104:107], v1, s[24:27], s44 offen offset:1024 nt
    ds_read_b32 v2, v15 offset:31272
    v_perm_b32 v52, v35, v35, v44
    v_perm_b32 v53, v35, v35, v45
    v_perm_b32 v54, v35, v35, v46
    v_perm_b32 v55, v35, v35, v47
    s_waitcnt vmcnt(6)
    s_nop 0
    v_mfma_f32_16x16x32_bf16 v[28:31], v[52:55], v[108:111], v[28:31]
    s_cbranch_vccnz L_is501
    s_waitcnt vmcnt(5)
    s_cbranch_scc0 L_is501
    s_waitcnt vmcnt(4)
L_is501:
    buffer_load_dwordx4 v[108:111], v1, s[24:27], s44 offen offset:1280 nt
    v_perm_b32 v56, v35, v35, v48
    v_perm_b32 v57, v35, v35, v49
    v_perm_b32 v58, v35, v35, v50
    v_perm_b32 v59, v35, v35, v51
    s_waitcnt vmcnt(6)
    s_nop 0
    v_mfma_f32_16x16x32_bf16 v[28:31], v[56:59], v[120:123], v[28:31]
    s_cbranch_vccnz L_is502
    s_waitcnt vmcnt(5)
    s_cbranch_scc0 L_is502
    s_waitcnt vmcnt(4)
L_is502:
    buffer_load_dwordx4 v[120:123], v1, s[24:27], s44 offen offset:1536 nt
    s_cbranch_vccnz L_is503
    s_waitcnt vmcnt(5)
    s_cbranch_scc0 L_is503
    s_waitcnt vmcnt(4)
L_is503:
    buffer_load_dwordx4 v[124:127], v1, s[24:27], s44 offen offset:1792 nt
    s_waitcnt lgkmcnt(0)
    v_readfirstlane_b32 s55, v2
    s_nop 1
    s_cmp_ge_u32 s55, 0x7d00
    s_cselect_b32 s55, s55, 0
    s_bitcmp1_b32 s55, 1
    s_cselect_b64 vcc, -1, 0
    s_bitcmp1_b32 s55, 0
    v_perm_b32 v52, v60, v60, v44
    v_perm_b32 v53, v60, v60, v45
    v_perm_b32 v54, v60, v60, v46
    v_perm_b32 v55, v60, v60, v47
    s_waitcnt vmcnt(7)
    s_nop 0
    v_mfma_f32_16x16x32_bf16 v[28:31], v[52:55], v[112:115], v[28:31]
    s_mov_b32 s44, 0xa1a0000
    buffer_load_dwordx4 v[112:115], v1, s[24:27], s44 offen offset:0 nt
    buffer_load_dwordx4 v[128:131], v1, s[24:27], s44 offen offset:256 nt
    v_perm_b32 v56, v60, v60, v48
    v_perm_b32 v57, v60, v60, v49
    v_perm_b32 v58, v60, v60, v50
    v_perm_b32 v59, v60, v60, v51
    s_waitcnt vmcnt(8)
    s_nop 0
    v_mfma_f32_16x16x32_bf16 v[28:31], v[56:59], v[116:119], v[28:31]
    buffer_load_dwordx4 v[116:119], v1, s[24:27], s44 offen offset:512 nt
    buffer_load_dwordx4 v[132:135], v1, s[24:27], s44 offen offset:768 nt
    ds_read_b128 v[32:35], v5 offset:3904
    v_perm_b32 v52, v61, v61, v44
    v_perm_b32 v53, v61, v61, v45
    v_perm_b32 v54, v61, v61, v46
    v_perm_b32 v55, v61, v61, v47
    s_waitcnt vmcnt(9)
    s_nop 0
    v_mfma_f32_16x16x32_bf16 v[28:31], v[52:55], v[96:99], v[28:31]
    buffer_load_dwordx4 v[96:99], v1, s[24:27], s44 offen offset:1024 nt
    buffer_load_dwordx4 v[136:139], v1, s[24:27], s44 offen offset:1280 nt
    v_perm_b32 v56, v61, v61, v48
    v_perm_b32 v57, v61, v61, v49
    v_perm_b32 v58, v61, v61, v50
    v_perm_b32 v59, v61, v61, v51
    s_waitcnt vmcnt(10)
    s_nop 0
    v_mfma_f32_16x16x32_bf16 v[28:31], v[56:59], v[100:103], v[28:31]
    buffer_load_dwordx4 v[100:103], v1, s[24:27], s44 offen offset:1536 nt
    buffer_load_dwordx4 v[140:143], v1, s[24:27], s44 offen offset:1792 nt
    v_perm_b32 v52, v62, v62, v44
    v_perm_b32 v53, v62, v62, v45
    v_perm_b32 v54, v62, v62, v46
    v_perm_b32 v55, v62, v62, v47
    s_waitcnt vmcnt(11)
    s_nop 0
    v_mfma_f32_16x16x32_bf16 v[28:31], v[52:55], v[104:107], v[28:31]
    v_perm_b32 v56, v62, v62, v48
    v_perm_b32 v57, v62, v62, v49
    v_perm_b32 v58, v62, v62, v50
    v_perm_b32 v59, v62, v62, v51
    s_waitcnt vmcnt(10)
    s_nop 0
    v_mfma_f32_16x16x32_bf16 v[28:31], v[56:59], v[108:111], v[28:31]
    v_perm_b32 v52, v63, v63, v44
    v_perm_b32 v53, v63, v63, v45
    v_perm_b32 v54, v63, v63, v46
    v_perm_b32 v55, v63, v63, v47
    s_waitcnt vmcnt(9)
    s_nop 0
    v_mfma_f32_16x16x32_bf16 v[28:31], v[52:55], v[120:123], v[28:31]
    v_perm_b32 v56, v63, v63, v48
    v_perm_b32 v57, v63, v63, v49
    v_perm_b32 v58, v63, v63, v50
    v_perm_b32 v59, v63, v63, v51
    s_waitcnt vmcnt(8)
    s_nop 0
    v_mfma_f32_16x16x32_bf16 v[28:31], v[56:59], v[124:127], v[28:31]
    s_waitcnt lgkmcnt(0)
    v_perm_b32 v52, v32, v32, v44
    v_perm_b32 v53, v32, v32, v45
    v_perm_b32 v54, v32, v32, v46
    v_perm_b32 v55, v32, v32, v47
    s_waitcnt vmcnt(7)
    s_nop 0
    v_mfma_f32_16x16x32_bf16 v[28:31], v[52:55], v[112:115], v[28:31]
    v_perm_b32 v56, v32, v32, v48
    v_perm_b32 v57, v32, v32, v49
    v_perm_b32 v58, v32, v32, v50
    v_perm_b32 v59, v32, v32, v51
    s_waitcnt vmcnt(6)
    s_nop 0
    v_mfma_f32_16x16x32_bf16 v[28:31], v[56:59], v[128:131], v[28:31]
    v_perm_b32 v52, v33, v33, v44
    v_perm_b32 v53, v33, v33, v45
    v_perm_b32 v54, v33, v33, v46
    v_perm_b32 v55, v33, v33, v47
    s_waitcnt vmcnt(5)
    s_nop 0
    v_mfma_f32_16x16x32_bf16 v[28:31], v[52:55], v[116:119], v[28:31]
    v_perm_b32 v56, v33, v33, v48
    v_perm_b32 v57, v33, v33, v49
    v_perm_b32 v58, v33, v33, v50
    v_perm_b32 v59, v33, v33, v51
    s_waitcnt vmcnt(4)
    s_nop 0
    v_mfma_f32_16x16x32_bf16 v[28:31], v[56:59], v[132:135], v[28:31]
    v_perm_b32 v52, v34, v34, v44
    v_perm_b32 v53, v34, v34, v45
    v_perm_b32 v54, v34, v34, v46
    v_perm_b32 v55, v34, v34, v47
    s_waitcnt vmcnt(3)
    s_nop 0
    v_mfma_f32_16x16x32_bf16 v[28:31], v[52:55], v[96:99], v[28:31]
    v_perm_b32 v56, v34, v34, v48
    v_perm_b32 v57, v34, v34, v49
    v_perm_b32 v58, v34, v34, v50
    v_perm_b32 v59, v34, v34, v51
    s_waitcnt vmcnt(2)
    s_nop 0
    v_mfma_f32_16x16x32_bf16 v[28:31], v[56:59], v[136:139], v[28:31]
    v_perm_b32 v52, v35, v35, v44
    v_perm_b32 v53, v35, v35, v45
    v_perm_b32 v54, v35, v35, v46
    v_perm_b32 v55, v35, v35, v47
    s_waitcnt vmcnt(1)
    s_nop 0
    v_mfma_f32_16x16x32_bf16 v[28:31], v[52:55], v[100:103], v[28:31]
    v_perm_b32 v56, v35, v35, v48
    v_perm_b32 v57, v35, v35, v49
    v_perm_b32 v58, v35, v35, v50
    v_perm_b32 v59, v35, v35, v51
    s_waitcnt vmcnt(0)
    s_nop 0
    v_mfma_f32_16x16x32_bf16 v[28:31], v[56:59], v[140:143], v[28:31]
    s_nop 7
    v_permlane32_swap_b32 v28, v30
    v_permlane32_swap_b32 v29, v31
    v_add_f32 v28, v28, v30
    v_add_f32 v29, v29, v31
    ds_write_b64 v8, v[28:29] offset:6144
    s_waitcnt lgkmcnt(0)
    s_barrier
    s_endpgm
.p2align 6
L_helper:
    s_and_b32 s3, s3, 3
    v_and_b32 v72, 3, v13
    v_and_b32 v76, 63, v0
    v_lshlrev_b32 v7, 3, v76
    v_lshlrev_b32 v3, 4, v76
    v_lshlrev_b32 v108, 2, v76
    v_mov_b32 v2, 0
    v_mov_b32 v16, -1
    v_mov_b32 v17, -1
    v_mov_b32 v18, -1
    v_mov_b32 v19, -1
    s_lshl_b32 s42, s3, 10
    v_add_u32 v73, s42, v3
    ds_write_b128 v73, v[16:19] offset:18432
    ds_write_b64 v7, v[16:17] offset:30720
    v_and_b32 v73, 124, v108
    ds_write_b32 v73, v2 offset:31232
    s_waitcnt lgkmcnt(0)
    s_barrier
    s_add_u32 s36, s18, 0x0
    s_addc_u32 s37, s19, 0
    s_mov_b32 s38, 0x800000
    s_mov_b32 s39, 0x20000
    s_lshl_b32 s47, s40, 14
    s_lshl_b32 s32, s41, 9
    s_add_u32 s53, s47, s32
    v_mov_b32 v110, v7
    s_lshl_b32 s52, s40, 10
    s_add_u32 s52, s52, 524288
    s_lshl_b32 s43, s40, 3
    s_add_u32 s16, s16, s43
    s_addc_u32 s17, s17, 0
    v_lshl_add_u32 v109, v72, 9, v4
    v_lshlrev_b32 v15, 9, v14
    v_add_u32 v15, 252, v15
    v_subrev_u32 v6, s40, v14
    v_and_b32 v6, 15, v6
    v_lshl_add_u32 v6, v72, 4, v6
    v_lshlrev_b32 v6, 2, v6
    s_mov_b32 s34, 2
    s_cmp_lg_u32 s3, 1
    s_cbranch_scc1 L_lead
    s_sub_u32 s42, s41, s40
    s_and_b32 s43, s42, 3
    s_cbranch_scc1 L_lead1
    s_bfe_u32 s42, s42, 0x20002
    s_lshr_b32 s34, s42, 1
    s_lshl_b32 s43, s34, 13
    s_add_u32 s47, s47, s43
    s_and_b32 s43, s42, 1
    s_lshl_b32 s43, s43, 8
    s_add_u32 s47, s47, s43
    s_add_u32 s33, s47, 4096
    s_lshl_b32 s35, s42, 8
    s_add_u32 s35, s35, s52
    buffer_load_dword v105, v15, s[36:39], s47 offen sc1
    buffer_load_dword v102, v6, s[36:39], s35 offen sc1
    buffer_load_dwordx4 v[16:19], v109, s[36:39], s47 offen offset:0 sc1
    buffer_load_dwordx4 v[20:23], v109, s[36:39], s47 offen offset:2048 sc1
    buffer_load_dwordx4 v[24:27], v109, s[36:39], s33 offen offset:0 sc1
    buffer_load_dwordx4 v[28:31], v109, s[36:39], s33 offen offset:2048 sc1
    s_lshl_b32 s42, s42, 2
    v_mov_b32 v74, s42
    v_mov_b32 v73, 1
    s_waitcnt vmcnt(0)
    v_alignbit_b32 v104, v16, v2, 1
    v_alignbit_b32 v104, v17, v104, 1
    v_alignbit_b32 v104, v18, v104, 1
    v_alignbit_b32 v104, v19, v104, 1
    v_alignbit_b32 v104, v20, v104, 1
    v_alignbit_b32 v104, v21, v104, 1
    v_alignbit_b32 v104, v22, v104, 1
    v_alignbit_b32 v104, v23, v104, 1
    v_alignbit_b32 v104, v24, v104, 1
    v_alignbit_b32 v104, v25, v104, 1
    v_alignbit_b32 v104, v26, v104, 1
    v_alignbit_b32 v104, v27, v104, 1
    v_alignbit_b32 v104, v28, v104, 1
    v_alignbit_b32 v104, v29, v104, 1
    v_alignbit_b32 v104, v30, v104, 1
    v_alignbit_b32 v104, v31, v104, 1
    v_alignbit_b32 v105, v105, v2, 1
    v_not_b32 v102, v102
    s_cmp_lg_u32 s34, 0
    s_cbranch_scc1 L_lead1
    s_mov_b64 exec, 1
    global_store_dword v74, v73, s[16:17] sc1
    s_mov_b64 exec, -1
L_lead1:
    v_mov_b32 v73, 1
    ds_write_b32 v2, v73 offset:31264
L_lead:
    s_bfe_u32 s43, s41, 0x20000
    s_lshl_b32 s43, s43, 8
    s_bfe_u32 s42, s41, 0x10002
    s_lshl_b32 s42, s42, 11
    s_or_b32 s43, s43, s42
    s_bfe_u32 s42, s41, 0x10003
    s_lshl_b32 s42, s42, 14
    s_or_b32 s43, s43, s42
    s_add_u32 s28, s12, s43
    s_addc_u32 s29, s13, 0
    s_sub_u32 s30, 0x200000, s43
    s_mov_b32 s31, 0x20000
    s_lshl_b32 s56, s40, 15
    s_add_u32 s56, s56, 1048576
    s_lshl_b32 s42, s3, 13
    s_add_u32 s32, s32, s42
    s_add_u32 s32, s32, s56
    s_lshr_b32 s42, s41, 2
    s_lshl_b32 s62, s42, 13
    s_add_u32 s62, s62, s56
    s_and_b32 s43, s41, 3
    s_lshl_b32 s57, s43, 7
    s_add_u32 s62, s62, s57
    s_add_u32 s63, s62, 4096
    v_lshrrev_b32 v73, 3, v76
    v_and_b32 v74, 7, v76
    v_lshlrev_b32 v107, 9, v73
    v_lshl_add_u32 v107, v74, 4, v107
    s_bfe_u32 s42, s41, 0x10002
    s_lshl_b32 s42, s42, 3
    s_bfe_u32 s55, s41, 0x10003
    s_lshl_b32 s55, s55, 5
    s_or_b32 s42, s42, s55
    s_bfe_u32 s57, s40, 0x30000
    s_lshl_b32 s57, s57, 0
    s_bfe_u32 s55, s40, 0x10003
    s_lshl_b32 s55, s55, 4
    s_or_b32 s57, s57, s55
    s_add_u32 s42, s42, s57
    s_lshl_b32 s42, s42, 8
    s_lshl_b32 s43, s43, 6
    s_add_u32 s42, s42, s43
    v_lshlrev_b32 v106, 3, v74
    v_lshl_add_u32 v106, v72, 1, v106
    v_add_u32 v106, s42, v106
    v_lshrrev_b32 v73, 3, v14
    v_lshl_add_u32 v8, v73, 2, v72
    v_lshlrev_b32 v8, 5, v8
    s_bfe_u32 s42, s3, 0x20000
    s_lshl_b32 s42, s42, 12
    v_lshlrev_b32 v1, 15, v72
    v_add3_u32 v1, v1, v4, s42
    v_lshrrev_b32 v73, 2, v14
    v_mul_u32_u24 v5, 4608, v73
    v_lshrrev_b32 v73, 1, v72
    v_mul_u32_u24 v73, 1152, v73
    s_lshl_b32 s42, s3, 7
    v_add3_u32 v5, v5, v73, s42
    v_and_b32 v73, 3, v14
    v_lshl_add_u32 v5, v73, 4, v5
    v_and_b32 v73, 1, v72
    v_lshl_add_u32 v5, v73, 3, v5
    s_lshl_b32 s42, s3, 11
    s_add_u32 s42, s42, 22528
    v_add_u32 v9, s42, v7
    s_lshl_b32 s64, s40, 12
    s_add_u32 s64, s64, 557056
    v_lshrrev_b32 v112, 2, v14
    v_lshlrev_b32 v112, 10, v112
    v_and_b32 v73, 3, v14
    v_lshl_add_u32 v112, v73, 5, v112
    v_lshl_add_u32 v112, v72, 8, v112
    v_and_b32 v73, 7, v14
    v_and_b32 v74, 1, v73
    v_lshrrev_b32 v73, 1, v73
    v_cmp_eq_u32 vcc, 1, v74
    v_mov_b32 v74, 0x0c0c0100
    v_mov_b32 v75, 0x01000c0c
    v_cndmask_b32 v74, v74, v75, vcc
    v_mov_b32 v75, 0x0c0c0302
    v_mov_b32 v76, 0x03020c0c
    v_cndmask_b32 v75, v75, v76, vcc
    v_mov_b32 v76, 0x0c0c0c0c
    v_cmp_eq_u32 vcc, 0, v73
    s_nop 1
    v_cndmask_b32 v84, v76, v74, vcc
    v_cndmask_b32 v88, v76, v75, vcc
    v_cmp_eq_u32 vcc, 1, v73
    s_nop 1
    v_cndmask_b32 v85, v76, v74, vcc
    v_cndmask_b32 v89, v76, v75, vcc
    v_cmp_eq_u32 vcc, 2, v73
    s_nop 1
    v_cndmask_b32 v86, v76, v74, vcc
    v_cndmask_b32 v90, v76, v75, vcc
    v_cmp_eq_u32 vcc, 3, v73
    s_nop 1
    v_cndmask_b32 v87, v76, v74, vcc
    v_cndmask_b32 v91, v76, v75, vcc
    s_mov_b32 s54, 0x3e0293ee
    s_bfe_u32 s43, s41, 0x20000
    s_lshl_b32 s43, s43, 8
    s_bfe_u32 s42, s41, 0x10002
    s_lshl_b32 s42, s42, 11
    s_or_b32 s43, s43, s42
    s_bfe_u32 s42, s41, 0x10003
    s_lshl_b32 s42, s42, 14
    s_or_b32 s43, s43, s42
    s_add_u32 s20, s10, s43
    s_addc_u32 s21, s11, 0
    s_sub_u32 s22, 0x200000, s43
    s_mov_b32 s23, 0x20000
    v_and_b32 v73, 15, v13
    v_xor_b32 v74, v73, v14
    v_lshlrev_b32 v74, 4, v74
    v_lshl_add_u32 v74, v73, 15, v74
    s_and_b32 s44, s40, 7
    s_lshl_b32 s43, s3, 10
    s_add_u32 s43, s43, 31744
    s_lshl_b32 s44, s40, 1
    s_bfe_u32 s46, s44, 0x10000
    s_lshl_b32 s46, s46, 10
    s_bfe_u32 s42, s44, 0x20001
    s_lshl_b32 s42, s42, 12
    s_or_b32 s46, s46, s42
    s_bfe_u32 s55, s44, 0x20003
    s_lshl_b32 s42, s55, 19
    s_or_b32 s46, s46, s42
    s_bfe_u32 s42, s44, 0x30000
    s_lshl_b32 s42, s42, 2
    s_or_b32 s42, s42, s55
    s_lshl_b32 s42, s42, 12
    s_add_u32 m0, s42, s43
    s_nop 0
    buffer_load_dwordx4 v74, s[20:23], s46 offen  lds
    s_add_u32 s44, s44, 1
    s_bfe_u32 s46, s44, 0x10000
    s_lshl_b32 s46, s46, 10
    s_bfe_u32 s42, s44, 0x20001
    s_lshl_b32 s42, s42, 12
    s_or_b32 s46, s46, s42
    s_bfe_u32 s55, s44, 0x20003
    s_lshl_b32 s42, s55, 19
    s_or_b32 s46, s46, s42
    s_bfe_u32 s42, s44, 0x30000
    s_lshl_b32 s42, s42, 2
    s_or_b32 s42, s42, s55
    s_lshl_b32 s42, s42, 12
    s_add_u32 m0, s42, s43
    s_nop 0
    buffer_load_dwordx4 v74, s[20:23], s46 offen  lds
    s_add_u32 s44, s44, 1
    s_bfe_u32 s46, s44, 0x10000
    s_lshl_b32 s46, s46, 10
    s_bfe_u32 s42, s44, 0x20001
    s_lshl_b32 s42, s42, 12
    s_or_b32 s46, s46, s42
    s_bfe_u32 s55, s44, 0x20003
    s_lshl_b32 s42, s55, 19
    s_or_b32 s46, s46, s42
    s_bfe_u32 s42, s44, 0x30000
    s_lshl_b32 s42, s42, 2
    s_or_b32 s42, s42, s55
    s_lshl_b32 s42, s42, 12
    s_add_u32 m0, s42, s43
    s_nop 0
    buffer_load_dwordx4 v74, s[20:23], s46 offen  lds
    s_waitcnt vmcnt(2)
    s_add_u32 s44, s44, 1
    s_bfe_u32 s46, s44, 0x10000
    s_lshl_b32 s46, s46, 10
    s_bfe_u32 s42, s44, 0x20001
    s_lshl_b32 s42, s42, 12
    s_or_b32 s46, s46, s42
    s_bfe_u32 s55, s44, 0x20003
    s_lshl_b32 s42, s55, 19
    s_or_b32 s46, s46, s42
    s_bfe_u32 s42, s44, 0x30000
    s_lshl_b32 s42, s42, 2
    s_or_b32 s42, s42, s55
    s_lshl_b32 s42, s42, 12
    s_add_u32 m0, s42, s43
    s_nop 0
    buffer_load_dwordx4 v74, s[20:23], s46 offen  lds
    s_waitcnt vmcnt(2)
    s_add_u32 s44, s44, 1
    s_bfe_u32 s46, s44, 0x10000
    s_lshl_b32 s46, s46, 10
    s_bfe_u32 s42, s44, 0x20001
    s_lshl_b32 s42, s42, 12
    s_or_b32 s46, s46, s42
    s_bfe_u32 s55, s44, 0x20003
    s_lshl_b32 s42, s55, 19
    s_or_b32 s46, s46, s42
    s_bfe_u32 s42, s44, 0x30000
    s_lshl_b32 s42, s42, 2
    s_or_b32 s42, s42, s55
    s_lshl_b32 s42, s42, 12
    s_add_u32 m0, s42, s43
    s_nop 0
    buffer_load_dwordx4 v74, s[20:23], s46 offen  lds
    s_waitcnt vmcnt(2)
    s_add_u32 s44, s44, 1
    s_bfe_u32 s46, s44, 0x10000
    s_lshl_b32 s46, s46, 10
    s_bfe_u32 s42, s44, 0x20001
    s_lshl_b32 s42, s42, 12
    s_or_b32 s46, s46, s42
    s_bfe_u32 s55, s44, 0x20003
    s_lshl_b32 s42, s55, 19
    s_or_b32 s46, s46, s42
    s_bfe_u32 s42, s44, 0x30000
    s_lshl_b32 s42, s42, 2
    s_or_b32 s42, s42, s55
    s_lshl_b32 s42, s42, 12
    s_add_u32 m0, s42, s43
    s_nop 0
    buffer_load_dwordx4 v74, s[20:23], s46 offen  lds
    s_waitcnt vmcnt(2)
    s_add_u32 s44, s44, 1
    s_bfe_u32 s46, s44, 0x10000
    s_lshl_b32 s46, s46, 10
    s_bfe_u32 s42, s44, 0x20001
    s_lshl_b32 s42, s42, 12
    s_or_b32 s46, s46, s42
    s_bfe_u32 s55, s44, 0x20003
    s_lshl_b32 s42, s55, 19
    s_or_b32 s46, s46, s42
    s_bfe_u32 s42, s44, 0x30000
    s_lshl_b32 s42, s42, 2
    s_or_b32 s42, s42, s55
    s_lshl_b32 s42, s42, 12
    s_add_u32 m0, s42, s43
    s_nop 0
    buffer_load_dwordx4 v74, s[20:23], s46 offen  lds
    s_waitcnt vmcnt(2)
    s_add_u32 s44, s44, 1
    s_bfe_u32 s46, s44, 0x10000
    s_lshl_b32 s46, s46, 10
    s_bfe_u32 s42, s44, 0x20001
    s_lshl_b32 s42, s42, 12
    s_or_b32 s46, s46, s42
    s_bfe_u32 s55, s44, 0x20003
    s_lshl_b32 s42, s55, 19
    s_or_b32 s46, s46, s42
    s_bfe_u32 s42, s44, 0x30000
    s_lshl_b32 s42, s42, 2
    s_or_b32 s42, s42, s55
    s_lshl_b32 s42, s42, 12
    s_add_u32 m0, s42, s43
    s_nop 0
    buffer_load_dwordx4 v74, s[20:23], s46 offen  lds
    s_waitcnt vmcnt(2)
    s_add_u32 s44, s44, 1
    s_bfe_u32 s46, s44, 0x10000
    s_lshl_b32 s46, s46, 10
    s_bfe_u32 s42, s44, 0x20001
    s_lshl_b32 s42, s42, 12
    s_or_b32 s46, s46, s42
    s_bfe_u32 s55, s44, 0x20003
    s_lshl_b32 s42, s55, 19
    s_or_b32 s46, s46, s42
    s_bfe_u32 s42, s44, 0x30000
    s_lshl_b32 s42, s42, 2
    s_or_b32 s42, s42, s55
    s_lshl_b32 s42, s42, 12
    s_add_u32 m0, s42, s43
    s_nop 0
    buffer_load_dwordx4 v74, s[20:23], s46 offen  lds
    s_waitcnt vmcnt(2)
    s_add_u32 s44, s44, 1
    s_bfe_u32 s46, s44, 0x10000
    s_lshl_b32 s46, s46, 10
    s_bfe_u32 s42, s44, 0x20001
    s_lshl_b32 s42, s42, 12
    s_or_b32 s46, s46, s42
    s_bfe_u32 s55, s44, 0x20003
    s_lshl_b32 s42, s55, 19
    s_or_b32 s46, s46, s42
    s_bfe_u32 s42, s44, 0x30000
    s_lshl_b32 s42, s42, 2
    s_or_b32 s42, s42, s55
    s_lshl_b32 s42, s42, 12
    s_add_u32 m0, s42, s43
    s_nop 0
    buffer_load_dwordx4 v74, s[20:23], s46 offen  lds
    s_waitcnt vmcnt(2)
    s_add_u32 s44, s44, 1
    s_bfe_u32 s46, s44, 0x10000
    s_lshl_b32 s46, s46, 10
    s_bfe_u32 s42, s44, 0x20001
    s_lshl_b32 s42, s42, 12
    s_or_b32 s46, s46, s42
    s_bfe_u32 s55, s44, 0x20003
    s_lshl_b32 s42, s55, 19
    s_or_b32 s46, s46, s42
    s_bfe_u32 s42, s44, 0x30000
    s_lshl_b32 s42, s42, 2
    s_or_b32 s42, s42, s55
    s_lshl_b32 s42, s42, 12
    s_add_u32 m0, s42, s43
    s_nop 0
    buffer_load_dwordx4 v74, s[20:23], s46 offen  lds
    s_waitcnt vmcnt(2)
    s_add_u32 s44, s44, 1
    s_bfe_u32 s46, s44, 0x10000
    s_lshl_b32 s46, s46, 10
    s_bfe_u32 s42, s44, 0x20001
    s_lshl_b32 s42, s42, 12
    s_or_b32 s46, s46, s42
    s_bfe_u32 s55, s44, 0x20003
    s_lshl_b32 s42, s55, 19
    s_or_b32 s46, s46, s42
    s_bfe_u32 s42, s44, 0x30000
    s_lshl_b32 s42, s42, 2
    s_or_b32 s42, s42, s55
    s_lshl_b32 s42, s42, 12
    s_add_u32 m0, s42, s43
    s_nop 0
    buffer_load_dwordx4 v74, s[20:23], s46 offen  lds
    s_waitcnt vmcnt(2)
    s_add_u32 s44, s44, 1
    s_bfe_u32 s46, s44, 0x10000
    s_lshl_b32 s46, s46, 10
    s_bfe_u32 s42, s44, 0x20001
    s_lshl_b32 s42, s42, 12
    s_or_b32 s46, s46, s42
    s_bfe_u32 s55, s44, 0x20003
    s_lshl_b32 s42, s55, 19
    s_or_b32 s46, s46, s42
    s_bfe_u32 s42, s44, 0x30000
    s_lshl_b32 s42, s42, 2
    s_or_b32 s42, s42, s55
    s_lshl_b32 s42, s42, 12
    s_add_u32 m0, s42, s43
    s_nop 0
    buffer_load_dwordx4 v74, s[20:23], s46 offen  lds
    s_waitcnt vmcnt(2)
    s_add_u32 s44, s44, 1
    s_bfe_u32 s46, s44, 0x10000
    s_lshl_b32 s46, s46, 10
    s_bfe_u32 s42, s44, 0x20001
    s_lshl_b32 s42, s42, 12
    s_or_b32 s46, s46, s42
    s_bfe_u32 s55, s44, 0x20003
    s_lshl_b32 s42, s55, 19
    s_or_b32 s46, s46, s42
    s_bfe_u32 s42, s44, 0x30000
    s_lshl_b32 s42, s42, 2
    s_or_b32 s42, s42, s55
    s_lshl_b32 s42, s42, 12
    s_add_u32 m0, s42, s43
    s_nop 0
    buffer_load_dwordx4 v74, s[20:23], s46 offen  lds
    s_waitcnt vmcnt(2)
    s_add_u32 s44, s44, 1
    s_bfe_u32 s46, s44, 0x10000
    s_lshl_b32 s46, s46, 10
    s_bfe_u32 s42, s44, 0x20001
    s_lshl_b32 s42, s42, 12
    s_or_b32 s46, s46, s42
    s_bfe_u32 s55, s44, 0x20003
    s_lshl_b32 s42, s55, 19
    s_or_b32 s46, s46, s42
    s_bfe_u32 s42, s44, 0x30000
    s_lshl_b32 s42, s42, 2
    s_or_b32 s42, s42, s55
    s_lshl_b32 s42, s42, 12
    s_add_u32 m0, s42, s43
    s_nop 0
    buffer_load_dwordx4 v74, s[20:23], s46 offen  lds
    s_waitcnt vmcnt(2)
    s_add_u32 s44, s44, 1
    s_bfe_u32 s46, s44, 0x10000
    s_lshl_b32 s46, s46, 10
    s_bfe_u32 s42, s44, 0x20001
    s_lshl_b32 s42, s42, 12
    s_or_b32 s46, s46, s42
    s_bfe_u32 s55, s44, 0x20003
    s_lshl_b32 s42, s55, 19
    s_or_b32 s46, s46, s42
    s_bfe_u32 s42, s44, 0x30000
    s_lshl_b32 s42, s42, 2
    s_or_b32 s42, s42, s55
    s_lshl_b32 s42, s42, 12
    s_add_u32 m0, s42, s43
    s_nop 0
    buffer_load_dwordx4 v74, s[20:23], s46 offen  lds
    s_waitcnt vmcnt(2)
    s_add_u32 s44, s44, 1
    s_bfe_u32 s46, s44, 0x10000
    s_lshl_b32 s46, s46, 10
    s_bfe_u32 s42, s44, 0x20001
    s_lshl_b32 s42, s42, 12
    s_or_b32 s46, s46, s42
    s_bfe_u32 s55, s44, 0x20003
    s_lshl_b32 s42, s55, 19
    s_or_b32 s46, s46, s42
    s_bfe_u32 s42, s44, 0x30000
    s_lshl_b32 s42, s42, 2
    s_or_b32 s42, s42, s55
    s_lshl_b32 s42, s42, 12
    s_add_u32 m0, s42, s43
    s_nop 0
    buffer_load_dwordx4 v74, s[20:23], s46 offen  lds
    s_waitcnt vmcnt(2)
    s_add_u32 s44, s44, 1
    s_bfe_u32 s46, s44, 0x10000
    s_lshl_b32 s46, s46, 10
    s_bfe_u32 s42, s44, 0x20001
    s_lshl_b32 s42, s42, 12
    s_or_b32 s46, s46, s42
    s_bfe_u32 s55, s44, 0x20003
    s_lshl_b32 s42, s55, 19
    s_or_b32 s46, s46, s42
    s_bfe_u32 s42, s44, 0x30000
    s_lshl_b32 s42, s42, 2
    s_or_b32 s42, s42, s55
    s_lshl_b32 s42, s42, 12
    s_add_u32 m0, s42, s43
    s_nop 0
    buffer_load_dwordx4 v74, s[20:23], s46 offen  lds
    s_waitcnt vmcnt(2)
    s_add_u32 s44, s44, 1
    s_bfe_u32 s46, s44, 0x10000
    s_lshl_b32 s46, s46, 10
    s_bfe_u32 s42, s44, 0x20001
    s_lshl_b32 s42, s42, 12
    s_or_b32 s46, s46, s42
    s_bfe_u32 s55, s44, 0x20003
    s_lshl_b32 s42, s55, 19
    s_or_b32 s46, s46, s42
    s_bfe_u32 s42, s44, 0x30000
    s_lshl_b32 s42, s42, 2
    s_or_b32 s42, s42, s55
    s_lshl_b32 s42, s42, 12
    s_add_u32 m0, s42, s43
    s_nop 0
    buffer_load_dwordx4 v74, s[20:23], s46 offen  lds
    s_waitcnt vmcnt(2)
    s_add_u32 s44, s44, 1
    s_bfe_u32 s46, s44, 0x10000
    s_lshl_b32 s46, s46, 10
    s_bfe_u32 s42, s44, 0x20001
    s_lshl_b32 s42, s42, 12
    s_or_b32 s46, s46, s42
    s_bfe_u32 s55, s44, 0x20003
    s_lshl_b32 s42, s55, 19
    s_or_b32 s46, s46, s42
    s_bfe_u32 s42, s44, 0x30000
    s_lshl_b32 s42, s42, 2
    s_or_b32 s42, s42, s55
    s_lshl_b32 s42, s42, 12
    s_add_u32 m0, s42, s43
    s_nop 0
    buffer_load_dwordx4 v74, s[20:23], s46 offen  lds
    s_waitcnt vmcnt(2)
    s_add_u32 s44, s44, 1
    s_bfe_u32 s46, s44, 0x10000
    s_lshl_b32 s46, s46, 10
    s_bfe_u32 s42, s44, 0x20001
    s_lshl_b32 s42, s42, 12
    s_or_b32 s46, s46, s42
    s_bfe_u32 s55, s44, 0x20003
    s_lshl_b32 s42, s55, 19
    s_or_b32 s46, s46, s42
    s_bfe_u32 s42, s44, 0x30000
    s_lshl_b32 s42, s42, 2
    s_or_b32 s42, s42, s55
    s_lshl_b32 s42, s42, 12
    s_add_u32 m0, s42, s43
    s_nop 0
    buffer_load_dwordx4 v74, s[20:23], s46 offen  lds
    s_waitcnt vmcnt(2)
    s_add_u32 s44, s44, 1
    s_bfe_u32 s46, s44, 0x10000
    s_lshl_b32 s46, s46, 10
    s_bfe_u32 s42, s44, 0x20001
    s_lshl_b32 s42, s42, 12
    s_or_b32 s46, s46, s42
    s_bfe_u32 s55, s44, 0x20003
    s_lshl_b32 s42, s55, 19
    s_or_b32 s46, s46, s42
    s_bfe_u32 s42, s44, 0x30000
    s_lshl_b32 s42, s42, 2
    s_or_b32 s42, s42, s55
    s_lshl_b32 s42, s42, 12
    s_add_u32 m0, s42, s43
    s_nop 0
    buffer_load_dwordx4 v74, s[20:23], s46 offen  lds
    s_waitcnt vmcnt(2)
    s_add_u32 s44, s44, 1
    s_bfe_u32 s46, s44, 0x10000
    s_lshl_b32 s46, s46, 10
    s_bfe_u32 s42, s44, 0x20001
    s_lshl_b32 s42, s42, 12
    s_or_b32 s46, s46, s42
    s_bfe_u32 s55, s44, 0x20003
    s_lshl_b32 s42, s55, 19
    s_or_b32 s46, s46, s42
    s_bfe_u32 s42, s44, 0x30000
    s_lshl_b32 s42, s42, 2
    s_or_b32 s42, s42, s55
    s_lshl_b32 s42, s42, 12
    s_add_u32 m0, s42, s43
    s_nop 0
    buffer_load_dwordx4 v74, s[20:23], s46 offen  lds
    s_waitcnt vmcnt(2)
    s_add_u32 s44, s44, 1
    s_bfe_u32 s46, s44, 0x10000
    s_lshl_b32 s46, s46, 10
    s_bfe_u32 s42, s44, 0x20001
    s_lshl_b32 s42, s42, 12
    s_or_b32 s46, s46, s42
    s_bfe_u32 s55, s44, 0x20003
    s_lshl_b32 s42, s55, 19
    s_or_b32 s46, s46, s42
    s_bfe_u32 s42, s44, 0x30000
    s_lshl_b32 s42, s42, 2
    s_or_b32 s42, s42, s55
    s_lshl_b32 s42, s42, 12
    s_add_u32 m0, s42, s43
    s_nop 0
    buffer_load_dwordx4 v74, s[20:23], s46 offen  lds
    s_waitcnt vmcnt(2)
    s_add_u32 s44, s44, 1
    s_bfe_u32 s46, s44, 0x10000
    s_lshl_b32 s46, s46, 10
    s_bfe_u32 s42, s44, 0x20001
    s_lshl_b32 s42, s42, 12
    s_or_b32 s46, s46, s42
    s_bfe_u32 s55, s44, 0x20003
    s_lshl_b32 s42, s55, 19
    s_or_b32 s46, s46, s42
    s_bfe_u32 s42, s44, 0x30000
    s_lshl_b32 s42, s42, 2
    s_or_b32 s42, s42, s55
    s_lshl_b32 s42, s42, 12
    s_add_u32 m0, s42, s43
    s_nop 0
    buffer_load_dwordx4 v74, s[20:23], s46 offen  lds
    s_waitcnt vmcnt(2)
    s_add_u32 s44, s44, 1
    s_bfe_u32 s46, s44, 0x10000
    s_lshl_b32 s46, s46, 10
    s_bfe_u32 s42, s44, 0x20001
    s_lshl_b32 s42, s42, 12
    s_or_b32 s46, s46, s42
    s_bfe_u32 s55, s44, 0x20003
    s_lshl_b32 s42, s55, 19
    s_or_b32 s46, s46, s42
    s_bfe_u32 s42, s44, 0x30000
    s_lshl_b32 s42, s42, 2
    s_or_b32 s42, s42, s55
    s_lshl_b32 s42, s42, 12
    s_add_u32 m0, s42, s43
    s_nop 0
    buffer_load_dwordx4 v74, s[20:23], s46 offen  lds
    s_waitcnt vmcnt(2)
    s_add_u32 s44, s44, 1
    s_bfe_u32 s46, s44, 0x10000
    s_lshl_b32 s46, s46, 10
    s_bfe_u32 s42, s44, 0x20001
    s_lshl_b32 s42, s42, 12
    s_or_b32 s46, s46, s42
    s_bfe_u32 s55, s44, 0x20003
    s_lshl_b32 s42, s55, 19
    s_or_b32 s46, s46, s42
    s_bfe_u32 s42, s44, 0x30000
    s_lshl_b32 s42, s42, 2
    s_or_b32 s42, s42, s55
    s_lshl_b32 s42, s42, 12
    s_add_u32 m0, s42, s43
    s_nop 0
    buffer_load_dwordx4 v74, s[20:23], s46 offen  lds
    s_waitcnt vmcnt(2)
    s_add_u32 s44, s44, 1
    s_bfe_u32 s46, s44, 0x10000
    s_lshl_b32 s46, s46, 10
    s_bfe_u32 s42, s44, 0x20001
    s_lshl_b32 s42, s42, 12
    s_or_b32 s46, s46, s42
    s_bfe_u32 s55, s44, 0x20003
    s_lshl_b32 s42, s55, 19
    s_or_b32 s46, s46, s42
    s_bfe_u32 s42, s44, 0x30000
    s_lshl_b32 s42, s42, 2
    s_or_b32 s42, s42, s55
    s_lshl_b32 s42, s42, 12
    s_add_u32 m0, s42, s43
    s_nop 0
    buffer_load_dwordx4 v74, s[20:23], s46 offen  lds
    s_waitcnt vmcnt(2)
    s_add_u32 s44, s44, 1
    s_bfe_u32 s46, s44, 0x10000
    s_lshl_b32 s46, s46, 10
    s_bfe_u32 s42, s44, 0x20001
    s_lshl_b32 s42, s42, 12
    s_or_b32 s46, s46, s42
    s_bfe_u32 s55, s44, 0x20003
    s_lshl_b32 s42, s55, 19
    s_or_b32 s46, s46, s42
    s_bfe_u32 s42, s44, 0x30000
    s_lshl_b32 s42, s42, 2
    s_or_b32 s42, s42, s55
    s_lshl_b32 s42, s42, 12
    s_add_u32 m0, s42, s43
    s_nop 0
    buffer_load_dwordx4 v74, s[20:23], s46 offen  lds
    s_waitcnt vmcnt(2)
    s_add_u32 s44, s44, 1
    s_bfe_u32 s46, s44, 0x10000
    s_lshl_b32 s46, s46, 10
    s_bfe_u32 s42, s44, 0x20001
    s_lshl_b32 s42, s42, 12
    s_or_b32 s46, s46, s42
    s_bfe_u32 s55, s44, 0x20003
    s_lshl_b32 s42, s55, 19
    s_or_b32 s46, s46, s42
    s_bfe_u32 s42, s44, 0x30000
    s_lshl_b32 s42, s42, 2
    s_or_b32 s42, s42, s55
    s_lshl_b32 s42, s42, 12
    s_add_u32 m0, s42, s43
    s_nop 0
    buffer_load_dwordx4 v74, s[20:23], s46 offen  lds
    s_waitcnt vmcnt(2)
    s_add_u32 s44, s44, 1
    s_bfe_u32 s46, s44, 0x10000
    s_lshl_b32 s46, s46, 10
    s_bfe_u32 s42, s44, 0x20001
    s_lshl_b32 s42, s42, 12
    s_or_b32 s46, s46, s42
    s_bfe_u32 s55, s44, 0x20003
    s_lshl_b32 s42, s55, 19
    s_or_b32 s46, s46, s42
    s_bfe_u32 s42, s44, 0x30000
    s_lshl_b32 s42, s42, 2
    s_or_b32 s42, s42, s55
    s_lshl_b32 s42, s42, 12
    s_add_u32 m0, s42, s43
    s_nop 0
    buffer_load_dwordx4 v74, s[20:23], s46 offen  lds
    s_waitcnt vmcnt(2)
    s_add_u32 s44, s44, 1
    s_bfe_u32 s46, s44, 0x10000
    s_lshl_b32 s46, s46, 10
    s_bfe_u32 s42, s44, 0x20001
    s_lshl_b32 s42, s42, 12
    s_or_b32 s46, s46, s42
    s_bfe_u32 s55, s44, 0x20003
    s_lshl_b32 s42, s55, 19
    s_or_b32 s46, s46, s42
    s_bfe_u32 s42, s44, 0x30000
    s_lshl_b32 s42, s42, 2
    s_or_b32 s42, s42, s55
    s_lshl_b32 s42, s42, 12
    s_add_u32 m0, s42, s43
    s_nop 0
    buffer_load_dwordx4 v74, s[20:23], s46 offen  lds
    s_lshl_b32 s42, s3, 2
    v_mov_b32 v73, s42
    v_mov_b32 v75, 1
    s_waitcnt vmcnt(0)
    ds_write_b32 v73, v75 offset:31296
    s_cmp_eq_u32 s3, 0
    s_cselect_b64 vcc, -1, 0
    s_add_u32 s57, s53, 0x2000
    s_add_u32 s46, s40, 0
    s_and_b32 s46, s46, 15
    s_lshl_b32 s46, s46, 17
    buffer_load_dwordx4 v[128:131], v1, s[28:31], s46 offen offset:0
    s_cbranch_vccz L_el1
    buffer_load_dword v111, v112, s[36:39], s64 offen sc1
L_el1:
    buffer_load_dwordx4 v[192:195], v1, s[28:31], s46 offen offset:1024
    s_add_u32 s46, s40, 1
    s_and_b32 s46, s46, 15
    s_lshl_b32 s46, s46, 17
    buffer_load_dwordx4 v[132:135], v1, s[28:31], s46 offen offset:0
    s_waitcnt vmcnt(2)
    buffer_load_dwordx4 v[196:199], v1, s[28:31], s46 offen offset:1024
    s_waitcnt vmcnt(2)
    s_add_u32 s46, s40, 2
    s_and_b32 s46, s46, 15
    s_lshl_b32 s46, s46, 17
    buffer_load_dwordx4 v[136:139], v1, s[28:31], s46 offen offset:0
    s_cbranch_vccz L_el5
    buffer_load_dwordx2 v[94:95], v110, s[36:39], s53 offen sc1
L_el5:
    s_waitcnt vmcnt(2)
    buffer_load_dwordx4 v[200:203], v1, s[28:31], s46 offen offset:1024
    s_waitcnt vmcnt(2)
    s_add_u32 s46, s40, 3
    s_and_b32 s46, s46, 15
    s_lshl_b32 s46, s46, 17
    buffer_load_dwordx4 v[140:143], v1, s[28:31], s46 offen offset:0
    s_waitcnt vmcnt(2)
    buffer_load_dwordx4 v[204:207], v1, s[28:31], s46 offen offset:1024
    s_waitcnt vmcnt(2)
    s_add_u32 s46, s40, 4
    s_and_b32 s46, s46, 15
    s_lshl_b32 s46, s46, 17
    buffer_load_dwordx4 v[144:147], v1, s[28:31], s46 offen offset:0
    s_cbranch_vccz L_el9
    buffer_load_dwordx2 v[96:97], v110, s[36:39], s57 offen sc1
L_el9:
    s_waitcnt vmcnt(2)
    buffer_load_dwordx4 v[208:211], v1, s[28:31], s46 offen offset:1024
    s_waitcnt vmcnt(2)
    s_add_u32 s46, s40, 5
    s_and_b32 s46, s46, 15
    s_lshl_b32 s46, s46, 17
    buffer_load_dwordx4 v[148:151], v1, s[28:31], s46 offen offset:0
    s_waitcnt vmcnt(2)
    buffer_load_dwordx4 v[212:215], v1, s[28:31], s46 offen offset:1024
    s_waitcnt vmcnt(2)
    s_add_u32 s46, s40, 6
    s_and_b32 s46, s46, 15
    s_lshl_b32 s46, s46, 17
    buffer_load_dwordx4 v[152:155], v1, s[28:31], s46 offen offset:0
    s_cbranch_vccz L_el13
    buffer_load_dwordx2 v[98:99], v7, s[36:39], s52 offen offset:0 sc1
L_el13:
    s_waitcnt vmcnt(2)
    buffer_load_dwordx4 v[216:219], v1, s[28:31], s46 offen offset:1024
    s_waitcnt vmcnt(2)
    s_add_u32 s46, s40, 7
    s_and_b32 s46, s46, 15
    s_lshl_b32 s46, s46, 17
    buffer_load_dwordx4 v[156:159], v1, s[28:31], s46 offen offset:0
    s_waitcnt vmcnt(2)
    buffer_load_dwordx4 v[220:223], v1, s[28:31], s46 offen offset:1024
    s_waitcnt vmcnt(2)
    s_add_u32 s46, s40, 8
    s_and_b32 s46, s46, 15
    s_lshl_b32 s46, s46, 17
    buffer_load_dwordx4 v[160:163], v1, s[28:31], s46 offen offset:0
    s_cbranch_vccz L_el17
    buffer_load_dwordx2 v[100:101], v7, s[36:39], s52 offen offset:512 sc1
L_el17:
    s_waitcnt vmcnt(2)
    buffer_load_dwordx4 v[224:227], v1, s[28:31], s46 offen offset:1024
    s_waitcnt vmcnt(2)
    s_add_u32 s46, s40, 9
    s_and_b32 s46, s46, 15
    s_lshl_b32 s46, s46, 17
    buffer_load_dwordx4 v[164:167], v1, s[28:31], s46 offen offset:0
    s_waitcnt vmcnt(2)
    buffer_load_dwordx4 v[228:231], v1, s[28:31], s46 offen offset:1024
    s_waitcnt vmcnt(2)
    s_add_u32 s46, s40, 10
    s_and_b32 s46, s46, 15
    s_lshl_b32 s46, s46, 17
    buffer_load_dwordx4 v[168:171], v1, s[28:31], s46 offen offset:0
    s_cbranch_vccz L_el21
    buffer_load_dwordx4 v[116:119], v107, s[36:39], s62 offen sc1
L_el21:
    s_waitcnt vmcnt(2)
    buffer_load_dwordx4 v[232:235], v1, s[28:31], s46 offen offset:1024
    s_waitcnt vmcnt(2)
    s_add_u32 s46, s40, 11
    s_and_b32 s46, s46, 15
    s_lshl_b32 s46, s46, 17
    buffer_load_dwordx4 v[172:175], v1, s[28:31], s46 offen offset:0
    s_waitcnt vmcnt(2)
    buffer_load_dwordx4 v[236:239], v1, s[28:31], s46 offen offset:1024
    s_waitcnt vmcnt(2)
    s_add_u32 s46, s40, 12
    s_and_b32 s46, s46, 15
    s_lshl_b32 s46, s46, 17
    buffer_load_dwordx4 v[176:179], v1, s[28:31], s46 offen offset:0
    s_cbranch_vccz L_el25
    buffer_load_dwordx4 v[120:123], v107, s[36:39], s63 offen sc1
L_el25:
    s_waitcnt vmcnt(2)
    buffer_load_dwordx4 v[240:243], v1, s[28:31], s46 offen offset:1024
    s_waitcnt vmcnt(2)
    s_add_u32 s46, s40, 13
    s_and_b32 s46, s46, 15
    s_lshl_b32 s46, s46, 17
    buffer_load_dwordx4 v[180:183], v1, s[28:31], s46 offen offset:0
    s_waitcnt vmcnt(2)
    buffer_load_dwordx4 v[244:247], v1, s[28:31], s46 offen offset:1024
    s_waitcnt vmcnt(2)
    s_add_u32 s46, s40, 14
    s_and_b32 s46, s46, 15
    s_lshl_b32 s46, s46, 17
    buffer_load_dwordx4 v[184:187], v1, s[28:31], s46 offen offset:0
    buffer_load_dwordx2 v[92:93], v110, s[36:39], s32 offen sc1
    s_waitcnt vmcnt(2)
    buffer_load_dwordx4 v[248:251], v1, s[28:31], s46 offen offset:1024
    s_waitcnt vmcnt(2)
    s_add_u32 s46, s40, 15
    s_and_b32 s46, s46, 15
    s_lshl_b32 s46, s46, 17
    buffer_load_dwordx4 v[188:191], v1, s[28:31], s46 offen offset:0
    s_waitcnt vmcnt(2)
    buffer_load_dwordx4 v[252:255], v1, s[28:31], s46 offen offset:1024
    s_cmp_lg_u32 s3, 0
    s_cbranch_scc1 L_init
L_ispin:
    s_mov_b64 exec, 1
    global_load_dwordx2 v[72:73], v2, s[16:17] sc1
    s_mov_b64 exec, -1
    s_waitcnt vmcnt(0)
    v_and_b32 v72, v72, v73
    s_nop 0
    v_readfirstlane_b32 s55, v72
    s_nop 1
    s_cmp_lg_u32 s55, 0
    s_cbranch_scc1 L_init0
    s_sleep 32
    s_branch L_ispin
L_init0:
    v_not_b32 v94, v94
    v_not_b32 v95, v95
    v_not_b32 v96, v96
    v_not_b32 v97, v97
    v_alignbit_b32 v103, v116, v2, 1
    v_alignbit_b32 v103, v117, v103, 1
    v_alignbit_b32 v103, v118, v103, 1
    v_alignbit_b32 v103, v119, v103, 1
    v_alignbit_b32 v103, v120, v103, 1
    v_alignbit_b32 v103, v121, v103, 1
    v_alignbit_b32 v103, v122, v103, 1
    v_alignbit_b32 v103, v123, v103, 1
L_h1:
    s_sleep 1
    ds_read_b32 v72, v2 offset:31264
    s_waitcnt lgkmcnt(0)
    v_readfirstlane_b32 s55, v72
    s_nop 1
    s_cmp_eq_u32 s55, 0
    s_cbranch_scc1 L_h1
L_init:
    s_waitcnt vmcnt(0) lgkmcnt(0)
    v_not_b32 v92, v92
    v_not_b32 v93, v93
    s_cmp_lg_u32 s3, 0
    s_cbranch_scc1 L_oth0
L_sidle0:
    s_sleep 16
    ds_read_b32 v72, v2 offset:31268
    s_waitcnt lgkmcnt(0)
    v_readfirstlane_b32 s69, v72
    s_nop 1
    s_cmp_lt_u32 s69, 26
    s_cbranch_scc1 L_sidle0
L_sspin0:
    s_sleep 4
    s_mov_b32 exec_lo, 0xffff
    s_mov_b32 exec_hi, 0
    buffer_load_dword v124, v112, s[36:39], s64 offen sc1
    s_mov_b64 exec, -1
    ds_read_b32 v125, v2 offset:31268
    s_waitcnt vmcnt(0) lgkmcnt(0)
    v_xor_b32 v124, v124, v111
    v_and_b32 v124, 1, v124
    v_cmp_eq_u32 s[70:71], 1, v124
    v_readfirstlane_b32 s69, v125
    s_nop 0
    s_bfe_u32 s65, s70, 0x100000
    s_bcnt1_i32_b32 s65, s65
    s_cmp_lt_u32 s65, 6
    s_cbranch_scc1 L_cb0
    s_mov_b32 s67, 0x2302
    v_mov_b32 v125, s67
    ds_write_b32 v2, v125 offset:31272
L_cb0:
    ds_read_b64 v[72:73], v7 offset:18432
    ds_read_b64 v[74:75], v7 offset:18944
    ds_read_b64 v[76:77], v7 offset:19456
    ds_read_b64 v[78:79], v7 offset:19968
    s_waitcnt lgkmcnt(0)
    v_max3_u32 v16, v72, v73, v74
    v_max3_u32 v17, v75, v76, v77
    v_max3_u32 v16, v16, v78, v79
    v_max_u32 v16, v16, v17
    v_cmp_eq_u32 vcc, -1, v16
    s_nop 4
    s_cbranch_vccnz L_sspin0
    v_add_f32 v72, v72, v74
    v_add_f32 v73, v73, v75
    v_add_f32 v72, v72, v76
    v_add_f32 v73, v73, v77
    v_add_f32 v72, v72, v78
    v_add_f32 v73, v73, v79
    v_bfi_b32 v72, 1, v94, v72
    v_bfi_b32 v73, 1, v95, v73
    buffer_store_dwordx2 v[72:73], v110, s[36:39], s53 offen sc1
    v_not_b32 v124, v111
    s_add_u32 s42, s41, 0
    s_lshl_b64 exec, 1, s42
    buffer_store_dword v124, v112, s[36:39], s64 offen sc1
    s_mov_b64 exec, -1
    s_cmp_lt_u32 s65, 11
    s_cbranch_scc1 L_cp0
    s_mov_b32 s67, 0x3a02
    v_mov_b32 v125, s67
    ds_write_b32 v2, v125 offset:31272
L_cp0:
    s_cmp_ge_u32 s65, 8
    s_cbranch_scc1 L_ca00
    s_max_u32 s69, s69, 34
    s_sub_u32 s42, s69, 33
    s_mul_i32 s42, s42, 10
    s_add_u32 s42, s42, s69
    s_lshl_b32 s67, s42, 8
    s_or_b32 s67, s67, 1
    v_mov_b32 v125, s67
    ds_write_b32 v2, v125 offset:31272
L_ca00:
L_spin0:
    s_cmp_ge_u32 s65, 8
    s_cbranch_scc1 L_slow0
    s_sleep 8
    s_mov_b32 exec_lo, 0xffff
    s_mov_b32 exec_hi, 0
    buffer_load_dword v124, v112, s[36:39], s64 offen sc1
    s_mov_b64 exec, -1
    ds_read_b32 v125, v2 offset:31268
    s_waitcnt vmcnt(0) lgkmcnt(0)
    v_xor_b32 v124, v124, v111
    v_and_b32 v124, 1, v124
    v_cmp_eq_u32 s[70:71], 1, v124
    v_readfirstlane_b32 s69, v125
    s_nop 0
    s_bfe_u32 s65, s70, 0x100000
    s_bcnt1_i32_b32 s65, s65
    s_cmp_ge_u32 s65, 8
    s_cbranch_scc1 L_ca0
    s_max_u32 s69, s69, 34
    s_sub_u32 s42, s69, 33
    s_mul_i32 s42, s42, 10
    s_add_u32 s42, s42, s69
    s_lshl_b32 s67, s42, 8
    s_or_b32 s67, s67, 1
    v_mov_b32 v125, s67
    ds_write_b32 v2, v125 offset:31272
L_ca0:
    s_branch L_mb0
L_slow0:
    s_sleep 32
L_mb0:
    buffer_load_dwordx2 v[16:17], v7, s[36:39], s52 offen offset:0 sc1
    s_waitcnt vmcnt(0)
    v_xor_b32 v72, v16, v98
    v_xor_b32 v73, v17, v99
    v_and_b32 v72, v72, v73
    v_and_b32 v72, 1, v72
    v_cmp_eq_u32 vcc, 0, v72
    v_and_b32 v16, -2, v16
    v_and_b32 v17, -2, v17
    s_nop 2
    s_cbranch_vccnz L_spin0
    v_cvt_pk_bf16_f32 v16, v16, v17
    v_min_u32 v16, -2, v16
    ds_write_b32 v108, v16 offset:30720
    s_branch L_lrd0
L_oth0:
    s_cmp_lg_u32 s34, 0
    s_cbranch_scc1 L_lspin0
L_gwait0:
    s_sleep 8
    ds_read_b32 v72, v2 offset:18688
    s_waitcnt lgkmcnt(0)
    v_readfirstlane_b32 s55, v72
    s_nop 1
    s_cmp_eq_u32 s55, -1
    s_cbranch_scc1 L_gwait0
L_gspin0:
    s_sleep 24
    buffer_load_dword v72, v15, s[36:39], s47 offen sc1
    s_waitcnt vmcnt(0)
    v_alignbit_b32 v72, v72, v2, 1
    v_xor_b32 v72, v72, v105
    v_cmp_ne_u32 vcc, 0x80000000, v72
    s_nop 4
    s_cbranch_vccnz L_gspin0
L_gfull0:
    buffer_load_dwordx4 v[16:19], v109, s[36:39], s47 offen offset:0 sc1
    buffer_load_dwordx4 v[20:23], v109, s[36:39], s47 offen offset:2048 sc1
    buffer_load_dwordx4 v[24:27], v109, s[36:39], s33 offen offset:0 sc1
    buffer_load_dwordx4 v[28:31], v109, s[36:39], s33 offen offset:2048 sc1
    s_waitcnt vmcnt(0)
    v_alignbit_b32 v72, v16, v2, 1
    v_alignbit_b32 v72, v17, v72, 1
    v_alignbit_b32 v72, v18, v72, 1
    v_alignbit_b32 v72, v19, v72, 1
    v_alignbit_b32 v72, v20, v72, 1
    v_alignbit_b32 v72, v21, v72, 1
    v_alignbit_b32 v72, v22, v72, 1
    v_alignbit_b32 v72, v23, v72, 1
    v_alignbit_b32 v72, v24, v72, 1
    v_alignbit_b32 v72, v25, v72, 1
    v_alignbit_b32 v72, v26, v72, 1
    v_alignbit_b32 v72, v27, v72, 1
    v_alignbit_b32 v72, v28, v72, 1
    v_alignbit_b32 v72, v29, v72, 1
    v_alignbit_b32 v72, v30, v72, 1
    v_alignbit_b32 v72, v31, v72, 1
    v_xor_b32 v72, v72, v104
    v_cmp_ne_u32 vcc, 0xffff0000, v72
    s_nop 4
    s_cbranch_vccnz L_gfull0
    v_and_b32 v16, -2, v16
    v_and_b32 v17, -2, v17
    v_and_b32 v18, -2, v18
    v_and_b32 v19, -2, v19
    v_and_b32 v20, -2, v20
    v_and_b32 v21, -2, v21
    v_and_b32 v22, -2, v22
    v_and_b32 v23, -2, v23
    v_and_b32 v24, -2, v24
    v_and_b32 v25, -2, v25
    v_and_b32 v26, -2, v26
    v_and_b32 v27, -2, v27
    v_and_b32 v28, -2, v28
    v_and_b32 v29, -2, v29
    v_and_b32 v30, -2, v30
    v_and_b32 v31, -2, v31
    v_add_f32 v16, v16, v20
    v_add_f32 v17, v17, v21
    v_add_f32 v18, v18, v22
    v_add_f32 v19, v19, v23
    v_add_f32 v16, v16, v24
    v_add_f32 v17, v17, v25
    v_add_f32 v18, v18, v26
    v_add_f32 v19, v19, v27
    v_add_f32 v16, v16, v28
    v_add_f32 v17, v17, v29
    v_add_f32 v18, v18, v30
    v_add_f32 v19, v19, v31
    v_permlane16_swap_b32 v16, v17
    s_nop 0
    v_permlane16_swap_b32 v18, v19
    v_add_f32 v16, v16, v17
    v_add_f32 v18, v18, v19
    s_nop 1
    v_permlane32_swap_b32 v16, v18
    v_add_f32 v16, v16, v18
    s_nop 1
    v_max_f32_dpp v21, v16, v16 row_ror:8 row_mask:0xf bank_mask:0xf
    s_nop 1
    v_max_f32_dpp v21, v21, v21 row_ror:4 row_mask:0xf bank_mask:0xf
    s_nop 1
    v_max_f32_dpp v21, v21, v21 row_ror:2 row_mask:0xf bank_mask:0xf
    s_nop 1
    v_max_f32_dpp v21, v21, v21 row_ror:1 row_mask:0xf bank_mask:0xf
    v_mov_b32 v22, v21
    s_nop 1
    v_permlane16_swap_b32 v21, v22
    v_max_f32 v21, v21, v22
    v_mov_b32 v22, v21
    s_nop 1
    v_permlane32_swap_b32 v21, v22
    v_max_f32 v21, v21, v22
    v_mul_f32 v21, s54, v21
    v_fma_f32 v16, v16, s54, -v21
    v_exp_f32 v16, v16
    s_nop 1
    v_add_f32_dpp v21, v16, v16 row_ror:8 row_mask:0xf bank_mask:0xf
    s_nop 1
    v_add_f32_dpp v21, v21, v21 row_ror:4 row_mask:0xf bank_mask:0xf
    s_nop 1
    v_add_f32_dpp v21, v21, v21 row_ror:2 row_mask:0xf bank_mask:0xf
    s_nop 1
    v_add_f32_dpp v21, v21, v21 row_ror:1 row_mask:0xf bank_mask:0xf
    v_mov_b32 v22, v21
    s_nop 1
    v_permlane16_swap_b32 v21, v22
    v_add_f32 v21, v21, v22
    v_mov_b32 v22, v21
    s_nop 1
    v_permlane32_swap_b32 v21, v22
    v_add_f32 v21, v21, v22
    v_rcp_f32 v21, v21
    s_nop 0
    v_mul_f32 v16, v16, v21
    v_bfi_b32 v16, 1, v102, v16
    buffer_store_dword v16, v6, s[36:39], s35 offen sc1
L_lspin0:
    s_sleep 8
L_lrd0:
    ds_read_b128 v[48:51], v8 offset:30720
    ds_read_b128 v[52:55], v8 offset:30736
    s_waitcnt lgkmcnt(0)
    v_max3_u32 v72, v48, v49, v50
    v_max3_u32 v73, v51, v52, v53
    v_max3_u32 v72, v72, v54, v55
    v_max_u32 v72, v72, v73
    v_cmp_eq_u32 vcc, -1, v72
    s_nop 4
    s_cbranch_vccnz L_lspin0
L_w0:
    v_perm_b32 v56, v48, v48, v84
    v_perm_b32 v57, v48, v48, v85
    v_perm_b32 v58, v48, v48, v86
    v_perm_b32 v59, v48, v48, v87
    v_perm_b32 v60, v48, v48, v88
    v_perm_b32 v61, v48, v48, v89
    v_perm_b32 v62, v48, v48, v90
    v_perm_b32 v63, v48, v48, v91
    v_mfma_f32_16x16x32_bf16 v[64:67], v[56:59], v[128:131], 0
    v_mfma_f32_16x16x32_bf16 v[68:71], v[56:59], v[192:195], 0
    v_perm_b32 v56, v49, v49, v84
    v_perm_b32 v57, v49, v49, v85
    v_perm_b32 v58, v49, v49, v86
    v_perm_b32 v59, v49, v49, v87
    v_mfma_f32_16x16x32_bf16 v[64:67], v[60:63], v[132:135], v[64:67]
    v_mfma_f32_16x16x32_bf16 v[68:71], v[60:63], v[196:199], v[68:71]
    v_perm_b32 v60, v49, v49, v88
    v_perm_b32 v61, v49, v49, v89
    v_perm_b32 v62, v49, v49, v90
    v_perm_b32 v63, v49, v49, v91
    v_mfma_f32_16x16x32_bf16 v[64:67], v[56:59], v[136:139], v[64:67]
    v_mfma_f32_16x16x32_bf16 v[68:71], v[56:59], v[200:203], v[68:71]
    v_perm_b32 v56, v50, v50, v84
    v_perm_b32 v57, v50, v50, v85
    v_perm_b32 v58, v50, v50, v86
    v_perm_b32 v59, v50, v50, v87
    v_mfma_f32_16x16x32_bf16 v[64:67], v[60:63], v[140:143], v[64:67]
    v_mfma_f32_16x16x32_bf16 v[68:71], v[60:63], v[204:207], v[68:71]
    v_perm_b32 v60, v50, v50, v88
    v_perm_b32 v61, v50, v50, v89
    v_perm_b32 v62, v50, v50, v90
    v_perm_b32 v63, v50, v50, v91
    v_mfma_f32_16x16x32_bf16 v[64:67], v[56:59], v[144:147], v[64:67]
    v_mfma_f32_16x16x32_bf16 v[68:71], v[56:59], v[208:211], v[68:71]
    v_perm_b32 v56, v51, v51, v84
    v_perm_b32 v57, v51, v51, v85
    v_perm_b32 v58, v51, v51, v86
    v_perm_b32 v59, v51, v51, v87
    v_mfma_f32_16x16x32_bf16 v[64:67], v[60:63], v[148:151], v[64:67]
    v_mfma_f32_16x16x32_bf16 v[68:71], v[60:63], v[212:215], v[68:71]
    v_perm_b32 v60, v51, v51, v88
    v_perm_b32 v61, v51, v51, v89
    v_perm_b32 v62, v51, v51, v90
    v_perm_b32 v63, v51, v51, v91
    v_mfma_f32_16x16x32_bf16 v[64:67], v[56:59], v[152:155], v[64:67]
    v_mfma_f32_16x16x32_bf16 v[68:71], v[56:59], v[216:219], v[68:71]
    v_perm_b32 v56, v52, v52, v84
    v_perm_b32 v57, v52, v52, v85
    v_perm_b32 v58, v52, v52, v86
    v_perm_b32 v59, v52, v52, v87
    v_mfma_f32_16x16x32_bf16 v[64:67], v[60:63], v[156:159], v[64:67]
    v_mfma_f32_16x16x32_bf16 v[68:71], v[60:63], v[220:223], v[68:71]
    v_perm_b32 v60, v52, v52, v88
    v_perm_b32 v61, v52, v52, v89
    v_perm_b32 v62, v52, v52, v90
    v_perm_b32 v63, v52, v52, v91
    v_mfma_f32_16x16x32_bf16 v[64:67], v[56:59], v[160:163], v[64:67]
    v_mfma_f32_16x16x32_bf16 v[68:71], v[56:59], v[224:227], v[68:71]
    v_perm_b32 v56, v53, v53, v84
    v_perm_b32 v57, v53, v53, v85
    v_perm_b32 v58, v53, v53, v86
    v_perm_b32 v59, v53, v53, v87
    v_mfma_f32_16x16x32_bf16 v[64:67], v[60:63], v[164:167], v[64:67]
    v_mfma_f32_16x16x32_bf16 v[68:71], v[60:63], v[228:231], v[68:71]
    v_perm_b32 v60, v53, v53, v88
    v_perm_b32 v61, v53, v53, v89
    v_perm_b32 v62, v53, v53, v90
    v_perm_b32 v63, v53, v53, v91
    v_mfma_f32_16x16x32_bf16 v[64:67], v[56:59], v[168:171], v[64:67]
    v_mfma_f32_16x16x32_bf16 v[68:71], v[56:59], v[232:235], v[68:71]
    v_perm_b32 v56, v54, v54, v84
    v_perm_b32 v57, v54, v54, v85
    v_perm_b32 v58, v54, v54, v86
    v_perm_b32 v59, v54, v54, v87
    v_mfma_f32_16x16x32_bf16 v[64:67], v[60:63], v[172:175], v[64:67]
    v_mfma_f32_16x16x32_bf16 v[68:71], v[60:63], v[236:239], v[68:71]
    v_perm_b32 v60, v54, v54, v88
    v_perm_b32 v61, v54, v54, v89
    v_perm_b32 v62, v54, v54, v90
    v_perm_b32 v63, v54, v54, v91
    v_mfma_f32_16x16x32_bf16 v[64:67], v[56:59], v[176:179], v[64:67]
    v_mfma_f32_16x16x32_bf16 v[68:71], v[56:59], v[240:243], v[68:71]
    v_perm_b32 v56, v55, v55, v84
    v_perm_b32 v57, v55, v55, v85
    v_perm_b32 v58, v55, v55, v86
    v_perm_b32 v59, v55, v55, v87
    v_mfma_f32_16x16x32_bf16 v[64:67], v[60:63], v[180:183], v[64:67]
    v_mfma_f32_16x16x32_bf16 v[68:71], v[60:63], v[244:247], v[68:71]
    v_perm_b32 v60, v55, v55, v88
    v_perm_b32 v61, v55, v55, v89
    v_perm_b32 v62, v55, v55, v90
    v_perm_b32 v63, v55, v55, v91
    v_mfma_f32_16x16x32_bf16 v[64:67], v[56:59], v[184:187], v[64:67]
    v_mfma_f32_16x16x32_bf16 v[68:71], v[56:59], v[248:251], v[68:71]
    v_mfma_f32_16x16x32_bf16 v[64:67], v[60:63], v[188:191], v[64:67]
    v_mfma_f32_16x16x32_bf16 v[68:71], v[60:63], v[252:255], v[68:71]
    s_nop 6
    v_cvt_pk_bf16_f32 v16, v64, v65
    v_cvt_pk_bf16_f32 v17, v66, v67
    v_lshlrev_b32 v20, 16, v16
    v_and_b32 v21, 0xffff0000, v16
    v_lshlrev_b32 v22, 16, v17
    v_and_b32 v23, 0xffff0000, v17
    v_sub_f32 v20, v64, v20
    v_sub_f32 v21, v65, v21
    v_sub_f32 v22, v66, v22
    v_sub_f32 v23, v67, v23
    v_cvt_pk_bf16_f32 v18, v20, v21
    v_cvt_pk_bf16_f32 v19, v22, v23
    ds_write_b64 v5, v[16:17] offset:0
    ds_write_b64 v5, v[18:19] offset:576
    v_cvt_pk_bf16_f32 v24, v68, v69
    v_cvt_pk_bf16_f32 v25, v70, v71
    v_lshlrev_b32 v28, 16, v24
    v_and_b32 v29, 0xffff0000, v24
    v_lshlrev_b32 v30, 16, v25
    v_and_b32 v31, 0xffff0000, v25
    v_sub_f32 v28, v68, v28
    v_sub_f32 v29, v69, v29
    v_sub_f32 v30, v70, v30
    v_sub_f32 v31, v71, v31
    v_cvt_pk_bf16_f32 v26, v28, v29
    v_cvt_pk_bf16_f32 v27, v30, v31
    ds_write_b64 v5, v[24:25] offset:64
    ds_write_b64 v5, v[26:27] offset:640
    s_waitcnt lgkmcnt(0)
    s_lshl_b32 s42, s3, 2
    v_mov_b32 v72, s42
    v_mov_b32 v73, 1
    ds_write_b32 v72, v73 offset:31232
    s_cmp_lg_u32 s3, 0
    s_cbranch_scc1 L_oth1
    s_add_u32 s53, s53, 0x2000
L_sidle1:
    s_sleep 16
    ds_read_b32 v72, v2 offset:31268
    s_waitcnt lgkmcnt(0)
    v_readfirstlane_b32 s69, v72
    s_nop 1
    s_cmp_lt_u32 s69, 58
    s_cbranch_scc1 L_sidle1
L_sspin1:
    s_sleep 4
    s_mov_b32 exec_lo, 0xffff0000
    s_mov_b32 exec_hi, 0
    buffer_load_dword v124, v112, s[36:39], s64 offen sc1
    s_mov_b64 exec, -1
    ds_read_b32 v125, v2 offset:31268
    s_waitcnt vmcnt(0) lgkmcnt(0)
    v_xor_b32 v124, v124, v111
    v_and_b32 v124, 1, v124
    v_cmp_eq_u32 s[70:71], 1, v124
    v_readfirstlane_b32 s69, v125
    s_nop 0
    s_bfe_u32 s65, s70, 0x100010
    s_bcnt1_i32_b32 s65, s65
    s_cmp_lt_u32 s65, 6
    s_cbranch_scc1 L_cb1
    s_mov_b32 s67, 0x4302
    v_mov_b32 v125, s67
    ds_write_b32 v2, v125 offset:31272
L_cb1:
    ds_read_b64 v[72:73], v7 offset:20480
    ds_read_b64 v[74:75], v7 offset:20992
    ds_read_b64 v[76:77], v7 offset:21504
    ds_read_b64 v[78:79], v7 offset:22016
    s_waitcnt lgkmcnt(0)
    v_max3_u32 v16, v72, v73, v74
    v_max3_u32 v17, v75, v76, v77
    v_max3_u32 v16, v16, v78, v79
    v_max_u32 v16, v16, v17
    v_cmp_eq_u32 vcc, -1, v16
    s_nop 4
    s_cbranch_vccnz L_sspin1
    v_add_f32 v72, v72, v74
    v_add_f32 v73, v73, v75
    v_add_f32 v72, v72, v76
    v_add_f32 v73, v73, v77
    v_add_f32 v72, v72, v78
    v_add_f32 v73, v73, v79
    v_bfi_b32 v72, 1, v96, v72
    v_bfi_b32 v73, 1, v97, v73
    buffer_store_dwordx2 v[72:73], v110, s[36:39], s53 offen sc1
    v_not_b32 v124, v111
    s_add_u32 s42, s41, 16
    s_lshl_b64 exec, 1, s42
    buffer_store_dword v124, v112, s[36:39], s64 offen sc1
    s_mov_b64 exec, -1
    s_cmp_lt_u32 s65, 11
    s_cbranch_scc1 L_cp1
    s_mov_b32 s67, 0x5a02
    v_mov_b32 v125, s67
    ds_write_b32 v2, v125 offset:31272
L_cp1:
    s_cmp_ge_u32 s65, 8
    s_cbranch_scc1 L_ca01
    s_max_u32 s69, s69, 66
    s_sub_u32 s42, s69, 65
    s_mul_i32 s42, s42, 10
    s_add_u32 s42, s42, s69
    s_lshl_b32 s67, s42, 8
    s_or_b32 s67, s67, 1
    v_mov_b32 v125, s67
    ds_write_b32 v2, v125 offset:31272
L_ca01:
L_spin1:
    s_cmp_ge_u32 s65, 8
    s_cbranch_scc1 L_slow1
    s_sleep 8
    s_mov_b32 exec_lo, 0xffff0000
    s_mov_b32 exec_hi, 0
    buffer_load_dword v124, v112, s[36:39], s64 offen sc1
    s_mov_b64 exec, -1
    ds_read_b32 v125, v2 offset:31268
    s_waitcnt vmcnt(0) lgkmcnt(0)
    v_xor_b32 v124, v124, v111
    v_and_b32 v124, 1, v124
    v_cmp_eq_u32 s[70:71], 1, v124
    v_readfirstlane_b32 s69, v125
    s_nop 0
    s_bfe_u32 s65, s70, 0x100010
    s_bcnt1_i32_b32 s65, s65
    s_cmp_ge_u32 s65, 8
    s_cbranch_scc1 L_ca1
    s_max_u32 s69, s69, 66
    s_sub_u32 s42, s69, 65
    s_mul_i32 s42, s42, 10
    s_add_u32 s42, s42, s69
    s_lshl_b32 s67, s42, 8
    s_or_b32 s67, s67, 1
    v_mov_b32 v125, s67
    ds_write_b32 v2, v125 offset:31272
L_ca1:
    s_branch L_mb1
L_slow1:
    s_sleep 32
L_mb1:
    buffer_load_dwordx2 v[16:17], v7, s[36:39], s52 offen offset:512 sc1
    s_waitcnt vmcnt(0)
    v_xor_b32 v72, v16, v100
    v_xor_b32 v73, v17, v101
    v_and_b32 v72, v72, v73
    v_and_b32 v72, 1, v72
    v_cmp_eq_u32 vcc, 0, v72
    v_and_b32 v16, -2, v16
    v_and_b32 v17, -2, v17
    s_nop 2
    s_cbranch_vccnz L_spin1
    v_cvt_pk_bf16_f32 v16, v16, v17
    v_min_u32 v16, -2, v16
    ds_write_b32 v108, v16 offset:30976
    s_branch L_lrd1
L_oth1:
    s_cmp_lg_u32 s34, 1
    s_cbranch_scc1 L_lspin1
L_gwait1:
    s_sleep 8
    ds_read_b32 v72, v2 offset:20736
    s_waitcnt lgkmcnt(0)
    v_readfirstlane_b32 s55, v72
    s_nop 1
    s_cmp_eq_u32 s55, -1
    s_cbranch_scc1 L_gwait1
L_gspin1:
    s_sleep 24
    buffer_load_dword v72, v15, s[36:39], s47 offen sc1
    s_waitcnt vmcnt(0)
    v_alignbit_b32 v72, v72, v2, 1
    v_xor_b32 v72, v72, v105
    v_cmp_ne_u32 vcc, 0x80000000, v72
    s_nop 4
    s_cbranch_vccnz L_gspin1
L_gfull1:
    buffer_load_dwordx4 v[16:19], v109, s[36:39], s47 offen offset:0 sc1
    buffer_load_dwordx4 v[20:23], v109, s[36:39], s47 offen offset:2048 sc1
    buffer_load_dwordx4 v[24:27], v109, s[36:39], s33 offen offset:0 sc1
    buffer_load_dwordx4 v[28:31], v109, s[36:39], s33 offen offset:2048 sc1
    s_waitcnt vmcnt(0)
    v_alignbit_b32 v72, v16, v2, 1
    v_alignbit_b32 v72, v17, v72, 1
    v_alignbit_b32 v72, v18, v72, 1
    v_alignbit_b32 v72, v19, v72, 1
    v_alignbit_b32 v72, v20, v72, 1
    v_alignbit_b32 v72, v21, v72, 1
    v_alignbit_b32 v72, v22, v72, 1
    v_alignbit_b32 v72, v23, v72, 1
    v_alignbit_b32 v72, v24, v72, 1
    v_alignbit_b32 v72, v25, v72, 1
    v_alignbit_b32 v72, v26, v72, 1
    v_alignbit_b32 v72, v27, v72, 1
    v_alignbit_b32 v72, v28, v72, 1
    v_alignbit_b32 v72, v29, v72, 1
    v_alignbit_b32 v72, v30, v72, 1
    v_alignbit_b32 v72, v31, v72, 1
    v_xor_b32 v72, v72, v104
    v_cmp_ne_u32 vcc, 0xffff0000, v72
    s_nop 4
    s_cbranch_vccnz L_gfull1
    v_and_b32 v16, -2, v16
    v_and_b32 v17, -2, v17
    v_and_b32 v18, -2, v18
    v_and_b32 v19, -2, v19
    v_and_b32 v20, -2, v20
    v_and_b32 v21, -2, v21
    v_and_b32 v22, -2, v22
    v_and_b32 v23, -2, v23
    v_and_b32 v24, -2, v24
    v_and_b32 v25, -2, v25
    v_and_b32 v26, -2, v26
    v_and_b32 v27, -2, v27
    v_and_b32 v28, -2, v28
    v_and_b32 v29, -2, v29
    v_and_b32 v30, -2, v30
    v_and_b32 v31, -2, v31
    v_add_f32 v16, v16, v20
    v_add_f32 v17, v17, v21
    v_add_f32 v18, v18, v22
    v_add_f32 v19, v19, v23
    v_add_f32 v16, v16, v24
    v_add_f32 v17, v17, v25
    v_add_f32 v18, v18, v26
    v_add_f32 v19, v19, v27
    v_add_f32 v16, v16, v28
    v_add_f32 v17, v17, v29
    v_add_f32 v18, v18, v30
    v_add_f32 v19, v19, v31
    v_permlane16_swap_b32 v16, v17
    s_nop 0
    v_permlane16_swap_b32 v18, v19
    v_add_f32 v16, v16, v17
    v_add_f32 v18, v18, v19
    s_nop 1
    v_permlane32_swap_b32 v16, v18
    v_add_f32 v16, v16, v18
    s_nop 1
    v_max_f32_dpp v21, v16, v16 row_ror:8 row_mask:0xf bank_mask:0xf
    s_nop 1
    v_max_f32_dpp v21, v21, v21 row_ror:4 row_mask:0xf bank_mask:0xf
    s_nop 1
    v_max_f32_dpp v21, v21, v21 row_ror:2 row_mask:0xf bank_mask:0xf
    s_nop 1
    v_max_f32_dpp v21, v21, v21 row_ror:1 row_mask:0xf bank_mask:0xf
    v_mov_b32 v22, v21
    s_nop 1
    v_permlane16_swap_b32 v21, v22
    v_max_f32 v21, v21, v22
    v_mov_b32 v22, v21
    s_nop 1
    v_permlane32_swap_b32 v21, v22
    v_max_f32 v21, v21, v22
    v_mul_f32 v21, s54, v21
    v_fma_f32 v16, v16, s54, -v21
    v_exp_f32 v16, v16
    s_nop 1
    v_add_f32_dpp v21, v16, v16 row_ror:8 row_mask:0xf bank_mask:0xf
    s_nop 1
    v_add_f32_dpp v21, v21, v21 row_ror:4 row_mask:0xf bank_mask:0xf
    s_nop 1
    v_add_f32_dpp v21, v21, v21 row_ror:2 row_mask:0xf bank_mask:0xf
    s_nop 1
    v_add_f32_dpp v21, v21, v21 row_ror:1 row_mask:0xf bank_mask:0xf
    v_mov_b32 v22, v21
    s_nop 1
    v_permlane16_swap_b32 v21, v22
    v_add_f32 v21, v21, v22
    v_mov_b32 v22, v21
    s_nop 1
    v_permlane32_swap_b32 v21, v22
    v_add_f32 v21, v21, v22
    v_rcp_f32 v21, v21
    s_nop 0
    v_mul_f32 v16, v16, v21
    v_bfi_b32 v16, 1, v102, v16
    buffer_store_dword v16, v6, s[36:39], s35 offen sc1
L_lspin1:
    s_sleep 8
L_lrd1:
    ds_read_b128 v[48:51], v8 offset:30976
    ds_read_b128 v[52:55], v8 offset:30992
    s_waitcnt lgkmcnt(0)
    v_max3_u32 v72, v48, v49, v50
    v_max3_u32 v73, v51, v52, v53
    v_max3_u32 v72, v72, v54, v55
    v_max_u32 v72, v72, v73
    v_cmp_eq_u32 vcc, -1, v72
    s_nop 4
    s_cbranch_vccnz L_lspin1
L_w1:
    v_perm_b32 v56, v48, v48, v84
    v_perm_b32 v57, v48, v48, v85
    v_perm_b32 v58, v48, v48, v86
    v_perm_b32 v59, v48, v48, v87
    v_perm_b32 v60, v48, v48, v88
    v_perm_b32 v61, v48, v48, v89
    v_perm_b32 v62, v48, v48, v90
    v_perm_b32 v63, v48, v48, v91
    v_mfma_f32_16x16x32_bf16 v[64:67], v[56:59], v[128:131], 0
    v_mfma_f32_16x16x32_bf16 v[68:71], v[56:59], v[192:195], 0
    v_perm_b32 v56, v49, v49, v84
    v_perm_b32 v57, v49, v49, v85
    v_perm_b32 v58, v49, v49, v86
    v_perm_b32 v59, v49, v49, v87
    v_mfma_f32_16x16x32_bf16 v[64:67], v[60:63], v[132:135], v[64:67]
    v_mfma_f32_16x16x32_bf16 v[68:71], v[60:63], v[196:199], v[68:71]
    v_perm_b32 v60, v49, v49, v88
    v_perm_b32 v61, v49, v49, v89
    v_perm_b32 v62, v49, v49, v90
    v_perm_b32 v63, v49, v49, v91
    v_mfma_f32_16x16x32_bf16 v[64:67], v[56:59], v[136:139], v[64:67]
    v_mfma_f32_16x16x32_bf16 v[68:71], v[56:59], v[200:203], v[68:71]
    v_perm_b32 v56, v50, v50, v84
    v_perm_b32 v57, v50, v50, v85
    v_perm_b32 v58, v50, v50, v86
    v_perm_b32 v59, v50, v50, v87
    v_mfma_f32_16x16x32_bf16 v[64:67], v[60:63], v[140:143], v[64:67]
    v_mfma_f32_16x16x32_bf16 v[68:71], v[60:63], v[204:207], v[68:71]
    v_perm_b32 v60, v50, v50, v88
    v_perm_b32 v61, v50, v50, v89
    v_perm_b32 v62, v50, v50, v90
    v_perm_b32 v63, v50, v50, v91
    v_mfma_f32_16x16x32_bf16 v[64:67], v[56:59], v[144:147], v[64:67]
    v_mfma_f32_16x16x32_bf16 v[68:71], v[56:59], v[208:211], v[68:71]
    v_perm_b32 v56, v51, v51, v84
    v_perm_b32 v57, v51, v51, v85
    v_perm_b32 v58, v51, v51, v86
    v_perm_b32 v59, v51, v51, v87
    v_mfma_f32_16x16x32_bf16 v[64:67], v[60:63], v[148:151], v[64:67]
    v_mfma_f32_16x16x32_bf16 v[68:71], v[60:63], v[212:215], v[68:71]
    v_perm_b32 v60, v51, v51, v88
    v_perm_b32 v61, v51, v51, v89
    v_perm_b32 v62, v51, v51, v90
    v_perm_b32 v63, v51, v51, v91
    v_mfma_f32_16x16x32_bf16 v[64:67], v[56:59], v[152:155], v[64:67]
    v_mfma_f32_16x16x32_bf16 v[68:71], v[56:59], v[216:219], v[68:71]
    v_perm_b32 v56, v52, v52, v84
    v_perm_b32 v57, v52, v52, v85
    v_perm_b32 v58, v52, v52, v86
    v_perm_b32 v59, v52, v52, v87
    v_mfma_f32_16x16x32_bf16 v[64:67], v[60:63], v[156:159], v[64:67]
    v_mfma_f32_16x16x32_bf16 v[68:71], v[60:63], v[220:223], v[68:71]
    v_perm_b32 v60, v52, v52, v88
    v_perm_b32 v61, v52, v52, v89
    v_perm_b32 v62, v52, v52, v90
    v_perm_b32 v63, v52, v52, v91
    v_mfma_f32_16x16x32_bf16 v[64:67], v[56:59], v[160:163], v[64:67]
    v_mfma_f32_16x16x32_bf16 v[68:71], v[56:59], v[224:227], v[68:71]
    v_perm_b32 v56, v53, v53, v84
    v_perm_b32 v57, v53, v53, v85
    v_perm_b32 v58, v53, v53, v86
    v_perm_b32 v59, v53, v53, v87
    v_mfma_f32_16x16x32_bf16 v[64:67], v[60:63], v[164:167], v[64:67]
    v_mfma_f32_16x16x32_bf16 v[68:71], v[60:63], v[228:231], v[68:71]
    v_perm_b32 v60, v53, v53, v88
    v_perm_b32 v61, v53, v53, v89
    v_perm_b32 v62, v53, v53, v90
    v_perm_b32 v63, v53, v53, v91
    v_mfma_f32_16x16x32_bf16 v[64:67], v[56:59], v[168:171], v[64:67]
    v_mfma_f32_16x16x32_bf16 v[68:71], v[56:59], v[232:235], v[68:71]
    v_perm_b32 v56, v54, v54, v84
    v_perm_b32 v57, v54, v54, v85
    v_perm_b32 v58, v54, v54, v86
    v_perm_b32 v59, v54, v54, v87
    v_mfma_f32_16x16x32_bf16 v[64:67], v[60:63], v[172:175], v[64:67]
    v_mfma_f32_16x16x32_bf16 v[68:71], v[60:63], v[236:239], v[68:71]
    v_perm_b32 v60, v54, v54, v88
    v_perm_b32 v61, v54, v54, v89
    v_perm_b32 v62, v54, v54, v90
    v_perm_b32 v63, v54, v54, v91
    v_mfma_f32_16x16x32_bf16 v[64:67], v[56:59], v[176:179], v[64:67]
    v_mfma_f32_16x16x32_bf16 v[68:71], v[56:59], v[240:243], v[68:71]
    v_perm_b32 v56, v55, v55, v84
    v_perm_b32 v57, v55, v55, v85
    v_perm_b32 v58, v55, v55, v86
    v_perm_b32 v59, v55, v55, v87
    v_mfma_f32_16x16x32_bf16 v[64:67], v[60:63], v[180:183], v[64:67]
    v_mfma_f32_16x16x32_bf16 v[68:71], v[60:63], v[244:247], v[68:71]
    v_perm_b32 v60, v55, v55, v88
    v_perm_b32 v61, v55, v55, v89
    v_perm_b32 v62, v55, v55, v90
    v_perm_b32 v63, v55, v55, v91
    v_mfma_f32_16x16x32_bf16 v[64:67], v[56:59], v[184:187], v[64:67]
    v_mfma_f32_16x16x32_bf16 v[68:71], v[56:59], v[248:251], v[68:71]
    v_mfma_f32_16x16x32_bf16 v[64:67], v[60:63], v[188:191], v[64:67]
    v_mfma_f32_16x16x32_bf16 v[68:71], v[60:63], v[252:255], v[68:71]
    s_nop 6
    v_cvt_pk_bf16_f32 v16, v64, v65
    v_cvt_pk_bf16_f32 v17, v66, v67
    v_lshlrev_b32 v20, 16, v16
    v_and_b32 v21, 0xffff0000, v16
    v_lshlrev_b32 v22, 16, v17
    v_and_b32 v23, 0xffff0000, v17
    v_sub_f32 v20, v64, v20
    v_sub_f32 v21, v65, v21
    v_sub_f32 v22, v66, v22
    v_sub_f32 v23, v67, v23
    v_cvt_pk_bf16_f32 v18, v20, v21
    v_cvt_pk_bf16_f32 v19, v22, v23
    ds_write_b64 v5, v[16:17] offset:2304
    ds_write_b64 v5, v[18:19] offset:2880
    v_cvt_pk_bf16_f32 v24, v68, v69
    v_cvt_pk_bf16_f32 v25, v70, v71
    v_lshlrev_b32 v28, 16, v24
    v_and_b32 v29, 0xffff0000, v24
    v_lshlrev_b32 v30, 16, v25
    v_and_b32 v31, 0xffff0000, v25
    v_sub_f32 v28, v68, v28
    v_sub_f32 v29, v69, v29
    v_sub_f32 v30, v70, v30
    v_sub_f32 v31, v71, v31
    v_cvt_pk_bf16_f32 v26, v28, v29
    v_cvt_pk_bf16_f32 v27, v30, v31
    ds_write_b64 v5, v[24:25] offset:2368
    ds_write_b64 v5, v[26:27] offset:2944
    s_waitcnt lgkmcnt(0)
    s_lshl_b32 s42, s3, 2
    v_mov_b32 v72, s42
    v_mov_b32 v73, 1
    ds_write_b32 v72, v73 offset:31248
    s_cmp_lg_u32 s3, 0
    s_cbranch_scc1 L_cend
L_cidle2:
    s_sleep 16
    ds_read_b32 v72, v2 offset:31268
    s_waitcnt lgkmcnt(0)
    v_readfirstlane_b32 s69, v72
    s_nop 1
    s_cmp_lt_u32 s69, 78
    s_cbranch_scc1 L_cidle2
L_ctl2:
    s_sleep 8
    s_mov_b32 exec_lo, 0
    s_mov_b32 exec_hi, 0xffff
    buffer_load_dword v124, v112, s[36:39], s64 offen sc1
    s_mov_b64 exec, -1
    ds_read_b32 v125, v2 offset:31268
    s_waitcnt vmcnt(0) lgkmcnt(0)
    v_xor_b32 v124, v124, v111
    v_and_b32 v124, 1, v124
    v_cmp_eq_u32 s[70:71], 1, v124
    v_readfirstlane_b32 s69, v125
    s_nop 0
    s_bfe_u32 s65, s71, 0x100000
    s_bcnt1_i32_b32 s65, s65
    s_cmp_ge_u32 s69, 88
    s_cbranch_scc1 L_cpub2
    s_cmp_lt_u32 s65, 6
    s_cbranch_scc1 L_cb2
    s_mov_b32 s67, 0x5902
    v_mov_b32 v125, s67
    ds_write_b32 v2, v125 offset:31272
L_cb2:
    s_branch L_ctl2
L_cpub2:
    v_not_b32 v124, v111
    s_add_u32 s42, s41, 32
    s_lshl_b64 exec, 1, s42
    buffer_store_dword v124, v112, s[36:39], s64 offen sc1
    s_mov_b64 exec, -1
    s_cmp_lt_u32 s65, 11
    s_cbranch_scc1 L_cp2
    s_mov_b32 s67, 0x7002
    v_mov_b32 v125, s67
    ds_write_b32 v2, v125 offset:31272
L_cp2:
L_cme2:
    s_cmp_ge_u32 s65, 8
    s_cbranch_scc1 L_ca2
    s_max_u32 s69, s69, 88
    s_sub_u32 s42, s69, 87
    s_mul_i32 s42, s42, 4
    s_add_u32 s42, s42, s69
    s_lshl_b32 s67, s42, 8
    s_or_b32 s67, s67, 1
    v_mov_b32 v125, s67
    ds_write_b32 v2, v125 offset:31272
L_ca2:
    s_cmp_ge_u32 s65, 8
    s_cbranch_scc1 L_cnx2
    s_sleep 8
    s_mov_b32 exec_lo, 0
    s_mov_b32 exec_hi, 0xffff
    buffer_load_dword v124, v112, s[36:39], s64 offen sc1
    s_mov_b64 exec, -1
    ds_read_b32 v125, v2 offset:31268
    s_waitcnt vmcnt(0) lgkmcnt(0)
    v_xor_b32 v124, v124, v111
    v_and_b32 v124, 1, v124
    v_cmp_eq_u32 s[70:71], 1, v124
    v_readfirstlane_b32 s69, v125
    s_nop 0
    s_bfe_u32 s65, s71, 0x100000
    s_bcnt1_i32_b32 s65, s65
    s_branch L_cme2
L_cnx2:
L_cidle3:
    s_sleep 16
    ds_read_b32 v72, v2 offset:31268
    s_waitcnt lgkmcnt(0)
    v_readfirstlane_b32 s69, v72
    s_nop 1
    s_cmp_lt_u32 s69, 98
    s_cbranch_scc1 L_cidle3
L_ctl3:
    s_sleep 8
    s_mov_b32 exec_lo, 0
    s_mov_b32 exec_hi, 0xffff0000
    buffer_load_dword v124, v112, s[36:39], s64 offen sc1
    s_mov_b64 exec, -1
    ds_read_b32 v125, v2 offset:31268
    s_waitcnt vmcnt(0) lgkmcnt(0)
    v_xor_b32 v124, v124, v111
    v_and_b32 v124, 1, v124
    v_cmp_eq_u32 s[70:71], 1, v124
    v_readfirstlane_b32 s69, v125
    s_nop 0
    s_bfe_u32 s65, s71, 0x100010
    s_bcnt1_i32_b32 s65, s65
    s_cmp_ge_u32 s69, 108
    s_cbranch_scc1 L_cpub3
    s_cmp_lt_u32 s65, 6
    s_cbranch_scc1 L_cb3
    s_mov_b32 s67, 0x6d02
    v_mov_b32 v125, s67
    ds_write_b32 v2, v125 offset:31272
L_cb3:
    s_branch L_ctl3
L_cpub3:
    v_not_b32 v124, v111
    s_add_u32 s42, s41, 48
    s_lshl_b64 exec, 1, s42
    buffer_store_dword v124, v112, s[36:39], s64 offen sc1
    s_mov_b64 exec, -1
    s_cmp_lt_u32 s65, 11
    s_cbranch_scc1 L_cp3
    s_mov_b32 s67, 0x8402
    v_mov_b32 v125, s67
    ds_write_b32 v2, v125 offset:31272
L_cp3:
L_cme3:
    s_cmp_ge_u32 s65, 8
    s_cbranch_scc1 L_ca3
    s_max_u32 s69, s69, 108
    s_sub_u32 s42, s69, 107
    s_mul_i32 s42, s42, 4
    s_add_u32 s42, s42, s69
    s_lshl_b32 s67, s42, 8
    s_or_b32 s67, s67, 1
    v_mov_b32 v125, s67
    ds_write_b32 v2, v125 offset:31272
L_ca3:
    s_cmp_ge_u32 s65, 8
    s_cbranch_scc1 L_cnx3
    s_sleep 8
    s_mov_b32 exec_lo, 0
    s_mov_b32 exec_hi, 0xffff0000
    buffer_load_dword v124, v112, s[36:39], s64 offen sc1
    s_mov_b64 exec, -1
    ds_read_b32 v125, v2 offset:31268
    s_waitcnt vmcnt(0) lgkmcnt(0)
    v_xor_b32 v124, v124, v111
    v_and_b32 v124, 1, v124
    v_cmp_eq_u32 s[70:71], 1, v124
    v_readfirstlane_b32 s69, v125
    s_nop 0
    s_bfe_u32 s65, s71, 0x100010
    s_bcnt1_i32_b32 s65, s65
    s_branch L_cme3
L_cnx3:
L_cend:
    s_waitcnt vmcnt(0) lgkmcnt(0)
    s_barrier
    ds_read_b64 v[72:73], v9 offset:0
    ds_read_b64 v[74:75], v9 offset:512
    ds_read_b64 v[76:77], v9 offset:1024
    ds_read_b64 v[78:79], v9 offset:1536
    s_waitcnt lgkmcnt(2)
    v_add_f32 v72, v72, v74
    v_add_f32 v73, v73, v75
    s_waitcnt lgkmcnt(1)
    v_add_f32 v72, v72, v76
    v_add_f32 v73, v73, v77
    s_waitcnt lgkmcnt(0)
    v_add_f32 v72, v72, v78
    v_add_f32 v73, v73, v79
    v_bfi_b32 v72, 1, v92, v72
    v_bfi_b32 v73, 1, v93, v73
    buffer_store_dwordx2 v[72:73], v110, s[36:39], s32 offen sc1
    s_cmp_lg_u32 s3, 0
    s_cbranch_scc1 L_hend
L_opoll:
    s_sleep 2
    buffer_load_dwordx4 v[16:19], v107, s[36:39], s62 offen sc1
    buffer_load_dwordx4 v[20:23], v107, s[36:39], s63 offen sc1
    s_waitcnt vmcnt(1)
    v_alignbit_b32 v72, v16, v2, 1
    v_alignbit_b32 v72, v17, v72, 1
    v_alignbit_b32 v72, v18, v72, 1
    v_alignbit_b32 v72, v19, v72, 1
    s_waitcnt vmcnt(0)
    v_alignbit_b32 v72, v20, v72, 1
    v_alignbit_b32 v72, v21, v72, 1
    v_alignbit_b32 v72, v22, v72, 1
    v_alignbit_b32 v72, v23, v72, 1
    v_xor_b32 v72, v72, v103
    v_cmp_ne_u32 vcc, 0xff000000, v72
    v_and_b32 v16, -2, v16
    v_and_b32 v17, -2, v17
    v_and_b32 v18, -2, v18
    v_and_b32 v19, -2, v19
    v_and_b32 v20, -2, v20
    v_and_b32 v21, -2, v21
    v_and_b32 v22, -2, v22
    v_and_b32 v23, -2, v23
    s_cbranch_vccnz L_opoll
    v_add_f32 v16, v16, v20
    v_add_f32 v17, v17, v21
    v_add_f32 v18, v18, v22
    v_add_f32 v19, v19, v23
    v_permlane16_swap_b32 v16, v17
    s_nop 0
    v_permlane16_swap_b32 v18, v19
    v_add_f32 v16, v16, v17
    v_add_f32 v18, v18, v19
    s_nop 1
    v_permlane32_swap_b32 v16, v18
    v_add_f32 v16, v16, v18
    s_nop 1
    v_add_f32_dpp v16, v16, v16 row_ror:8 row_mask:0xf bank_mask:0xf
    v_cvt_pk_bf16_f32 v16, v16, v16
    s_mov_b32 exec_lo, 0x00ff00ff
    s_mov_b32 exec_hi, 0x00ff00ff
    global_store_short v106, v16, s[14:15]
    s_mov_b64 exec, -1
L_hend:
L_end:
    s_endpgm
.section .rodata,"a"
.p2align 6
.amdhsa_kernel standalone__low_rank_proj_linformer__decode_kernel
  .amdhsa_next_free_vgpr 256
  .amdhsa_next_free_sgpr 80
  .amdhsa_accum_offset 256
  .amdhsa_group_segment_fixed_size 0
  .amdhsa_kernarg_size 64
  .amdhsa_user_sgpr_count 2
  .amdhsa_user_sgpr_kernarg_segment_ptr 1
  .amdhsa_system_sgpr_workgroup_id_x 1
  .amdhsa_float_denorm_mode_32 3
.end_amdhsa_kernel
```
